```python
import torch

def _softmax(x, axis=-1):
    return torch.softmax(x, dim=axis)
def _gelu(x):
    return torch.nn.functional.gelu(x, approximate="tanh")
def _silu(x):
    return torch.nn.functional.silu(x)
def _sigmoid(x):
    return torch.sigmoid(x)
def _layernorm(x, axis=-1, eps=1e-5):
    m = x.mean(dim=axis, keepdim=True)
    v = x.var(dim=axis, keepdim=True, unbiased=False)
    return (x - m) / torch.sqrt(v + eps)
def _scatter_add(tgt, idx, src, axis=0):
    return tgt.clone().index_add_(axis, idx, src)
def _segment_sum(src, seg, n):
    out = torch.zeros((n,) + src.shape[1:], dtype=src.dtype)
    return out.index_add_(0, seg, src)
def _pad(x, pw):
    flat = tuple(v for pair in reversed(pw) for v in pair)
    return torch.nn.functional.pad(x, flat)

kernel_name = 'standalone__mha_block_cached__near_ridge'

def setup_inputs():

    _w = (lambda a: (lambda t: t.to(torch.bfloat16) if t.is_floating_point() else t)(torch.as_tensor(a)))
    B, Sq, D = 16, 144, 512
    H, Sk, Dh = 32, 512, 128
    return {
        "x": _w((lambda *s: torch.randn(*s, dtype=torch.bfloat16) * 0.8)(B, Sq, D)),
        "k_cache": _w((lambda *s: torch.randn(*s, dtype=torch.bfloat16) * 0.8)(B, H, Sk, Dh)),
        "v_cache": _w((lambda *s: torch.randn(*s, dtype=torch.bfloat16) * 0.05)(B, H, Sk, Dh)),
        "wq": _w((lambda *s: torch.randn(*s, dtype=torch.bfloat16) * 0.8)(D, H * Dh) * (D ** -0.5)),
        "wo": _w((lambda *s: torch.randn(*s, dtype=torch.bfloat16) * 0.05)(H * Dh, D) * ((H * Dh) ** -0.5)),
    }

def reference(x, k_cache, v_cache, wq, wo):
    B, Sq, D = x.shape
    H, Dh = 32, 128
    q = (lambda x, *d: x.permute(*d))((x @ wq).reshape(B, Sq, H, Dh), 0, 2, 1, 3)
    scores = torch.einsum("bhqd,bhkd->bhqk", q, k_cache) * (Dh ** -0.5)
    p = _softmax(scores, axis=-1)
    o = torch.einsum("bhqk,bhkd->bhqd", p, v_cache)
    return (lambda x, *d: x.permute(*d))(o, 0, 2, 1, 3).reshape(B, Sq, H * Dh) @ wo
```

```asm
; @launch grid=(256,1,1) block=(256,1,1) lds=163840
.amdgcn_target "amdgcn-amd-amdhsa--gfx950"
.text
.globl standalone__mha_block_cached__near_ridge_kernel
.p2align 8
.type standalone__mha_block_cached__near_ridge_kernel,@function
standalone__mha_block_cached__near_ridge_kernel:
    s_cmp_ge_u32 s2, 256
    s_cbranch_scc1 L_exit
    s_load_dwordx8 s[8:15], s[0:1], 0
    s_load_dwordx8 s[24:31], s[0:1], 32
    v_lshrrev_b32 v1, 6, v0
    s_and_b32 s3, s2, 7
    v_readfirstlane_b32 s36, v1
    s_lshr_b32 s4, s2, 3
    s_and_b32 s5, s3, 1
    s_lshl_b32 s5, s5, 3
    s_and_b32 s6, s4, 7
    s_add_u32 s37, s5, s6
    s_lshr_b32 s45, s3, 1
    s_lshr_b32 s46, s4, 3
    s_lshl_b32 s5, s45, 3
    s_lshl_b32 s6, s46, 1
    s_add_u32 s38, s5, s6
    s_lshl_b32 s39, s36, 12
    s_lshl_b32 s99, s36, 10
    s_xor_b32 s5, s36, s45
    s_lshl_b32 s80, s5, 10
    s_and_b32 s7, s46, 1
    s_and_b32 s5, s37, 3
    s_xor_b32 s7, s7, s5
    s_mul_i32 s5, s37, 147456
    s_lshl_b32 s6, s38, 8
    s_xor_b32 s3, s7, 0
    s_lshl_b32 s4, s3, 8
    s_add_u32 s52, s5, s4
    s_lshl_b32 s4, s3, 20
    s_add_u32 s56, s6, s4
    s_xor_b32 s3, s7, 1
    s_lshl_b32 s4, s3, 8
    s_add_u32 s53, s5, s4
    s_lshl_b32 s4, s3, 20
    s_add_u32 s57, s6, s4
    s_xor_b32 s3, s7, 2
    s_lshl_b32 s4, s3, 8
    s_add_u32 s54, s5, s4
    s_lshl_b32 s4, s3, 20
    s_add_u32 s58, s6, s4
    s_xor_b32 s3, s7, 3
    s_lshl_b32 s4, s3, 8
    s_add_u32 s55, s5, s4
    s_lshl_b32 s4, s3, 20
    s_add_u32 s59, s6, s4
    s_lshl_b32 s5, s37, 5
    s_add_u32 s5, s5, s38
    s_lshl_b32 s40, s5, 17
    s_mov_b32 s41, 0
    s_mov_b32 s76, 0x15000000
    s_mov_b32 s77, 0x15000000
    v_mbcnt_lo_u32_b32 v161, -1, 0
    v_mbcnt_hi_u32_b32 v161, -1, v161
    s_lshl_b32 s3, s36, 15
    v_and_b32 v162, 15, v161
    v_lshrrev_b32 v163, 4, v161
    v_lshlrev_b32 v247, 4, v161
    v_xor_b32 v248, v162, v163
    v_lshlrev_b32 v248, 4, v248
    v_lshl_add_u32 v248, v163, 10, v248
    v_add_u32 v148, s3, v248
    v_xor_b32 v149, 64, v148
    v_add_u32 v149, 3072, v149
    v_xor_b32 v150, 128, v148
    v_add_u32 v150, 6144, v150
    v_xor_b32 v151, 192, v148
    v_add_u32 v151, 9216, v151
    s_mul_i32 s3, s36, 4160
    v_xor_b32 v160, s3, v248
    s_lshl_b32 s3, s36, 2
    v_add_u32 v250, s3, v163
    v_and_b32 v248, 7, v250
    v_lshlrev_b32 v248, 1, v248
    v_xor_b32 v248, v162, v248
    v_lshlrev_b32 v248, 4, v248
    s_lshl_b32 s3, s36, 4
    v_add_u32 v251, s3, v163
    v_lshl_add_u32 v246, v251, 13, v248
    v_lshl_add_u32 v249, v163, 8, s39
    v_add_u32 v245, v248, v249
    v_and_b32 v248, 0xf0, v160
    v_add_u32 v244, v248, v249
    s_waitcnt lgkmcnt(0)
    s_mov_b32 s84, s28
    s_mov_b32 s85, s29
    s_mov_b32 s86, 256
    s_mov_b32 s87, 0x20000
    s_mov_b32 s32, s26
    s_mov_b32 s33, s27
    s_mov_b32 s34, 2359296
    s_mov_b32 s35, 0x20000
    s_mov_b32 s28, s30
    s_mov_b32 s29, s31
    s_mov_b32 s30, 33554432
    s_mov_b32 s31, 0x20000
    s_mov_b32 s26, 4194304
    s_mov_b32 s27, 0x20000
    s_mov_b32 s20, s14
    s_mov_b32 s21, s15
    s_mov_b32 s22, 4194304
    s_mov_b32 s23, 0x20000
    s_mov_b32 s16, s12
    s_mov_b32 s17, s13
    s_mov_b32 s18, 67108864
    s_mov_b32 s19, 0x20000
    s_mov_b32 s12, s10
    s_mov_b32 s13, s11
    s_mov_b32 s14, 67108864
    s_mov_b32 s15, 0x20000
    s_mov_b32 s10, 2359296
    s_mov_b32 s11, 0x20000
L_go:
    s_add_u32 m0, s39, 0
    s_add_u32 s43, s52, 0
    s_buffer_load_dword s100, s[20:23], s56
    s_buffer_load_dword s100, s[20:23], s58
    buffer_load_dwordx4 v148, s[8:11], s43 offen offset:0  lds
    buffer_load_dwordx4 v149, s[8:11], s43 offen offset:1024  lds
    buffer_load_dwordx4 v150, s[8:11], s43 offen offset:2048  lds
    s_mov_b64 exec, 0
    s_cmp_eq_u32 s36, 0
    s_cbranch_scc1 L_pad0
    s_cmp_eq_u32 s36, 1
    s_cbranch_scc1 L_pad1
    s_cmp_eq_u32 s36, 2
    s_cbranch_scc1 L_pad2
    s_branch L_pad3
L_back0:
    s_mov_b64 exec, -1
    buffer_load_dwordx4 v151, s[8:11], s43 offen offset:3072  lds
    s_add_u32 m0, s39, 65536
    s_add_u32 s43, s52, 16384
    buffer_load_dwordx4 v148, s[8:11], s43 offen offset:0  lds
    buffer_load_dwordx4 v149, s[8:11], s43 offen offset:1024  lds
    buffer_load_dwordx4 v150, s[8:11], s43 offen offset:2048  lds
    buffer_load_dwordx4 v151, s[8:11], s43 offen offset:3072  lds
    s_add_u32 m0, s99, 131072
    s_add_u32 s43, s52, 131072
    buffer_load_dwordx4 v160, s[8:11], s43 offen offset:0  lds
    s_add_u32 m0, s39, 16384
    s_add_u32 s43, s56, 0
    s_cmp_eq_u32 s36, 0
    s_cselect_b32 s3, s40, 2130706432
    s_buffer_load_dword s100, s[12:15], s3
    s_buffer_load_dword s100, s[16:19], s3
    buffer_load_dwordx4 v246, s[20:23], s43 offen offset:0  lds
    s_add_u32 s43, s56, 31744
    buffer_load_dwordx4 v246, s[20:23], s43 offen offset:1024  lds
    s_add_u32 s43, s56, 63488
    v_lshlrev_b32 v248, 1, v163
    v_xor_b32 v248, v248, v162
    v_lshlrev_b32 v248, 4, v248
    v_lshl_add_u32 v248, v162, 8, v248
    v_add_u32 v238, 131072, v248
    v_add_u32 v152, s39, v248
    v_add_u32 v156, 65536, v152
    v_xor_b32 v239, 16, v238
    v_xor_b32 v153, 16, v152
    v_xor_b32 v157, 16, v156
    v_xor_b32 v240, 128, v238
    v_xor_b32 v154, 128, v152
    v_xor_b32 v158, 128, v156
    v_xor_b32 v241, 144, v238
    v_xor_b32 v155, 144, v152
    v_xor_b32 v159, 144, v156
    v_lshrrev_b32 v249, 2, v162
    v_and_b32 v248, 1, v163
    v_lshl_add_u32 v248, v248, 2, v249
    v_lshlrev_b32 v248, 5, v248
    v_lshlrev_b32 v251, 12, v163
    v_lshl_add_u32 v251, v249, 8, v251
    v_and_b32 v250, 3, v162
    v_lshl_add_u32 v251, v250, 3, v251
    v_add_u32 v248, v248, v251
    s_lshr_b32 s4, s80, 4
    v_xor_b32 v230, s4, v248
    v_add_u32 v222, 65536, v230
    v_xor_b32 v231, 32, v230
    v_xor_b32 v223, 32, v222
    v_xor_b32 v232, 64, v230
    v_xor_b32 v224, 64, v222
    v_xor_b32 v233, 96, v230
    v_xor_b32 v225, 96, v222
    v_xor_b32 v234, 128, v230
    v_xor_b32 v226, 128, v222
    v_xor_b32 v235, 160, v230
    v_xor_b32 v227, 160, v222
    v_xor_b32 v236, 192, v230
    v_xor_b32 v228, 192, v222
    v_xor_b32 v237, 224, v230
    v_xor_b32 v229, 224, v222
    buffer_load_dwordx4 v246, s[20:23], s43 offen offset:2048  lds
    s_add_u32 s43, s56, 95232
    buffer_load_dwordx4 v246, s[20:23], s43 offen offset:3072  lds
    s_add_u32 m0, s39, 81920
    s_add_u32 s43, s56, 524288
    buffer_load_dwordx4 v246, s[20:23], s43 offen offset:0  lds
    s_add_u32 s43, s56, 556032
    buffer_load_dwordx4 v246, s[20:23], s43 offen offset:1024  lds
    s_add_u32 s43, s56, 587776
    buffer_load_dwordx4 v246, s[20:23], s43 offen offset:2048  lds
    s_add_u32 s43, s56, 619520
    s_lshl_b32 s3, s37, 2
    s_add_u32 s3, s3, s46
    s_lshl_b32 s3, s3, 2
    s_add_u32 s3, s3, s45
    s_lshl_b32 s3, s3, 2
    s_add_u32 s3, s3, s36
    s_lshl_b32 s3, s3, 7
    s_add_u32 s47, s3, 32505856
    s_add_u32 s3, s47, s41
    v_mov_b32 v165, 0
    v_and_b32 v248, 3, v161
    v_lshlrev_b32 v249, 2, v248
    buffer_store_dword v165, v249, s[28:31], s3 offen sc1
    buffer_load_dwordx4 v246, s[20:23], s43 offen offset:3072  lds
    s_add_u32 m0, s39, 32768
    s_add_u32 s43, s53, 0
    s_getpc_b64 s[4:5]
L_pc:
    s_lshr_b32 s3, s2, 3
    s_lshl_b32 s3, s3, 2
    s_add_u32 s3, s3, s36
    s_lshl_b32 s3, s3, 9
    v_and_b32 v180, 3, v161
    v_lshl_add_u32 v180, v180, 7, s3
    v_min_u32 v180, L_exit-L_pc, v180
    v_mov_b32 v183, s5
    v_add_co_u32 v182, vcc, s4, v180
    s_nop 1
    v_addc_co_u32 v183, vcc, 0, v183, vcc
    global_load_dword v166, v[182:183], off
    buffer_load_dwordx4 v148, s[8:11], s43 offen offset:0  lds
    buffer_load_dwordx4 v149, s[8:11], s43 offen offset:1024  lds
    buffer_load_dwordx4 v150, s[8:11], s43 offen offset:2048  lds
    s_xor_b32 s81, s80, 1024
    s_xor_b32 s82, s80, 2048
    s_xor_b32 s83, s80, 3072
    s_lshl_b32 s3, s37, 2
    s_add_u32 s3, s3, s45
    s_mul_i32 s3, s3, 294912
    s_lshl_b32 s4, s36, 13
    s_add_u32 s3, s3, s4
    s_lshl_b32 s5, s45, 20
    s_lshl_b32 s6, s46, 8
    s_add_u32 s5, s5, s6
    s_xor_b32 s6, s46, 0
    s_mul_i32 s7, s6, 73728
    s_add_u32 s64, s3, s7
    s_lshl_b32 s7, s6, 18
    s_add_u32 s60, s5, s7
    s_cmp_le_u32 s46, 0
    s_cselect_b32 s6, 1, 0
    s_mul_i32 s7, s6, 73728
    s_add_u32 s65, s3, s7
    s_lshl_b32 s7, s6, 18
    s_add_u32 s61, s5, s7
    s_cmp_le_u32 s46, 1
    s_cselect_b32 s6, 2, 1
    s_mul_i32 s7, s6, 73728
    s_add_u32 s66, s3, s7
    s_lshl_b32 s7, s6, 18
    s_add_u32 s62, s5, s7
    s_cmp_le_u32 s46, 2
    s_cselect_b32 s6, 3, 2
    s_mul_i32 s7, s6, 73728
    s_add_u32 s67, s3, s7
    s_lshl_b32 s7, s6, 18
    s_add_u32 s63, s5, s7
    s_add_u32 s48, s64, s80
    s_add_u32 s49, s64, s81
    s_add_u32 s50, s64, s82
    s_add_u32 s51, s64, s83
    s_and_b32 s6, s37, 7
    s_lshl_b32 s6, s6, 2
    s_add_u32 s6, s6, s36
    s_lshl_b32 s7, s6, 15
    s_add_u32 s96, s5, s7
    s_lshl_b32 s3, s37, 2
    s_add_u32 s3, s3, s46
    s_lshl_b32 s3, s3, 2
    s_xor_b32 s4, s45, 3
    s_add_u32 s4, s4, s3
    s_lshl_b32 s4, s4, 2
    s_add_u32 s4, s4, s36
    s_mul_i32 s4, s4, 6144
    s_add_u32 s68, s4, 20971520
    s_xor_b32 s4, s45, 2
    s_add_u32 s4, s4, s3
    s_lshl_b32 s4, s4, 2
    s_add_u32 s4, s4, s36
    s_mul_i32 s4, s4, 6144
    s_add_u32 s69, s4, 20973568
    s_xor_b32 s4, s45, 1
    s_add_u32 s4, s4, s3
    s_lshl_b32 s4, s4, 2
    s_add_u32 s4, s4, s36
    s_mul_i32 s4, s4, 6144
    s_add_u32 s70, s4, 20975616
    s_xor_b32 s4, s45, 0
    s_add_u32 s4, s4, s3
    s_lshl_b32 s4, s4, 2
    s_add_u32 s4, s4, s36
    s_mul_i32 s4, s4, 6144
    s_add_u32 s71, s4, 20971520
    s_xor_b32 s4, s45, s36
    s_add_u32 s4, s4, s3
    s_lshl_b32 s4, s4, 12
    s_add_u32 s4, s4, 29360128
    s_add_u32 s5, s4, s99
    s_cmp_eq_u32 s36, 0
    s_cselect_b32 s73, s4, 2130706432
    s_cselect_b32 s72, 2130706432, s5
    s_mul_i32 s4, s37, 147456
    s_lshl_b32 s5, s46, 8
    s_add_u32 s4, s4, s5
    s_xor_b32 s5, s45, s36
    s_xor_b32 s6, s5, 3
    s_lshl_b32 s6, s6, 6
    s_lshl_b32 s7, s36, 15
    s_add_u32 s6, s6, s7
    s_add_u32 s74, s4, s6
    s_lshl_b32 s5, s5, 6
    s_add_u32 s4, s4, s5
    s_add_u32 s4, s4, 131072
    s_cmp_eq_u32 s36, 0
    s_cselect_b32 s75, s4, 2130706432
    s_mov_b32 s42, 0x3e0293ee
    s_mov_b32 s78, 0x39800000
    v_mov_b32 v0, 1
    s_lshl_b32 s6, s37, 4
    s_add_u32 s7, s6, s39
    v_mov_b32 v1, s7
    s_cmp_eq_u32 s36, 0
    s_cselect_b32 s101, 16, 0
    v_add_u32 v172, s39, v161
    s_and_b32 s7, s46, 1
    s_lshl_b32 s7, s7, 8
    s_add_u32 s6, s6, s7
    v_lshl_add_u32 v248, v172, 9, s6
    v_xor_b32 v249, 256, v248
    v_and_b32 v172, 1, v163
    v_lshlrev_b32 v172, 1, v172
    v_lshrrev_b32 v173, 1, v163
    v_or_b32 v172, v172, v173
    v_xor_b32 v172, v172, v162
    v_lshrrev_b32 v173, 2, v162
    v_and_b32 v174, 3, v162
    v_lshlrev_b32 v175, 12, v173
    v_lshl_add_u32 v175, v174, 8, v175
    v_lshl_add_u32 v172, v172, 4, v175
    s_lshr_b32 s4, s80, 4
    v_xor_b32 v214, s4, v172
    v_add_u32 v218, s99, v214
    v_xor_b32 v215, 64, v214
    v_xor_b32 v219, 64, v218
    v_xor_b32 v216, 128, v214
    v_xor_b32 v220, 128, v218
    v_xor_b32 v217, 192, v214
    v_xor_b32 v221, 192, v218
    v_mov_b32 v202, 0
    v_mov_b32 v203, 0
    v_mov_b32 v204, 0
    v_mov_b32 v205, 0
    v_mov_b32 v206, 0
    v_mov_b32 v207, 0
    v_mov_b32 v208, 0
    v_mov_b32 v209, 0
    v_mov_b32 v210, 0
    v_mov_b32 v211, 0
    v_mov_b32 v212, 0
    v_mov_b32 v213, 0
    v_cmp_eq_u32 vcc, 0, v174
    v_mov_b32 v176, 0x3f803f80
    s_nop 1
    v_cndmask_b32 v176, v202, v176, vcc
    v_accvgpr_write_b32 a240, v176
    v_accvgpr_write_b32 a241, v176
    v_accvgpr_write_b32 a242, v176
    v_accvgpr_write_b32 a243, v176
    v_add_u32 v242, 131072, v247
    s_lshr_b32 s3, s36, 1
    s_lshl_b32 s3, s3, 10
    s_and_b32 s7, s36, 1
    s_lshl_b32 s7, s7, 3
    s_add_u32 s3, s3, s7
    s_add_u32 s3, s3, 147456
    v_add_u32 v243, s3, v247
    v_add_u32 v252, s80, v242
    v_add_u32 v253, s81, v242
    v_add_u32 v254, s82, v242
    v_add_u32 v255, s83, v242
    buffer_load_dwordx4 v151, s[8:11], s43 offen offset:3072  lds
    s_add_u32 m0, s39, 98304
    s_add_u32 s43, s53, 16384
    s_cmp_lg_u32 s36, 1
    s_cbranch_scc1 L_noto
    s_buffer_load_dword s100, s[24:27], s60
    s_buffer_load_dword s100, s[28:31], s64
    s_buffer_load_dword s100, s[28:31], s66
    s_buffer_load_dword s100, s[28:31], s71
    s_buffer_load_dword s100, s[28:31], s72
    s_buffer_load_dword s100, s[32:35], s74
L_noto:
    buffer_load_dwordx4 v148, s[8:11], s43 offen offset:0  lds
    buffer_load_dwordx4 v149, s[8:11], s43 offen offset:1024  lds
    buffer_load_dwordx4 v150, s[8:11], s43 offen offset:2048  lds
    buffer_load_dwordx4 v151, s[8:11], s43 offen offset:3072  lds
    s_add_u32 m0, s99, 135168
    s_add_u32 s43, s53, 131072
    buffer_load_dwordx4 v160, s[8:11], s43 offen offset:0  lds
    s_add_u32 m0, s39, 49152
    s_add_u32 s43, s57, 0
    buffer_load_dwordx4 v246, s[20:23], s43 offen offset:0  lds
    s_add_u32 s43, s57, 31744
    buffer_load_dwordx4 v246, s[20:23], s43 offen offset:1024  lds
    s_add_u32 s43, s57, 63488
    buffer_load_dwordx4 v246, s[20:23], s43 offen offset:2048  lds
    s_add_u32 s43, s57, 95232
    buffer_load_dwordx4 v246, s[20:23], s43 offen offset:3072  lds
    s_add_u32 m0, s39, 114688
    s_add_u32 s43, s57, 524288
    s_branch L_pad0
.p2align 12
L_pad0:
    s_cbranch_execz L_back0
    s_waitcnt vmcnt(13)
    s_barrier
    ds_read_b128 a[0:3], v152 offset:0
    ds_read_b64_tr_b16 a[128:129], v230 offset:16384
    ds_read_b64_tr_b16 a[130:131], v230 offset:17408
    s_waitcnt lgkmcnt(0)
    v_mfma_f32_16x16x32_bf16 v[4:7], a[128:131], a[0:3], 0
    ds_read_b128 a[4:7], v153 offset:0
    ds_read_b64_tr_b16 a[132:133], v230 offset:18432
    ds_read_b64_tr_b16 a[134:135], v230 offset:19456
    ds_read_b128 a[8:11], v154 offset:0
    ds_read_b64_tr_b16 a[136:137], v222 offset:16384
    s_waitcnt lgkmcnt(2)
    v_mfma_f32_16x16x32_bf16 v[4:7], a[132:135], a[4:7], v[4:7]
    ds_read_b64_tr_b16 a[138:139], v222 offset:17408
    ds_read_b128 a[12:15], v155 offset:0
    ds_read_b64_tr_b16 a[140:141], v222 offset:18432
    ds_read_b64_tr_b16 a[142:143], v222 offset:19456
    s_waitcnt lgkmcnt(3)
    v_mfma_f32_16x16x32_bf16 v[4:7], a[136:139], a[8:11], v[4:7]
    s_waitcnt lgkmcnt(0)
    buffer_load_dwordx4 v246, s[20:23], s43 offen offset:0  lds
    ds_read_b128 a[76:79], v159 offset:0
    ds_read_b128 a[72:75], v158 offset:0
    v_mfma_f32_16x16x32_bf16 v[4:7], a[140:143], a[12:15], v[4:7]
    s_waitcnt lgkmcnt(1)
    ds_read_b128 a[68:71], v157 offset:0
    ds_read_b64_tr_b16 a[144:145], v231 offset:16384
    ds_read_b128 a[64:67], v156 offset:0
    ds_read_b128 a[224:227], v238 offset:0
    v_mfma_f32_16x16x32_bf16 v[36:39], a[140:143], a[76:79], 0
    s_waitcnt lgkmcnt(4)
    ds_read_b128 a[228:231], v239 offset:0
    ds_read_b64_tr_b16 a[146:147], v231 offset:17408
    ds_read_b128 a[232:235], v240 offset:0
    ds_read_b128 a[236:239], v241 offset:0
    v_mfma_f32_16x16x32_bf16 v[36:39], a[136:139], a[72:75], v[36:39]
    s_waitcnt lgkmcnt(7)
    s_add_u32 s43, s57, 556032
    ds_read_b64_tr_b16 a[148:149], v231 offset:18432
    v_mfma_f32_16x16x32_bf16 v[36:39], a[132:135], a[68:71], v[36:39]
    s_waitcnt lgkmcnt(6)
    buffer_load_dwordx4 v246, s[20:23], s43 offen offset:1024  lds
    ds_read_b64_tr_b16 a[150:151], v231 offset:19456
    v_mfma_f32_16x16x32_bf16 v[36:39], a[128:131], a[64:67], v[36:39]
    s_waitcnt lgkmcnt(6)
    ds_read_b64_tr_b16 a[152:153], v223 offset:16384
    ds_read_b64_tr_b16 a[154:155], v223 offset:17408
    v_mfma_f32_16x16x32_bf16 v[68:71], a[128:131], a[224:227], 0
    s_waitcnt lgkmcnt(7)
    ds_read_b64_tr_b16 a[156:157], v223 offset:18432
    ds_read_b64_tr_b16 a[158:159], v223 offset:19456
    v_mfma_f32_16x16x32_bf16 v[68:71], a[132:135], a[228:231], v[68:71]
    s_waitcnt lgkmcnt(7)
    s_add_u32 s43, s57, 587776
    v_mfma_f32_16x16x32_bf16 v[68:71], a[136:139], a[232:235], v[68:71]
    s_waitcnt lgkmcnt(6)
    buffer_load_dwordx4 v246, s[20:23], s43 offen offset:2048  lds
    v_mfma_f32_16x16x32_bf16 v[68:71], a[140:143], a[236:239], v[68:71]
    ds_read_b64_tr_b16 a[160:161], v232 offset:16384
    v_mfma_f32_16x16x32_bf16 v[8:11], a[144:147], a[0:3], 0
    s_waitcnt lgkmcnt(5)
    ds_read_b64_tr_b16 a[162:163], v232 offset:17408
    v_mfma_f32_16x16x32_bf16 v[8:11], a[148:151], a[4:7], v[8:11]
    s_waitcnt lgkmcnt(4)
    s_add_u32 s43, s57, 619520
    ds_read_b64_tr_b16 a[164:165], v232 offset:18432
    v_mfma_f32_16x16x32_bf16 v[8:11], a[152:155], a[8:11], v[8:11]
    s_waitcnt lgkmcnt(3)
    buffer_load_dwordx4 v246, s[20:23], s43 offen offset:3072  lds
    v_mfma_f32_16x16x32_bf16 v[8:11], a[156:159], a[12:15], v[8:11]
    s_add_u32 m0, s99, 139264
    ds_read_b64_tr_b16 a[166:167], v232 offset:19456
    v_mfma_f32_16x16x32_bf16 v[40:43], a[156:159], a[76:79], 0
    s_add_u32 s43, s54, 131072
    ds_read_b64_tr_b16 a[168:169], v224 offset:16384
    v_mfma_f32_16x16x32_bf16 v[40:43], a[152:155], a[72:75], v[40:43]
    s_lshl_b32 s3, s36, 2
    buffer_load_dwordx4 v160, s[8:11], s43 offen offset:0  lds
    v_mfma_f32_16x16x32_bf16 v[40:43], a[148:151], a[68:71], v[40:43]
    s_add_u32 m0, s39, 0
    ds_read_b64_tr_b16 a[170:171], v224 offset:17408
    ds_read_b64_tr_b16 a[172:173], v224 offset:18432
    v_mfma_f32_16x16x32_bf16 v[40:43], a[144:147], a[64:67], v[40:43]
    s_add_u32 s43, s54, 0
    ds_read_b64_tr_b16 a[174:175], v224 offset:19456
    v_mfma_f32_16x16x32_bf16 v[72:75], a[144:147], a[224:227], 0
    s_add_u32 s4, s3, 159744
    buffer_load_dwordx4 v148, s[8:11], s43 offen offset:0  lds
    v_mfma_f32_16x16x32_bf16 v[72:75], a[148:151], a[228:231], v[72:75]
    s_lshl_b32 s5, s36, 13
    ds_read_b64_tr_b16 a[128:129], v233 offset:16384
    v_mfma_f32_16x16x32_bf16 v[72:75], a[152:155], a[232:235], v[72:75]
    s_sub_u32 s5, 32768, s5
    buffer_load_dwordx4 v149, s[8:11], s43 offen offset:1024  lds
    v_mfma_f32_16x16x32_bf16 v[72:75], a[156:159], a[236:239], v[72:75]
    s_waitcnt lgkmcnt(7)
    ds_read_b64_tr_b16 a[130:131], v233 offset:17408
    ds_read_b64_tr_b16 a[132:133], v233 offset:18432
    v_mfma_f32_16x16x32_bf16 v[12:15], a[160:163], a[0:3], 0
    s_waitcnt lgkmcnt(7)
    buffer_load_dwordx4 v150, s[8:11], s43 offen offset:2048  lds
    v_mfma_f32_16x16x32_bf16 v[12:15], a[164:167], a[4:7], v[12:15]
    s_waitcnt lgkmcnt(5)
    ds_read_b64_tr_b16 a[134:135], v233 offset:19456
    ds_read_b64_tr_b16 a[136:137], v225 offset:16384
    v_mfma_f32_16x16x32_bf16 v[12:15], a[168:171], a[8:11], v[12:15]
    s_waitcnt lgkmcnt(5)
    buffer_load_dwordx4 v151, s[8:11], s43 offen offset:3072  lds
    v_mfma_f32_16x16x32_bf16 v[12:15], a[172:175], a[12:15], v[12:15]
    s_add_u32 m0, s39, 65536
    ds_read_b64_tr_b16 a[138:139], v225 offset:17408
    ds_read_b64_tr_b16 a[140:141], v225 offset:18432
    v_mfma_f32_16x16x32_bf16 v[44:47], a[172:175], a[76:79], 0
    s_add_u32 s43, s54, 16384
    ds_read_b64_tr_b16 a[142:143], v225 offset:19456
    v_mfma_f32_16x16x32_bf16 v[44:47], a[168:171], a[72:75], v[44:47]
    s_add_u32 s5, s5, s83
    buffer_load_dwordx4 v148, s[8:11], s43 offen offset:0  lds
    v_mfma_f32_16x16x32_bf16 v[44:47], a[164:167], a[68:71], v[44:47]
    s_waitcnt vmcnt(19)
    ds_read_b128 a[16:19], v152 offset:32768
    ds_read_b64_tr_b16 a[144:145], v234 offset:16384
    v_mfma_f32_16x16x32_bf16 v[44:47], a[160:163], a[64:67], v[44:47]
    s_waitcnt lgkmcnt(8)
    buffer_load_dwordx4 v149, s[8:11], s43 offen offset:1024  lds
    v_mfma_f32_16x16x32_bf16 v[16:19], a[128:131], a[0:3], 0
    s_waitcnt lgkmcnt(6)
    ds_read_b64_tr_b16 a[146:147], v234 offset:17408
    ds_read_b64_tr_b16 a[148:149], v234 offset:18432
    v_mfma_f32_16x16x32_bf16 v[16:19], a[132:135], a[4:7], v[16:19]
    s_waitcnt lgkmcnt(6)
    buffer_load_dwordx4 v150, s[8:11], s43 offen offset:2048  lds
    v_mfma_f32_16x16x32_bf16 v[16:19], a[136:139], a[8:11], v[16:19]
    s_waitcnt lgkmcnt(4)
    ds_read_b64_tr_b16 a[150:151], v234 offset:19456
    ds_read_b64_tr_b16 a[152:153], v226 offset:16384
    v_mfma_f32_16x16x32_bf16 v[16:19], a[140:143], a[12:15], v[16:19]
    ds_read_b64_tr_b16 a[154:155], v226 offset:17408
    ds_read_b64_tr_b16 a[156:157], v226 offset:18432
    v_mfma_f32_16x16x32_bf16 v[48:51], a[140:143], a[76:79], 0
    ds_read_b64_tr_b16 a[158:159], v226 offset:19456
    v_mfma_f32_16x16x32_bf16 v[48:51], a[136:139], a[72:75], v[48:51]
    ds_read_b128 a[20:23], v153 offset:32768
    ds_read_b64_tr_b16 a[160:161], v235 offset:16384
    v_mfma_f32_16x16x32_bf16 v[48:51], a[132:135], a[68:71], v[48:51]
    buffer_load_dwordx4 v151, s[8:11], s43 offen offset:3072  lds
    v_mfma_f32_16x16x32_bf16 v[48:51], a[128:131], a[64:67], v[48:51]
    s_waitcnt lgkmcnt(8)
    ds_read_b128 a[24:27], v154 offset:32768
    ds_read_b64_tr_b16 a[162:163], v235 offset:17408
    v_mfma_f32_16x16x32_bf16 v[20:23], a[144:147], a[0:3], 0
    s_waitcnt lgkmcnt(8)
    ds_read_b128 a[28:31], v155 offset:32768
    ds_read_b64_tr_b16 a[164:165], v235 offset:18432
    v_mfma_f32_16x16x32_bf16 v[20:23], a[148:151], a[4:7], v[20:23]
    s_waitcnt lgkmcnt(8)
    s_add_u32 m0, s39, 32768
    s_add_u32 s43, s58, 0
    v_mfma_f32_16x16x32_bf16 v[20:23], a[152:155], a[8:11], v[20:23]
    s_waitcnt lgkmcnt(6)
    ds_read_b64_tr_b16 a[166:167], v235 offset:19456
    ds_read_b64_tr_b16 a[168:169], v227 offset:16384
    v_mfma_f32_16x16x32_bf16 v[20:23], a[156:159], a[12:15], v[20:23]
    ds_read_b64_tr_b16 a[170:171], v227 offset:17408
    ds_read_b64_tr_b16 a[172:173], v227 offset:18432
    v_mfma_f32_16x16x32_bf16 v[52:55], a[156:159], a[76:79], 0
    ds_read_b64_tr_b16 a[174:175], v227 offset:19456
    ds_read_b64_tr_b16 a[128:129], v236 offset:16384
    v_mfma_f32_16x16x32_bf16 v[52:55], a[152:155], a[72:75], v[52:55]
    s_waitcnt vmcnt(18)
    ds_read_b128 a[80:83], v156 offset:32768
    ds_read_b64_tr_b16 a[130:131], v236 offset:17408
    v_mfma_f32_16x16x32_bf16 v[52:55], a[148:151], a[68:71], v[52:55]
    ds_read_b128 a[84:87], v157 offset:32768
    ds_read_b64_tr_b16 a[132:133], v236 offset:18432
    v_mfma_f32_16x16x32_bf16 v[52:55], a[144:147], a[64:67], v[52:55]
    s_waitcnt lgkmcnt(11)
    buffer_load_dwordx4 v246, s[20:23], s43 offen offset:0  lds
    v_mfma_f32_16x16x32_bf16 v[24:27], a[160:163], a[0:3], 0
    s_waitcnt lgkmcnt(9)
    ds_read_b128 a[88:91], v158 offset:32768
    ds_read_b64_tr_b16 a[134:135], v236 offset:19456
    v_mfma_f32_16x16x32_bf16 v[24:27], a[164:167], a[4:7], v[24:27]
    s_waitcnt lgkmcnt(9)
    ds_read_b64_tr_b16 a[136:137], v228 offset:16384
    ds_read_b64_tr_b16 a[138:139], v228 offset:17408
    v_mfma_f32_16x16x32_bf16 v[24:27], a[168:171], a[8:11], v[24:27]
    s_waitcnt lgkmcnt(9)
    s_add_u32 s43, s58, 31744
    ds_read_b128 a[92:95], v159 offset:32768
    v_mfma_f32_16x16x32_bf16 v[24:27], a[172:175], a[12:15], v[24:27]
    buffer_load_dwordx4 v246, s[20:23], s43 offen offset:1024  lds
    v_mfma_f32_16x16x32_bf16 v[56:59], a[172:175], a[76:79], 0
    s_add_u32 s43, s58, 63488
    ds_read_b64_tr_b16 a[140:141], v228 offset:18432
    ds_read_b64_tr_b16 a[142:143], v228 offset:19456
    v_mfma_f32_16x16x32_bf16 v[56:59], a[168:171], a[72:75], v[56:59]
    buffer_load_dwordx4 v246, s[20:23], s43 offen offset:2048  lds
    v_mfma_f32_16x16x32_bf16 v[56:59], a[164:167], a[68:71], v[56:59]
    s_add_u32 s43, s58, 95232
    ds_read_b64_tr_b16 a[144:145], v237 offset:16384
    ds_read_b64_tr_b16 a[146:147], v237 offset:17408
    v_mfma_f32_16x16x32_bf16 v[56:59], a[160:163], a[64:67], v[56:59]
    s_waitcnt lgkmcnt(11)
    buffer_load_dwordx4 v246, s[20:23], s43 offen offset:3072  lds
    ds_read_b64_tr_b16 a[148:149], v237 offset:18432
    v_mfma_f32_16x16x32_bf16 v[28:31], a[128:131], a[0:3], 0
    s_waitcnt lgkmcnt(8)
    ds_read_b64_tr_b16 a[150:151], v237 offset:19456
    ds_read_b64_tr_b16 a[152:153], v229 offset:16384
    v_mfma_f32_16x16x32_bf16 v[28:31], a[132:135], a[4:7], v[28:31]
    s_waitcnt lgkmcnt(8)
    ds_read_b64_tr_b16 a[154:155], v229 offset:17408
    ds_read_b64_tr_b16 a[156:157], v229 offset:18432
    v_mfma_f32_16x16x32_bf16 v[28:31], a[136:139], a[8:11], v[28:31]
    s_waitcnt lgkmcnt(7)
    s_add_u32 m0, s39, 98304
    s_add_u32 s43, s58, 524288
    v_mfma_f32_16x16x32_bf16 v[28:31], a[140:143], a[12:15], v[28:31]
    buffer_load_dwordx4 v246, s[20:23], s43 offen offset:0  lds
    ds_read_b64_tr_b16 a[158:159], v229 offset:19456
    v_mfma_f32_16x16x32_bf16 v[60:63], a[140:143], a[76:79], 0
    s_add_u32 s43, s58, 556032
    v_mfma_f32_16x16x32_bf16 v[60:63], a[136:139], a[72:75], v[60:63]
    v_mfma_f32_16x16x32_bf16 v[60:63], a[132:135], a[68:71], v[60:63]
    v_mfma_f32_16x16x32_bf16 v[60:63], a[128:131], a[64:67], v[60:63]
    s_waitcnt vmcnt(14) lgkmcnt(0)
    s_barrier
    ds_read_b64_tr_b16 a[160:161], v230 offset:49152
    ds_read_b64_tr_b16 a[162:163], v230 offset:50176
    v_mfma_f32_16x16x32_bf16 v[32:35], a[144:147], a[0:3], 0
    buffer_load_dwordx4 v246, s[20:23], s43 offen offset:1024  lds
    ds_read_b64_tr_b16 a[164:165], v230 offset:51200
    v_mfma_f32_16x16x32_bf16 v[32:35], a[148:151], a[4:7], v[32:35]
    ds_read_b64_tr_b16 a[166:167], v230 offset:52224
    ds_read_b64_tr_b16 a[168:169], v222 offset:49152
    v_mfma_f32_16x16x32_bf16 v[32:35], a[152:155], a[8:11], v[32:35]
    ds_read_b64_tr_b16 a[170:171], v222 offset:50176
    ds_read_b64_tr_b16 a[172:173], v222 offset:51200
    v_mfma_f32_16x16x32_bf16 v[32:35], a[156:159], a[12:15], v[32:35]
    s_add_u32 s43, s58, 587776
    ds_read_b64_tr_b16 a[174:175], v222 offset:52224
    v_mfma_f32_16x16x32_bf16 v[64:67], a[156:159], a[76:79], 0
    buffer_load_dwordx4 v246, s[20:23], s43 offen offset:2048  lds
    v_mfma_f32_16x16x32_bf16 v[64:67], a[152:155], a[72:75], v[64:67]
    s_add_u32 s43, s58, 619520
    ds_read_b128 a[224:227], v238 offset:4096
    v_mfma_f32_16x16x32_bf16 v[64:67], a[148:151], a[68:71], v[64:67]
    ds_read_b128 a[228:231], v239 offset:4096
    v_mfma_f32_16x16x32_bf16 v[64:67], a[144:147], a[64:67], v[64:67]
    s_waitcnt lgkmcnt(8)
    buffer_load_dwordx4 v246, s[20:23], s43 offen offset:3072  lds
    v_mfma_f32_16x16x32_bf16 v[4:7], a[160:163], a[16:19], v[4:7]
    s_waitcnt lgkmcnt(6)
    ds_read_b128 a[232:235], v240 offset:4096
    v_mfma_f32_16x16x32_bf16 v[4:7], a[164:167], a[20:23], v[4:7]
    s_waitcnt lgkmcnt(5)
    ds_read_b128 a[236:239], v241 offset:4096
    ds_read_b64_tr_b16 a[128:129], v231 offset:49152
    v_mfma_f32_16x16x32_bf16 v[4:7], a[168:171], a[24:27], v[4:7]
    s_waitcnt lgkmcnt(5)
    ds_read_b64_tr_b16 a[130:131], v231 offset:50176
    v_mfma_f32_16x16x32_bf16 v[4:7], a[172:175], a[28:31], v[4:7]
    s_add_u32 m0, s39, 16384
    s_add_u32 s43, s55, 0
    v_mfma_f32_16x16x32_bf16 v[36:39], a[172:175], a[92:95], v[36:39]
    buffer_load_dwordx4 v148, s[8:11], s43 offen offset:0  lds
    v_mfma_f32_16x16x32_bf16 v[36:39], a[168:171], a[88:91], v[36:39]
    ds_read_b64_tr_b16 a[132:133], v231 offset:51200
    ds_read_b64_tr_b16 a[134:135], v231 offset:52224
    v_mfma_f32_16x16x32_bf16 v[36:39], a[164:167], a[84:87], v[36:39]
    ds_read_b64_tr_b16 a[136:137], v223 offset:49152
    ds_read_b64_tr_b16 a[138:139], v223 offset:50176
    v_mfma_f32_16x16x32_bf16 v[36:39], a[160:163], a[80:83], v[36:39]
    s_waitcnt lgkmcnt(9)
    ds_read_b64_tr_b16 a[140:141], v223 offset:51200
    ds_read_b64_tr_b16 a[142:143], v223 offset:52224
    v_mfma_f32_16x16x32_bf16 v[68:71], a[160:163], a[224:227], v[68:71]
    s_waitcnt lgkmcnt(10)
    buffer_load_dwordx4 v149, s[8:11], s43 offen offset:1024  lds
    v_mfma_f32_16x16x32_bf16 v[68:71], a[164:167], a[228:231], v[68:71]
    s_waitcnt lgkmcnt(9)
    v_mfma_f32_16x16x32_bf16 v[68:71], a[168:171], a[232:235], v[68:71]
    s_waitcnt lgkmcnt(8)
    ds_read_b64_tr_b16 a[144:145], v232 offset:49152
    v_mfma_f32_16x16x32_bf16 v[68:71], a[172:175], a[236:239], v[68:71]
    s_waitcnt lgkmcnt(7)
    ds_read_b64_tr_b16 a[146:147], v232 offset:50176
    v_mfma_f32_16x16x32_bf16 v[8:11], a[128:131], a[16:19], v[8:11]
    s_waitcnt lgkmcnt(6)
    ds_read_b64_tr_b16 a[148:149], v232 offset:51200
    v_mfma_f32_16x16x32_bf16 v[8:11], a[132:135], a[20:23], v[8:11]
    s_waitcnt lgkmcnt(5)
    buffer_load_dwordx4 v150, s[8:11], s43 offen offset:2048  lds
    v_mfma_f32_16x16x32_bf16 v[8:11], a[136:139], a[24:27], v[8:11]
    s_waitcnt lgkmcnt(3)
    ds_read_b64_tr_b16 a[150:151], v232 offset:52224
    v_mfma_f32_16x16x32_bf16 v[8:11], a[140:143], a[28:31], v[8:11]
    ds_read_b64_tr_b16 a[152:153], v224 offset:49152
    v_mfma_f32_16x16x32_bf16 v[40:43], a[140:143], a[92:95], v[40:43]
    ds_read_b64_tr_b16 a[154:155], v224 offset:50176
    v_mfma_f32_16x16x32_bf16 v[40:43], a[136:139], a[88:91], v[40:43]
    ds_read_b64_tr_b16 a[156:157], v224 offset:51200
    v_mfma_f32_16x16x32_bf16 v[40:43], a[132:135], a[84:87], v[40:43]
    buffer_load_dwordx4 v151, s[8:11], s43 offen offset:3072  lds
    v_mfma_f32_16x16x32_bf16 v[40:43], a[128:131], a[80:83], v[40:43]
    s_add_u32 m0, s39, 81920
    ds_read_b64_tr_b16 a[158:159], v224 offset:52224
    v_mfma_f32_16x16x32_bf16 v[72:75], a[128:131], a[224:227], v[72:75]
    s_add_u32 s43, s55, 16384
    ds_read_b64_tr_b16 a[160:161], v233 offset:49152
    v_mfma_f32_16x16x32_bf16 v[72:75], a[132:135], a[228:231], v[72:75]
    ds_read_b64_tr_b16 a[162:163], v233 offset:50176
    v_mfma_f32_16x16x32_bf16 v[72:75], a[136:139], a[232:235], v[72:75]
    buffer_load_dwordx4 v148, s[8:11], s43 offen offset:0  lds
    v_mfma_f32_16x16x32_bf16 v[72:75], a[140:143], a[236:239], v[72:75]
    s_waitcnt lgkmcnt(8)
    ds_read_b64_tr_b16 a[164:165], v233 offset:51200
    ds_read_b64_tr_b16 a[166:167], v233 offset:52224
    v_mfma_f32_16x16x32_bf16 v[12:15], a[144:147], a[16:19], v[12:15]
    s_waitcnt lgkmcnt(8)
    ds_read_b64_tr_b16 a[168:169], v225 offset:49152
    v_mfma_f32_16x16x32_bf16 v[12:15], a[148:151], a[20:23], v[12:15]
    s_waitcnt lgkmcnt(7)
    ds_read_b64_tr_b16 a[170:171], v225 offset:50176
    v_mfma_f32_16x16x32_bf16 v[12:15], a[152:155], a[24:27], v[12:15]
    s_waitcnt lgkmcnt(6)
    ds_read_b64_tr_b16 a[172:173], v225 offset:51200
    ds_read_b64_tr_b16 a[174:175], v225 offset:52224
    v_mfma_f32_16x16x32_bf16 v[12:15], a[156:159], a[28:31], v[12:15]
    buffer_load_dwordx4 v149, s[8:11], s43 offen offset:1024  lds
    v_mfma_f32_16x16x32_bf16 v[44:47], a[156:159], a[92:95], v[44:47]
    ds_read_b64_tr_b16 a[128:129], v234 offset:49152
    v_mfma_f32_16x16x32_bf16 v[44:47], a[152:155], a[88:91], v[44:47]
    buffer_load_dwordx4 v150, s[8:11], s43 offen offset:2048  lds
    v_mfma_f32_16x16x32_bf16 v[44:47], a[148:151], a[84:87], v[44:47]
    ds_read_b64_tr_b16 a[130:131], v234 offset:50176
    v_mfma_f32_16x16x32_bf16 v[44:47], a[144:147], a[80:83], v[44:47]
    s_waitcnt lgkmcnt(8)
    buffer_load_dwordx4 v151, s[8:11], s43 offen offset:3072  lds
    v_mfma_f32_16x16x32_bf16 v[16:19], a[160:163], a[16:19], v[16:19]
    s_waitcnt vmcnt(20) lgkmcnt(6)
    ds_read_b128 a[32:35], v152 offset:0
    ds_read_b64_tr_b16 a[132:133], v234 offset:51200
    v_mfma_f32_16x16x32_bf16 v[16:19], a[164:167], a[20:23], v[16:19]
    s_waitcnt lgkmcnt(6)
    ds_read_b64_tr_b16 a[134:135], v234 offset:52224
    ds_read_b64_tr_b16 a[136:137], v226 offset:49152
    v_mfma_f32_16x16x32_bf16 v[16:19], a[168:171], a[24:27], v[16:19]
    s_waitcnt lgkmcnt(6)
    s_add_u32 m0, s99, 143360
    s_add_u32 s43, s55, 131072
    v_mfma_f32_16x16x32_bf16 v[16:19], a[172:175], a[28:31], v[16:19]
    buffer_load_dwordx4 v160, s[8:11], s43 offen offset:0  lds
    v_mfma_f32_16x16x32_bf16 v[48:51], a[172:175], a[92:95], v[48:51]
    s_add_u32 m0, s39, 0
    ds_read_b64_tr_b16 a[138:139], v226 offset:50176
    ds_read_b64_tr_b16 a[140:141], v226 offset:51200
    v_mfma_f32_16x16x32_bf16 v[48:51], a[168:171], a[88:91], v[48:51]
    s_add_u32 s43, s59, 0
    ds_read_b64_tr_b16 a[142:143], v226 offset:52224
    ds_read_b64_tr_b16 a[144:145], v235 offset:49152
    v_mfma_f32_16x16x32_bf16 v[48:51], a[164:167], a[84:87], v[48:51]
    ds_read_b128 a[36:39], v153 offset:0
    ds_read_b64_tr_b16 a[146:147], v235 offset:50176
    v_mfma_f32_16x16x32_bf16 v[48:51], a[160:163], a[80:83], v[48:51]
    s_waitcnt lgkmcnt(10)
    ds_read_b128 a[40:43], v154 offset:0
    ds_read_b64_tr_b16 a[148:149], v235 offset:51200
    v_mfma_f32_16x16x32_bf16 v[20:23], a[128:131], a[16:19], v[20:23]
    s_waitcnt lgkmcnt(9)
    ds_read_b128 a[44:47], v155 offset:0
    ds_read_b64_tr_b16 a[150:151], v235 offset:52224
    v_mfma_f32_16x16x32_bf16 v[20:23], a[132:135], a[20:23], v[20:23]
    s_waitcnt vmcnt(17) lgkmcnt(9)
    ds_read_b128 a[96:99], v156 offset:0
    ds_read_b64_tr_b16 a[152:153], v227 offset:49152
    v_mfma_f32_16x16x32_bf16 v[20:23], a[136:139], a[24:27], v[20:23]
    s_waitcnt lgkmcnt(9)
    ds_read_b128 a[100:103], v157 offset:0
    ds_read_b64_tr_b16 a[154:155], v227 offset:50176
    v_mfma_f32_16x16x32_bf16 v[20:23], a[140:143], a[28:31], v[20:23]
    ds_read_b128 a[104:107], v158 offset:0
    ds_read_b64_tr_b16 a[156:157], v227 offset:51200
    v_mfma_f32_16x16x32_bf16 v[52:55], a[140:143], a[92:95], v[52:55]
    ds_read_b64_tr_b16 a[158:159], v227 offset:52224
    ds_read_b64_tr_b16 a[160:161], v236 offset:49152
    v_mfma_f32_16x16x32_bf16 v[52:55], a[136:139], a[88:91], v[52:55]
    ds_read_b128 a[108:111], v159 offset:0
    ds_read_b64_tr_b16 a[162:163], v236 offset:50176
    v_mfma_f32_16x16x32_bf16 v[52:55], a[132:135], a[84:87], v[52:55]
    ds_read_b64_tr_b16 a[164:165], v236 offset:51200
    ds_read_b64_tr_b16 a[166:167], v236 offset:52224
    v_mfma_f32_16x16x32_bf16 v[52:55], a[128:131], a[80:83], v[52:55]
    s_waitcnt lgkmcnt(13)
    buffer_load_dwordx4 v246, s[20:23], s43 offen offset:0  lds
    v_mfma_f32_16x16x32_bf16 v[24:27], a[144:147], a[16:19], v[24:27]
    s_waitcnt lgkmcnt(12)
    ds_read_b64_tr_b16 a[168:169], v228 offset:49152
    ds_read_b64_tr_b16 a[170:171], v228 offset:50176
    v_mfma_f32_16x16x32_bf16 v[24:27], a[148:151], a[20:23], v[24:27]
    s_waitcnt lgkmcnt(10)
    ds_read_b64_tr_b16 a[172:173], v228 offset:51200
    v_mfma_f32_16x16x32_bf16 v[24:27], a[152:155], a[24:27], v[24:27]
    s_waitcnt lgkmcnt(8)
    s_add_u32 s43, s59, 31744
    ds_read_b64_tr_b16 a[174:175], v228 offset:52224
    v_mfma_f32_16x16x32_bf16 v[24:27], a[156:159], a[28:31], v[24:27]
    buffer_load_dwordx4 v246, s[20:23], s43 offen offset:1024  lds
    v_mfma_f32_16x16x32_bf16 v[56:59], a[156:159], a[92:95], v[56:59]
    s_add_u32 s43, s59, 63488
    ds_read_b64_tr_b16 a[128:129], v237 offset:49152
    ds_read_b64_tr_b16 a[130:131], v237 offset:50176
    v_mfma_f32_16x16x32_bf16 v[56:59], a[152:155], a[88:91], v[56:59]
    buffer_load_dwordx4 v246, s[20:23], s43 offen offset:2048  lds
    v_mfma_f32_16x16x32_bf16 v[56:59], a[148:151], a[84:87], v[56:59]
    s_add_u32 s43, s59, 95232
    ds_read_b64_tr_b16 a[132:133], v237 offset:51200
    ds_read_b64_tr_b16 a[134:135], v237 offset:52224
    v_mfma_f32_16x16x32_bf16 v[56:59], a[144:147], a[80:83], v[56:59]
    s_waitcnt lgkmcnt(10)
    buffer_load_dwordx4 v246, s[20:23], s43 offen offset:3072  lds
    v_mfma_f32_16x16x32_bf16 v[28:31], a[160:163], a[16:19], v[28:31]
    s_waitcnt lgkmcnt(8)
    ds_read_b64_tr_b16 a[136:137], v229 offset:49152
    ds_read_b64_tr_b16 a[138:139], v229 offset:50176
    v_mfma_f32_16x16x32_bf16 v[28:31], a[164:167], a[20:23], v[28:31]
    s_waitcnt lgkmcnt(8)
    ds_read_b64_tr_b16 a[140:141], v229 offset:51200
    ds_read_b64_tr_b16 a[142:143], v229 offset:52224
    v_mfma_f32_16x16x32_bf16 v[28:31], a[168:171], a[24:27], v[28:31]
    s_waitcnt lgkmcnt(8)
    s_add_u32 m0, s39, 65536
    s_add_u32 s43, s59, 524288
    v_mfma_f32_16x16x32_bf16 v[28:31], a[172:175], a[28:31], v[28:31]
    buffer_load_dwordx4 v246, s[20:23], s43 offen offset:0  lds
    v_mfma_f32_16x16x32_bf16 v[60:63], a[172:175], a[92:95], v[60:63]
    s_add_u32 s43, s59, 556032
    v_mfma_f32_16x16x32_bf16 v[60:63], a[168:171], a[88:91], v[60:63]
    buffer_load_dwordx4 v246, s[20:23], s43 offen offset:1024  lds
    v_mfma_f32_16x16x32_bf16 v[60:63], a[164:167], a[84:87], v[60:63]
    s_add_u32 s43, s59, 587776
    v_mfma_f32_16x16x32_bf16 v[60:63], a[160:163], a[80:83], v[60:63]
    s_waitcnt vmcnt(15) lgkmcnt(0)
    s_barrier
    ds_read_b64_tr_b16 a[144:145], v230 offset:32768
    ds_read_b64_tr_b16 a[146:147], v230 offset:33792
    v_mfma_f32_16x16x32_bf16 v[32:35], a[128:131], a[16:19], v[32:35]
    buffer_load_dwordx4 v246, s[20:23], s43 offen offset:2048  lds
    ds_read_b64_tr_b16 a[148:149], v230 offset:34816
    v_mfma_f32_16x16x32_bf16 v[32:35], a[132:135], a[20:23], v[32:35]
    ds_read_b64_tr_b16 a[150:151], v230 offset:35840
    ds_read_b64_tr_b16 a[152:153], v222 offset:32768
    v_mfma_f32_16x16x32_bf16 v[32:35], a[136:139], a[24:27], v[32:35]
    ds_read_b64_tr_b16 a[154:155], v222 offset:33792
    ds_read_b64_tr_b16 a[156:157], v222 offset:34816
    v_mfma_f32_16x16x32_bf16 v[32:35], a[140:143], a[28:31], v[32:35]
    s_add_u32 s43, s59, 619520
    ds_read_b64_tr_b16 a[158:159], v222 offset:35840
    v_mfma_f32_16x16x32_bf16 v[64:67], a[140:143], a[92:95], v[64:67]
    buffer_load_dwordx4 v246, s[20:23], s43 offen offset:3072  lds
    v_mfma_f32_16x16x32_bf16 v[64:67], a[136:139], a[88:91], v[64:67]
    s_add_u32 m0, s39, 49152
    ds_read_b128 a[224:227], v238 offset:8192
    v_mfma_f32_16x16x32_bf16 v[64:67], a[132:135], a[84:87], v[64:67]
    s_add_u32 s43, s40, 0
    ds_read_b128 a[228:231], v239 offset:8192
    v_mfma_f32_16x16x32_bf16 v[64:67], a[128:131], a[80:83], v[64:67]
    s_waitcnt lgkmcnt(8)
    ds_read_b128 a[232:235], v240 offset:8192
    v_mfma_f32_16x16x32_bf16 v[4:7], a[144:147], a[32:35], v[4:7]
    s_waitcnt lgkmcnt(7)
    buffer_load_dwordx4 v244, s[12:15], s43 offen offset:0 nt lds
    v_mfma_f32_16x16x32_bf16 v[4:7], a[148:151], a[36:39], v[4:7]
    s_waitcnt lgkmcnt(5)
    ds_read_b128 a[236:239], v241 offset:8192
    ds_read_b64_tr_b16 a[160:161], v231 offset:32768
    v_mfma_f32_16x16x32_bf16 v[4:7], a[152:155], a[40:43], v[4:7]
    s_waitcnt lgkmcnt(5)
    ds_read_b64_tr_b16 a[162:163], v231 offset:33792
    ds_read_b64_tr_b16 a[164:165], v231 offset:34816
    v_mfma_f32_16x16x32_bf16 v[4:7], a[156:159], a[44:47], v[4:7]
    ds_read_b64_tr_b16 a[166:167], v231 offset:35840
    v_mfma_f32_16x16x32_bf16 v[36:39], a[156:159], a[108:111], v[36:39]
    buffer_load_dwordx4 v244, s[12:15], s43 offen offset:1024 nt lds
    v_mfma_f32_16x16x32_bf16 v[36:39], a[152:155], a[104:107], v[36:39]
    ds_read_b64_tr_b16 a[168:169], v223 offset:32768
    ds_read_b64_tr_b16 a[170:171], v223 offset:33792
    v_mfma_f32_16x16x32_bf16 v[36:39], a[148:151], a[100:103], v[36:39]
    ds_read_b64_tr_b16 a[172:173], v223 offset:34816
    ds_read_b64_tr_b16 a[174:175], v223 offset:35840
    v_mfma_f32_16x16x32_bf16 v[36:39], a[144:147], a[96:99], v[36:39]
    s_waitcnt lgkmcnt(11)
    v_mfma_f32_16x16x32_bf16 v[68:71], a[144:147], a[224:227], v[68:71]
    s_waitcnt lgkmcnt(10)
    v_mfma_f32_16x16x32_bf16 v[68:71], a[148:151], a[228:231], v[68:71]
    s_waitcnt lgkmcnt(9)
    buffer_load_dwordx4 v244, s[12:15], s43 offen offset:2048 nt lds
    v_mfma_f32_16x16x32_bf16 v[68:71], a[152:155], a[232:235], v[68:71]
    s_waitcnt lgkmcnt(8)
    ds_read_b64_tr_b16 a[128:129], v232 offset:32768
    v_mfma_f32_16x16x32_bf16 v[68:71], a[156:159], a[236:239], v[68:71]
    s_waitcnt lgkmcnt(7)
    ds_read_b64_tr_b16 a[130:131], v232 offset:33792
    v_mfma_f32_16x16x32_bf16 v[8:11], a[160:163], a[32:35], v[8:11]
    s_waitcnt lgkmcnt(6)
    ds_read_b64_tr_b16 a[132:133], v232 offset:34816
    v_mfma_f32_16x16x32_bf16 v[8:11], a[164:167], a[36:39], v[8:11]
    s_waitcnt lgkmcnt(5)
    ds_read_b64_tr_b16 a[134:135], v232 offset:35840
    v_mfma_f32_16x16x32_bf16 v[8:11], a[168:171], a[40:43], v[8:11]
    s_waitcnt lgkmcnt(4)
    ds_read_b64_tr_b16 a[136:137], v224 offset:32768
    v_mfma_f32_16x16x32_bf16 v[8:11], a[172:175], a[44:47], v[8:11]
    s_add_u32 m0, s39, 16384
    ds_read_b64_tr_b16 a[138:139], v224 offset:33792
    v_mfma_f32_16x16x32_bf16 v[40:43], a[172:175], a[108:111], v[40:43]
    s_add_u32 s43, s56, 256
    ds_read_b64_tr_b16 a[140:141], v224 offset:34816
    v_mfma_f32_16x16x32_bf16 v[40:43], a[168:171], a[104:107], v[40:43]
    ds_read_b64_tr_b16 a[142:143], v224 offset:35840
    v_mfma_f32_16x16x32_bf16 v[40:43], a[164:167], a[100:103], v[40:43]
    s_waitcnt vmcnt(16)
    ds_read_b128 a[48:51], v152 offset:16384
    v_mfma_f32_16x16x32_bf16 v[40:43], a[160:163], a[96:99], v[40:43]
    ds_read_b128 a[52:55], v153 offset:16384
    v_mfma_f32_16x16x32_bf16 v[72:75], a[160:163], a[224:227], v[72:75]
    ds_read_b128 a[56:59], v154 offset:16384
    v_mfma_f32_16x16x32_bf16 v[72:75], a[164:167], a[228:231], v[72:75]
    ds_read_b128 a[60:63], v155 offset:16384
    ds_read_b64_tr_b16 a[144:145], v233 offset:32768
    v_mfma_f32_16x16x32_bf16 v[72:75], a[168:171], a[232:235], v[72:75]
    s_waitcnt vmcnt(12)
    ds_read_b128 a[112:115], v156 offset:16384
    ds_read_b64_tr_b16 a[146:147], v233 offset:33792
    v_mfma_f32_16x16x32_bf16 v[72:75], a[172:175], a[236:239], v[72:75]
    s_waitcnt lgkmcnt(13)
    ds_read_b128 a[116:119], v157 offset:16384
    ds_read_b64_tr_b16 a[148:149], v233 offset:34816
    v_mfma_f32_16x16x32_bf16 v[12:15], a[128:131], a[32:35], v[12:15]
    s_waitcnt lgkmcnt(13)
    ds_read_b128 a[120:123], v158 offset:16384
    ds_read_b64_tr_b16 a[150:151], v233 offset:35840
    v_mfma_f32_16x16x32_bf16 v[12:15], a[132:135], a[36:39], v[12:15]
    s_waitcnt lgkmcnt(13)
    ds_read_b128 a[124:127], v159 offset:16384
    ds_read_b64_tr_b16 a[152:153], v225 offset:32768
    v_mfma_f32_16x16x32_bf16 v[12:15], a[136:139], a[40:43], v[12:15]
    s_waitcnt lgkmcnt(13)
    ds_read_b64_tr_b16 a[154:155], v225 offset:33792
    ds_read_b64_tr_b16 a[156:157], v225 offset:34816
    v_mfma_f32_16x16x32_bf16 v[12:15], a[140:143], a[44:47], v[12:15]
    ds_read_b64_tr_b16 a[158:159], v225 offset:35840
    v_mfma_f32_16x16x32_bf16 v[44:47], a[140:143], a[108:111], v[44:47]
    ds_read_b64_tr_b16 a[160:161], v234 offset:32768
    v_mfma_f32_16x16x32_bf16 v[44:47], a[136:139], a[104:107], v[44:47]
    ds_read_b64_tr_b16 a[162:163], v234 offset:33792
    v_mfma_f32_16x16x32_bf16 v[44:47], a[132:135], a[100:103], v[44:47]
    ds_read_b64_tr_b16 a[164:165], v234 offset:34816
    v_mfma_f32_16x16x32_bf16 v[44:47], a[128:131], a[96:99], v[44:47]
    s_waitcnt lgkmcnt(12)
    ds_read_b64_tr_b16 a[166:167], v234 offset:35840
    v_mfma_f32_16x16x32_bf16 v[16:19], a[144:147], a[32:35], v[16:19]
L_pad1:
    s_cbranch_execz L_back0
    s_waitcnt lgkmcnt(9)
    ds_read_b64_tr_b16 a[168:169], v226 offset:32768
    v_mfma_f32_16x16x32_bf16 v[16:19], a[148:151], a[36:39], v[16:19]
    s_waitcnt lgkmcnt(7)
    ds_read_b64_tr_b16 a[170:171], v226 offset:33792
    v_mfma_f32_16x16x32_bf16 v[16:19], a[152:155], a[40:43], v[16:19]
    s_waitcnt lgkmcnt(6)
    ds_read_b64_tr_b16 a[172:173], v226 offset:34816
    ds_read_b64_tr_b16 a[174:175], v226 offset:35840
    v_mfma_f32_16x16x32_bf16 v[16:19], a[156:159], a[44:47], v[16:19]
    ds_read_b64_tr_b16 a[128:129], v235 offset:32768
    v_mfma_f32_16x16x32_bf16 v[48:51], a[156:159], a[108:111], v[48:51]
    ds_read_b64_tr_b16 a[130:131], v235 offset:33792
    v_mfma_f32_16x16x32_bf16 v[48:51], a[152:155], a[104:107], v[48:51]
    buffer_load_dwordx4 v246, s[20:23], s43 offen offset:0  lds
    v_mfma_f32_16x16x32_bf16 v[48:51], a[148:151], a[100:103], v[48:51]
    s_add_u32 s43, s56, 32000
    ds_read_b64_tr_b16 a[132:133], v235 offset:34816
    v_mfma_f32_16x16x32_bf16 v[48:51], a[144:147], a[96:99], v[48:51]
    s_waitcnt lgkmcnt(9)
    ds_read_b64_tr_b16 a[134:135], v235 offset:35840
    v_mfma_f32_16x16x32_bf16 v[20:23], a[160:163], a[32:35], v[20:23]
    s_waitcnt lgkmcnt(8)
    ds_read_b64_tr_b16 a[136:137], v227 offset:32768
    v_mfma_f32_16x16x32_bf16 v[20:23], a[164:167], a[36:39], v[20:23]
    s_waitcnt lgkmcnt(7)
    buffer_load_dwordx4 v246, s[20:23], s43 offen offset:1024  lds
    v_mfma_f32_16x16x32_bf16 v[20:23], a[168:171], a[40:43], v[20:23]
    s_waitcnt lgkmcnt(5)
    ds_read_b64_tr_b16 a[138:139], v227 offset:33792
    ds_read_b64_tr_b16 a[140:141], v227 offset:34816
    v_mfma_f32_16x16x32_bf16 v[20:23], a[172:175], a[44:47], v[20:23]
    s_add_u32 s43, s56, 63744
    ds_read_b64_tr_b16 a[142:143], v227 offset:35840
    v_mfma_f32_16x16x32_bf16 v[52:55], a[172:175], a[108:111], v[52:55]
    ds_read_b64_tr_b16 a[144:145], v236 offset:32768
    v_mfma_f32_16x16x32_bf16 v[52:55], a[168:171], a[104:107], v[52:55]
    buffer_load_dwordx4 v246, s[20:23], s43 offen offset:2048  lds
    v_mfma_f32_16x16x32_bf16 v[52:55], a[164:167], a[100:103], v[52:55]
    s_add_u32 m0, s39, 52224
    ds_read_b64_tr_b16 a[146:147], v236 offset:33792
    ds_read_b64_tr_b16 a[148:149], v236 offset:34816
    v_mfma_f32_16x16x32_bf16 v[52:55], a[160:163], a[96:99], v[52:55]
    s_waitcnt lgkmcnt(9)
    ds_read_b64_tr_b16 a[150:151], v236 offset:35840
    ds_read_b64_tr_b16 a[152:153], v228 offset:32768
    v_mfma_f32_16x16x32_bf16 v[24:27], a[128:131], a[32:35], v[24:27]
    s_waitcnt lgkmcnt(9)
    s_add_u32 s43, s40, 3072
    ds_read_b64_tr_b16 a[154:155], v228 offset:33792
    v_mfma_f32_16x16x32_bf16 v[24:27], a[132:135], a[36:39], v[24:27]
    s_waitcnt lgkmcnt(8)
    buffer_load_dwordx4 v244, s[12:15], s43 offen offset:0 nt lds
    v_mfma_f32_16x16x32_bf16 v[24:27], a[136:139], a[40:43], v[24:27]
    s_waitcnt lgkmcnt(6)
    ds_read_b64_tr_b16 a[156:157], v228 offset:34816
    ds_read_b64_tr_b16 a[158:159], v228 offset:35840
    v_mfma_f32_16x16x32_bf16 v[24:27], a[140:143], a[44:47], v[24:27]
    s_add_u32 m0, s39, 19456
    ds_read_b64_tr_b16 a[160:161], v237 offset:32768
    ds_read_b64_tr_b16 a[162:163], v237 offset:33792
    v_mfma_f32_16x16x32_bf16 v[56:59], a[140:143], a[108:111], v[56:59]
    s_add_u32 s43, s56, 98560
    ds_read_b64_tr_b16 a[164:165], v237 offset:34816
    v_mfma_f32_16x16x32_bf16 v[56:59], a[136:139], a[104:107], v[56:59]
    buffer_load_dwordx4 v246, s[20:23], s43 offen offset:0  lds
    v_mfma_f32_16x16x32_bf16 v[56:59], a[132:135], a[100:103], v[56:59]
    s_add_u32 m0, s39, 81920
    ds_read_b64_tr_b16 a[166:167], v237 offset:35840
    ds_read_b64_tr_b16 a[168:169], v229 offset:32768
    v_mfma_f32_16x16x32_bf16 v[56:59], a[128:131], a[96:99], v[56:59]
    s_waitcnt lgkmcnt(11)
    ds_read_b64_tr_b16 a[170:171], v229 offset:33792
    ds_read_b64_tr_b16 a[172:173], v229 offset:34816
    v_mfma_f32_16x16x32_bf16 v[28:31], a[144:147], a[32:35], v[28:31]
    s_waitcnt lgkmcnt(11)
    s_add_u32 s43, s56, 524544
    ds_read_b64_tr_b16 a[174:175], v229 offset:35840
    v_mfma_f32_16x16x32_bf16 v[28:31], a[148:151], a[36:39], v[28:31]
    s_waitcnt lgkmcnt(10)
    buffer_load_dwordx4 v246, s[20:23], s43 offen offset:0  lds
    v_mfma_f32_16x16x32_bf16 v[28:31], a[152:155], a[40:43], v[28:31]
    s_waitcnt lgkmcnt(8)
    v_mfma_f32_16x16x32_bf16 v[28:31], a[156:159], a[44:47], v[28:31]
    s_add_u32 s43, s56, 556288
    v_mfma_f32_16x16x32_bf16 v[60:63], a[156:159], a[108:111], v[60:63]
    buffer_load_dwordx4 v246, s[20:23], s43 offen offset:1024  lds
    v_mfma_f32_16x16x32_bf16 v[60:63], a[152:155], a[104:107], v[60:63]
    s_add_u32 m0, s39, 114688
    v_mfma_f32_16x16x32_bf16 v[60:63], a[148:151], a[100:103], v[60:63]
    s_add_u32 s43, s40, 0
    v_mfma_f32_16x16x32_bf16 v[60:63], a[144:147], a[96:99], v[60:63]
    s_waitcnt vmcnt(10) lgkmcnt(0)
    s_barrier
    ds_read_b64_tr_b16 a[128:129], v230 offset:0
    ds_read_b64_tr_b16 a[130:131], v230 offset:1024
    v_mfma_f32_16x16x32_bf16 v[32:35], a[160:163], a[32:35], v[32:35]
    buffer_load_dwordx4 v245, s[16:19], s43 offen offset:0 nt lds
    ds_read_b64_tr_b16 a[132:133], v230 offset:2048
    v_mfma_f32_16x16x32_bf16 v[32:35], a[164:167], a[36:39], v[32:35]
    ds_read_b64_tr_b16 a[134:135], v230 offset:3072
    ds_read_b64_tr_b16 a[136:137], v222 offset:0
    v_mfma_f32_16x16x32_bf16 v[32:35], a[168:171], a[40:43], v[32:35]
    ds_read_b64_tr_b16 a[138:139], v222 offset:1024
    ds_read_b64_tr_b16 a[140:141], v222 offset:2048
    v_mfma_f32_16x16x32_bf16 v[32:35], a[172:175], a[44:47], v[32:35]
    s_add_u32 m0, s39, 83968
    s_add_u32 s43, s56, 590080
    ds_read_b64_tr_b16 a[142:143], v222 offset:3072
    v_mfma_f32_16x16x32_bf16 v[64:67], a[172:175], a[108:111], v[64:67]
    buffer_load_dwordx4 v246, s[20:23], s43 offen offset:0  lds
    v_mfma_f32_16x16x32_bf16 v[64:67], a[168:171], a[104:107], v[64:67]
    s_add_u32 s43, s56, 621824
    ds_read_b128 a[224:227], v238 offset:12288
    v_mfma_f32_16x16x32_bf16 v[64:67], a[164:167], a[100:103], v[64:67]
    ds_read_b128 a[228:231], v239 offset:12288
    v_mfma_f32_16x16x32_bf16 v[64:67], a[160:163], a[96:99], v[64:67]
    s_waitcnt lgkmcnt(8)
    ds_read_b128 a[232:235], v240 offset:12288
    v_mfma_f32_16x16x32_bf16 v[4:7], a[128:131], a[48:51], v[4:7]
    s_waitcnt lgkmcnt(7)
    buffer_load_dwordx4 v246, s[20:23], s43 offen offset:1024  lds
    v_mfma_f32_16x16x32_bf16 v[4:7], a[132:135], a[52:55], v[4:7]
    s_waitcnt lgkmcnt(5)
    ds_read_b128 a[236:239], v241 offset:12288
    ds_read_b64_tr_b16 a[144:145], v231 offset:0
    v_mfma_f32_16x16x32_bf16 v[4:7], a[136:139], a[56:59], v[4:7]
    s_waitcnt lgkmcnt(5)
    ds_read_b64_tr_b16 a[146:147], v231 offset:1024
    ds_read_b64_tr_b16 a[148:149], v231 offset:2048
    v_mfma_f32_16x16x32_bf16 v[4:7], a[140:143], a[60:63], v[4:7]
    s_add_u32 m0, s39, 115712
    s_add_u32 s43, s40, 1024
    v_mfma_f32_16x16x32_bf16 v[36:39], a[140:143], a[124:127], v[36:39]
    buffer_load_dwordx4 v245, s[16:19], s43 offen offset:0 nt lds
    v_mfma_f32_16x16x32_bf16 v[36:39], a[136:139], a[120:123], v[36:39]
    ds_read_b64_tr_b16 a[150:151], v231 offset:3072
    ds_read_b64_tr_b16 a[152:153], v223 offset:0
    v_mfma_f32_16x16x32_bf16 v[36:39], a[132:135], a[116:119], v[36:39]
    ds_read_b64_tr_b16 a[154:155], v223 offset:1024
    ds_read_b64_tr_b16 a[156:157], v223 offset:2048
    v_mfma_f32_16x16x32_bf16 v[36:39], a[128:131], a[112:115], v[36:39]
    s_waitcnt lgkmcnt(10)
    ds_read_b64_tr_b16 a[158:159], v223 offset:3072
    v_mul_f32 v4, s42, v4
    v_mul_f32 v5, s42, v5
    v_mfma_f32_16x16x32_bf16 v[68:71], a[128:131], a[224:227], v[68:71]
    s_waitcnt lgkmcnt(10)
    v_mul_f32 v6, s42, v6
    v_mul_f32 v7, s42, v7
    v_mfma_f32_16x16x32_bf16 v[68:71], a[132:135], a[228:231], v[68:71]
    s_waitcnt lgkmcnt(9)
    v_cvt_pk_bf16_f32 v4, v4, v5
    v_cvt_pk_bf16_f32 v5, v6, v7
    v_mfma_f32_16x16x32_bf16 v[68:71], a[136:139], a[232:235], v[68:71]
    s_waitcnt lgkmcnt(8)
    ds_read_b64_tr_b16 a[160:161], v232 offset:0
    v_mfma_f32_16x16x32_bf16 v[68:71], a[140:143], a[236:239], v[68:71]
    s_waitcnt lgkmcnt(7)
    ds_read_b64_tr_b16 a[162:163], v232 offset:1024
    v_mul_f32 v36, s42, v36
    v_mfma_f32_16x16x32_bf16 v[8:11], a[144:147], a[48:51], v[8:11]
    s_waitcnt lgkmcnt(6)
    ds_read_b64_tr_b16 a[164:165], v232 offset:2048
    v_mul_f32 v37, s42, v37
    v_mfma_f32_16x16x32_bf16 v[8:11], a[148:151], a[52:55], v[8:11]
    s_waitcnt lgkmcnt(5)
    ds_read_b64_tr_b16 a[166:167], v232 offset:3072
    v_mul_f32 v38, s42, v38
    v_mul_f32 v39, s42, v39
    v_mfma_f32_16x16x32_bf16 v[8:11], a[152:155], a[56:59], v[8:11]
    s_waitcnt lgkmcnt(4)
    buffer_load_dwordx4 v245, s[16:19], s43 offen offset:1024 nt lds
    v_mfma_f32_16x16x32_bf16 v[8:11], a[156:159], a[60:63], v[8:11]
    ds_read_b64_tr_b16 a[168:169], v224 offset:0
    v_mul_f32 v68, s42, v68
    v_mul_f32 v69, s42, v69
    v_mul_f32 v70, s42, v70
    v_mfma_f32_16x16x32_bf16 v[40:43], a[156:159], a[124:127], v[40:43]
    ds_read_b64_tr_b16 a[170:171], v224 offset:1024
    v_mul_f32 v71, s42, v71
    v_cvt_pk_bf16_f32 v68, v68, v69
    v_cvt_pk_bf16_f32 v69, v70, v71
    v_mfma_f32_16x16x32_bf16 v[40:43], a[152:155], a[120:123], v[40:43]
    ds_read_b64_tr_b16 a[172:173], v224 offset:2048
    v_cvt_pk_bf16_f32 v36, v36, v37
    v_cvt_pk_bf16_f32 v37, v38, v39
    v_mfma_f32_16x16x32_bf16 v[40:43], a[148:151], a[116:119], v[40:43]
    ds_read_b64_tr_b16 a[174:175], v224 offset:3072
    v_mfma_f32_16x16x32_bf16 v[40:43], a[144:147], a[112:115], v[40:43]
    ds_read_b64_tr_b16 a[128:129], v233 offset:0
    v_mul_f32 v8, s42, v8
    v_mul_f32 v9, s42, v9
    v_mul_f32 v10, s42, v10
    v_mfma_f32_16x16x32_bf16 v[72:75], a[144:147], a[224:227], v[72:75]
    ds_read_b64_tr_b16 a[130:131], v233 offset:1024
    v_mul_f32 v11, s42, v11
    v_cvt_pk_bf16_f32 v6, v8, v9
    v_cvt_pk_bf16_f32 v7, v10, v11
    v_mfma_f32_16x16x32_bf16 v[72:75], a[148:151], a[228:231], v[72:75]
    ds_read_b64_tr_b16 a[132:133], v233 offset:2048
    v_permlane16_swap_b32 v4, v6
    v_mfma_f32_16x16x32_bf16 v[72:75], a[152:155], a[232:235], v[72:75]
    ds_read_b64_tr_b16 a[134:135], v233 offset:3072
    v_permlane16_swap_b32 v5, v7
    v_mfma_f32_16x16x32_bf16 v[72:75], a[156:159], a[236:239], v[72:75]
    s_waitcnt lgkmcnt(10)
    ds_read_b64_tr_b16 a[136:137], v225 offset:0
    v_mul_f32 v40, s42, v40
    v_mul_f32 v41, s42, v41
    v_mul_f32 v42, s42, v42
    v_mfma_f32_16x16x32_bf16 v[12:15], a[160:163], a[48:51], v[12:15]
    s_waitcnt lgkmcnt(9)
    ds_read_b64_tr_b16 a[138:139], v225 offset:1024
    v_mul_f32 v43, s42, v43
    v_cvt_pk_bf16_f32 v38, v40, v41
    v_cvt_pk_bf16_f32 v39, v42, v43
    v_mfma_f32_16x16x32_bf16 v[12:15], a[164:167], a[52:55], v[12:15]
    s_waitcnt lgkmcnt(8)
    ds_read_b64_tr_b16 a[140:141], v225 offset:2048
    v_accvgpr_write_b32 a176, v4
    v_mfma_f32_16x16x32_bf16 v[12:15], a[168:171], a[56:59], v[12:15]
    s_waitcnt lgkmcnt(7)
    ds_read_b64_tr_b16 a[142:143], v225 offset:3072
    v_accvgpr_write_b32 a177, v5
    v_mfma_f32_16x16x32_bf16 v[12:15], a[172:175], a[60:63], v[12:15]
    buffer_load_dwordx4 v245, s[16:19], s43 offen offset:2048 nt lds
    v_mul_f32 v72, s42, v72
    v_mul_f32 v73, s42, v73
    v_mfma_f32_16x16x32_bf16 v[44:47], a[172:175], a[124:127], v[44:47]
    s_add_u32 m0, s39, 32768
    v_mul_f32 v74, s42, v74
    ds_read_b64_tr_b16 a[144:145], v234 offset:0
    v_mul_f32 v75, s42, v75
    v_cvt_pk_bf16_f32 v70, v72, v73
    v_mfma_f32_16x16x32_bf16 v[44:47], a[168:171], a[120:123], v[44:47]
    s_add_u32 s43, s40, 16384
    ds_read_b64_tr_b16 a[146:147], v234 offset:1024
    v_cvt_pk_bf16_f32 v71, v74, v75
    v_permlane16_swap_b32 v68, v70
    v_mfma_f32_16x16x32_bf16 v[44:47], a[164:167], a[116:119], v[44:47]
    ds_read_b64_tr_b16 a[148:149], v234 offset:2048
    v_permlane16_swap_b32 v69, v71
    v_mfma_f32_16x16x32_bf16 v[44:47], a[160:163], a[112:115], v[44:47]
    s_waitcnt lgkmcnt(9)
    ds_read_b64_tr_b16 a[150:151], v234 offset:3072
    v_mul_f32 v12, s42, v12
    v_mul_f32 v13, s42, v13
    v_mul_f32 v14, s42, v14
    v_mfma_f32_16x16x32_bf16 v[16:19], a[128:131], a[48:51], v[16:19]
    s_waitcnt lgkmcnt(8)
    ds_read_b64_tr_b16 a[152:153], v226 offset:0
    v_mul_f32 v15, s42, v15
    v_cvt_pk_bf16_f32 v12, v12, v13
    v_cvt_pk_bf16_f32 v13, v14, v15
    v_mfma_f32_16x16x32_bf16 v[16:19], a[132:135], a[52:55], v[16:19]
    s_waitcnt lgkmcnt(7)
    ds_read_b64_tr_b16 a[154:155], v226 offset:1024
    v_accvgpr_write_b32 a178, v6
    v_mfma_f32_16x16x32_bf16 v[16:19], a[136:139], a[56:59], v[16:19]
    s_waitcnt lgkmcnt(6)
    ds_read_b64_tr_b16 a[156:157], v226 offset:2048
    v_accvgpr_write_b32 a179, v7
    v_mfma_f32_16x16x32_bf16 v[16:19], a[140:143], a[60:63], v[16:19]
    ds_read_b64_tr_b16 a[158:159], v226 offset:3072
    v_mul_f32 v44, s42, v44
    v_mul_f32 v45, s42, v45
    v_mul_f32 v46, s42, v46
    v_mfma_f32_16x16x32_bf16 v[48:51], a[140:143], a[124:127], v[48:51]
    ds_read_b64_tr_b16 a[160:161], v235 offset:0
    v_mul_f32 v47, s42, v47
    v_cvt_pk_bf16_f32 v44, v44, v45
    v_cvt_pk_bf16_f32 v45, v46, v47
    v_mfma_f32_16x16x32_bf16 v[48:51], a[136:139], a[120:123], v[48:51]
    ds_read_b64_tr_b16 a[162:163], v235 offset:1024
    v_permlane16_swap_b32 v36, v38
    v_mfma_f32_16x16x32_bf16 v[48:51], a[132:135], a[116:119], v[48:51]
    ds_read_b64_tr_b16 a[164:165], v235 offset:2048
    v_permlane16_swap_b32 v37, v39
    v_mfma_f32_16x16x32_bf16 v[48:51], a[128:131], a[112:115], v[48:51]
    s_waitcnt lgkmcnt(9)
    buffer_load_dwordx4 v244, s[12:15], s43 offen offset:0 nt lds
    v_mul_f32 v16, s42, v16
    v_mul_f32 v17, s42, v17
    v_mfma_f32_16x16x32_bf16 v[20:23], a[144:147], a[48:51], v[20:23]
    s_waitcnt lgkmcnt(7)
    ds_read_b64_tr_b16 a[166:167], v235 offset:3072
    v_mul_f32 v18, s42, v18
    v_mul_f32 v19, s42, v19
    v_cvt_pk_bf16_f32 v14, v16, v17
    v_mfma_f32_16x16x32_bf16 v[20:23], a[148:151], a[52:55], v[20:23]
    s_waitcnt lgkmcnt(6)
    ds_read_b64_tr_b16 a[168:169], v227 offset:0
    v_cvt_pk_bf16_f32 v15, v18, v19
    v_mfma_f32_16x16x32_bf16 v[20:23], a[152:155], a[56:59], v[20:23]
    s_waitcnt lgkmcnt(5)
    ds_read_b64_tr_b16 a[170:171], v227 offset:1024
    v_accvgpr_write_b32 a192, v36
    v_mfma_f32_16x16x32_bf16 v[20:23], a[156:159], a[60:63], v[20:23]
    ds_read_b64_tr_b16 a[172:173], v227 offset:2048
    v_mul_f32 v48, s42, v48
    v_mul_f32 v49, s42, v49
    v_mul_f32 v50, s42, v50
    v_mfma_f32_16x16x32_bf16 v[52:55], a[156:159], a[124:127], v[52:55]
    ds_read_b64_tr_b16 a[174:175], v227 offset:3072
    v_mul_f32 v51, s42, v51
    v_cvt_pk_bf16_f32 v46, v48, v49
    v_cvt_pk_bf16_f32 v47, v50, v51
    v_mfma_f32_16x16x32_bf16 v[52:55], a[152:155], a[120:123], v[52:55]
    ds_read_b64_tr_b16 a[128:129], v236 offset:0
    v_accvgpr_write_b32 a193, v37
    v_mfma_f32_16x16x32_bf16 v[52:55], a[148:151], a[116:119], v[52:55]
    ds_read_b64_tr_b16 a[130:131], v236 offset:1024
    v_accvgpr_write_b32 a194, v38
    v_mfma_f32_16x16x32_bf16 v[52:55], a[144:147], a[112:115], v[52:55]
    s_waitcnt lgkmcnt(8)
    ds_read_b64_tr_b16 a[132:133], v236 offset:2048
    v_mul_f32 v20, s42, v20
    v_mul_f32 v21, s42, v21
    v_mul_f32 v22, s42, v22
    v_mfma_f32_16x16x32_bf16 v[24:27], a[160:163], a[48:51], v[24:27]
    s_waitcnt lgkmcnt(7)
    ds_read_b64_tr_b16 a[134:135], v236 offset:3072
    v_mul_f32 v23, s42, v23
    v_cvt_pk_bf16_f32 v20, v20, v21
    v_cvt_pk_bf16_f32 v21, v22, v23
    v_mfma_f32_16x16x32_bf16 v[24:27], a[164:167], a[52:55], v[24:27]
    s_waitcnt lgkmcnt(6)
    ds_read_b64_tr_b16 a[136:137], v228 offset:0
    v_accvgpr_write_b32 a195, v39
    v_mfma_f32_16x16x32_bf16 v[24:27], a[168:171], a[56:59], v[24:27]
    s_waitcnt lgkmcnt(5)
    ds_read_b64_tr_b16 a[138:139], v228 offset:1024
    v_permlane16_swap_b32 v12, v14
    v_mfma_f32_16x16x32_bf16 v[24:27], a[172:175], a[60:63], v[24:27]
    ds_read_b64_tr_b16 a[140:141], v228 offset:2048
    v_mul_f32 v52, s42, v52
    v_mul_f32 v53, s42, v53
    v_mul_f32 v54, s42, v54
    v_mfma_f32_16x16x32_bf16 v[56:59], a[172:175], a[124:127], v[56:59]
    buffer_load_dwordx4 v244, s[12:15], s43 offen offset:1024 nt lds
    v_mul_f32 v55, s42, v55
    v_cvt_pk_bf16_f32 v52, v52, v53
    v_mfma_f32_16x16x32_bf16 v[56:59], a[168:171], a[120:123], v[56:59]
    ds_read_b64_tr_b16 a[142:143], v228 offset:3072
    v_cvt_pk_bf16_f32 v53, v54, v55
    v_mfma_f32_16x16x32_bf16 v[56:59], a[164:167], a[116:119], v[56:59]
    ds_read_b64_tr_b16 a[144:145], v237 offset:0
    v_permlane16_swap_b32 v13, v15
    v_mfma_f32_16x16x32_bf16 v[56:59], a[160:163], a[112:115], v[56:59]
    s_waitcnt lgkmcnt(7)
    ds_read_b64_tr_b16 a[146:147], v237 offset:1024
    v_mul_f32 v24, s42, v24
    v_mul_f32 v25, s42, v25
    v_mul_f32 v26, s42, v26
    v_mfma_f32_16x16x32_bf16 v[28:31], a[128:131], a[48:51], v[28:31]
    s_waitcnt lgkmcnt(6)
    ds_read_b64_tr_b16 a[148:149], v237 offset:2048
    v_mul_f32 v27, s42, v27
    v_cvt_pk_bf16_f32 v22, v24, v25
    v_cvt_pk_bf16_f32 v23, v26, v27
    v_mfma_f32_16x16x32_bf16 v[28:31], a[132:135], a[52:55], v[28:31]
    s_waitcnt lgkmcnt(5)
    ds_read_b64_tr_b16 a[150:151], v237 offset:3072
    ds_read_b64_tr_b16 a[152:153], v229 offset:0
    v_mfma_f32_16x16x32_bf16 v[28:31], a[136:139], a[56:59], v[28:31]
    s_waitcnt lgkmcnt(5)
    ds_read_b64_tr_b16 a[154:155], v229 offset:1024
    v_accvgpr_write_b32 a180, v12
    v_mfma_f32_16x16x32_bf16 v[28:31], a[140:143], a[60:63], v[28:31]
    ds_read_b64_tr_b16 a[156:157], v229 offset:2048
    v_mul_f32 v56, s42, v56
    v_mul_f32 v57, s42, v57
    v_mul_f32 v58, s42, v58
    v_mfma_f32_16x16x32_bf16 v[60:63], a[140:143], a[124:127], v[60:63]
    ds_write_b128 v252, v[68:71] offset:20480
    v_mul_f32 v59, s42, v59
    v_cvt_pk_bf16_f32 v54, v56, v57
    v_cvt_pk_bf16_f32 v55, v58, v59
    v_mfma_f32_16x16x32_bf16 v[60:63], a[136:139], a[120:123], v[60:63]
    ds_read_b64_tr_b16 a[158:159], v229 offset:3072
    v_accvgpr_write_b32 a181, v13
    v_mfma_f32_16x16x32_bf16 v[60:63], a[132:135], a[116:119], v[60:63]
    v_accvgpr_write_b32 a182, v14
    v_accvgpr_write_b32 a183, v15
    v_mfma_f32_16x16x32_bf16 v[60:63], a[128:131], a[112:115], v[60:63]
    s_waitcnt vmcnt(10) lgkmcnt(0)
    s_barrier
    v_mul_f32 v28, s42, v28
    v_mul_f32 v29, s42, v29
    v_mfma_f32_16x16x32_bf16 v[32:35], a[144:147], a[48:51], v[32:35]
    buffer_load_dwordx4 v244, s[12:15], s43 offen offset:2048 nt lds
    v_mul_f32 v30, s42, v30
    v_mul_f32 v31, s42, v31
    v_mfma_f32_16x16x32_bf16 v[32:35], a[148:151], a[52:55], v[32:35]
    ds_read_b64_tr_b16 a[160:161], v230 offset:16384
    v_cvt_pk_bf16_f32 v28, v28, v29
    v_cvt_pk_bf16_f32 v29, v30, v31
    v_permlane16_swap_b32 v44, v46
    v_mfma_f32_16x16x32_bf16 v[32:35], a[152:155], a[56:59], v[32:35]
    ds_read_b64_tr_b16 a[162:163], v230 offset:17408
    v_permlane16_swap_b32 v45, v47
    v_accvgpr_write_b32 a196, v44
    v_accvgpr_write_b32 a197, v45
    v_mfma_f32_16x16x32_bf16 v[32:35], a[156:159], a[60:63], v[32:35]
    ds_read_b64_tr_b16 a[164:165], v230 offset:18432
    v_mul_f32 v60, s42, v60
    v_mul_f32 v61, s42, v61
    v_mul_f32 v62, s42, v62
    v_mfma_f32_16x16x32_bf16 v[64:67], a[156:159], a[124:127], v[64:67]
    ds_read_b64_tr_b16 a[166:167], v230 offset:19456
    v_mul_f32 v63, s42, v63
    v_cvt_pk_bf16_f32 v60, v60, v61
    v_cvt_pk_bf16_f32 v61, v62, v63
    v_mfma_f32_16x16x32_bf16 v[64:67], a[152:155], a[120:123], v[64:67]
    ds_read_b128 a[208:211], v252 offset:20480
    v_accvgpr_write_b32 a198, v46
    v_accvgpr_write_b32 a199, v47
    v_permlane16_swap_b32 v20, v22
    v_mfma_f32_16x16x32_bf16 v[64:67], a[148:151], a[116:119], v[64:67]
    ds_read_b128 a[212:215], v253 offset:20480
    v_permlane16_swap_b32 v21, v23
    v_accvgpr_write_b32 a184, v20
    v_accvgpr_write_b32 a185, v21
    v_mfma_f32_16x16x32_bf16 v[64:67], a[144:147], a[112:115], v[64:67]
    s_waitcnt lgkmcnt(4)
    ds_read_b128 a[216:219], v254 offset:20480
    v_mul_f32 v32, s42, v32
    v_mul_f32 v33, s42, v33
    v_mul_f32 v34, s42, v34
    v_mfma_f32_16x16x32_bf16 v[76:79], a[160:163], a[0:3], 0
    s_waitcnt lgkmcnt(3)
    ds_read_b128 a[220:223], v255 offset:20480
    v_mul_f32 v35, s42, v35
    v_cvt_pk_bf16_f32 v30, v32, v33
    v_cvt_pk_bf16_f32 v31, v34, v35
    v_mfma_f32_16x16x32_bf16 v[76:79], a[164:167], a[4:7], v[76:79]
    ds_read_b128 a[232:235], v238 offset:0
    v_accvgpr_write_b32 a186, v22
    v_accvgpr_write_b32 a187, v23
    v_permlane16_swap_b32 v52, v54
    v_mfma_f32_16x16x32_bf16 v[108:111], a[164:167], a[68:71], 0
    ds_read_b128 a[236:239], v239 offset:0
    v_permlane16_swap_b32 v53, v55
    v_accvgpr_write_b32 a200, v52
    v_accvgpr_write_b32 a201, v53
    v_mfma_f32_16x16x32_bf16 v[108:111], a[160:163], a[64:67], v[108:111]
    s_waitcnt lgkmcnt(1)
    ds_read_b128 a[168:171], v218 offset:49152
    v_mul_f32 v64, s42, v64
    v_mul_f32 v65, s42, v65
    v_mul_f32 v66, s42, v66
    v_mfma_f32_16x16x32_bf16 v[140:143], a[160:163], a[232:235], 0
    s_waitcnt lgkmcnt(1)
    buffer_load_dwordx4 v244, s[12:15], s43 offen offset:3072 nt lds
    v_mul_f32 v67, s42, v67
    v_cvt_pk_bf16_f32 v62, v64, v65
    v_mfma_f32_16x16x32_bf16 v[140:143], a[164:167], a[236:239], v[140:143]
    s_waitcnt lgkmcnt(0)
    v_accvgpr_write_b32 a202, v54
    v_accvgpr_write_b32 a203, v55
    v_permlane16_swap_b32 v28, v30
    v_permlane16_swap_b32 v29, v31
    v_accvgpr_write_b32 a188, v28
    v_accvgpr_write_b32 a189, v29
    v_accvgpr_write_b32 a190, v30
    v_accvgpr_write_b32 a191, v31
    v_cvt_pk_bf16_f32 v63, v66, v67
    v_permlane16_swap_b32 v60, v62
    s_nop 0
    v_permlane16_swap_b32 v61, v63
    v_accvgpr_write_b32 a204, v60
    v_accvgpr_write_b32 a205, v61
    v_accvgpr_write_b32 a206, v62
    v_accvgpr_write_b32 a207, v63
    s_cmp_eq_u32 s76, -1
    s_cbranch_scc1 L_max0
L_maxret0:
    ds_read_b128 a[172:175], v219 offset:49152
    ds_read_b128 a[128:131], v220 offset:49152
    v_mfma_f32_16x16x32_bf16 v[180:183], a[168:171], a[208:211], v[210:213]
    s_waitcnt lgkmcnt(1)
    ds_read_b128 a[132:135], v221 offset:49152
    ds_read_b128 a[136:139], v214 offset:49152
    ds_read_b128 a[140:143], v215 offset:49152
    v_mfma_f32_16x16x32_bf16 v[180:183], a[172:175], a[212:215], v[180:183]
    s_waitcnt lgkmcnt(3)
    ds_read_b128 a[144:147], v216 offset:49152
    ds_read_b128 a[148:151], v217 offset:49152
    v_mfma_f32_16x16x32_bf16 v[180:183], a[128:131], a[216:219], v[180:183]
    s_waitcnt lgkmcnt(4)
    ds_read_b64_tr_b16 a[152:153], v231 offset:16384
    v_mfma_f32_16x16x32_bf16 v[180:183], a[132:135], a[220:223], v[180:183]
    s_waitcnt lgkmcnt(4)
    ds_read_b64_tr_b16 a[154:155], v231 offset:17408
    v_mfma_f32_16x16x32_bf16 v[148:151], a[136:139], a[176:179], v[202:205]
    s_waitcnt lgkmcnt(4)
    ds_read_b64_tr_b16 a[156:157], v231 offset:18432
    ds_read_b64_tr_b16 a[158:159], v231 offset:19456
    v_mfma_f32_16x16x32_bf16 v[148:151], a[140:143], a[180:183], v[148:151]
    s_waitcnt lgkmcnt(5)
    v_mfma_f32_16x16x32_bf16 v[148:151], a[144:147], a[184:187], v[148:151]
    s_waitcnt lgkmcnt(4)
    v_mfma_f32_16x16x32_bf16 v[148:151], a[148:151], a[188:191], v[148:151]
    s_add_u32 m0, s39, 98304
    v_exp_f32 v180, v180
    v_mfma_f32_16x16x32_bf16 v[152:155], a[148:151], a[204:207], v[206:209]
    buffer_load_dwordx4 v245, s[16:19], s43 offen offset:0 nt lds
    v_mfma_f32_16x16x32_bf16 v[152:155], a[144:147], a[200:203], v[152:155]
    v_exp_f32 v181, v181
    v_mfma_f32_16x16x32_bf16 v[152:155], a[140:143], a[196:199], v[152:155]
    ds_read_b128 a[160:163], v214 offset:50176
    v_cvt_pk_bf16_f32 v200, v180, v181
    v_mfma_f32_16x16x32_bf16 v[152:155], a[136:139], a[192:195], v[152:155]
    s_waitcnt lgkmcnt(3)
    ds_read_b128 a[164:167], v215 offset:50176
    v_mfma_f32_16x16x32_bf16 v[80:83], a[152:155], a[0:3], 0
    s_waitcnt lgkmcnt(2)
    ds_read_b128 a[168:171], v216 offset:50176
    v_mfma_f32_16x16x32_bf16 v[80:83], a[156:159], a[4:7], v[80:83]
    v_exp_f32 v182, v182
    v_mfma_f32_16x16x32_bf16 v[112:115], a[156:159], a[68:71], 0
    ds_read_b128 a[172:175], v217 offset:50176
    v_mfma_f32_16x16x32_bf16 v[112:115], a[152:155], a[64:67], v[112:115]
    v_exp_f32 v183, v183
    v_mfma_f32_16x16x32_bf16 v[144:147], a[152:155], a[232:235], 0
    ds_read_b128 a[128:131], v214 offset:51200
    v_cvt_pk_bf16_f32 v201, v182, v183
    v_mfma_f32_16x16x32_bf16 v[144:147], a[156:159], a[236:239], v[144:147]
    s_waitcnt lgkmcnt(4)
    v_exp_f32 v148, v148
    v_mfma_f32_16x16x32_bf16 v[156:159], a[160:163], a[176:179], v[202:205]
    s_waitcnt lgkmcnt(3)
    v_exp_f32 v149, v149
    v_mfma_f32_16x16x32_bf16 v[156:159], a[164:167], a[180:183], v[156:159]
    s_waitcnt lgkmcnt(2)
    ds_read_b128 a[132:135], v215 offset:51200
    v_cvt_pk_bf16_f32 v184, v148, v149
    v_mfma_f32_16x16x32_bf16 v[156:159], a[168:171], a[184:187], v[156:159]
    s_waitcnt lgkmcnt(2)
    ds_read_b128 a[136:139], v216 offset:51200
    v_mfma_f32_16x16x32_bf16 v[156:159], a[172:175], a[188:191], v[156:159]
    v_exp_f32 v150, v150
    v_mfma_f32_16x16x32_bf16 v[160:163], a[172:175], a[204:207], v[206:209]
    ds_read_b128 a[140:143], v217 offset:51200
    v_mfma_f32_16x16x32_bf16 v[160:163], a[168:171], a[200:203], v[160:163]
    buffer_load_dwordx4 v245, s[16:19], s43 offen offset:1024 nt lds
    v_mfma_f32_16x16x32_bf16 v[160:163], a[164:167], a[196:199], v[160:163]
    v_exp_f32 v151, v151
    v_mfma_f32_16x16x32_bf16 v[160:163], a[160:163], a[192:195], v[160:163]
    s_waitcnt lgkmcnt(3)
    ds_read_b64_tr_b16 a[144:145], v232 offset:16384
    v_cvt_pk_bf16_f32 v185, v150, v151
    v_mfma_f32_16x16x32_bf16 v[164:167], a[128:131], a[176:179], v[202:205]
    s_waitcnt lgkmcnt(3)
    ds_read_b64_tr_b16 a[146:147], v232 offset:17408
    ds_read_b64_tr_b16 a[148:149], v232 offset:18432
    v_mfma_f32_16x16x32_bf16 v[164:167], a[132:135], a[180:183], v[164:167]
    s_waitcnt lgkmcnt(4)
    v_exp_f32 v156, v156
    v_mfma_f32_16x16x32_bf16 v[164:167], a[136:139], a[184:187], v[164:167]
    s_waitcnt lgkmcnt(3)
    ds_read_b64_tr_b16 a[150:151], v232 offset:19456
    v_mfma_f32_16x16x32_bf16 v[164:167], a[140:143], a[188:191], v[164:167]
    v_exp_f32 v157, v157
    v_mfma_f32_16x16x32_bf16 v[168:171], a[140:143], a[204:207], v[206:209]
    ds_read_b128 a[152:155], v214 offset:52224
    v_cvt_pk_bf16_f32 v186, v156, v157
    v_mfma_f32_16x16x32_bf16 v[168:171], a[136:139], a[200:203], v[168:171]
    ds_read_b128 a[156:159], v215 offset:52224
    v_mfma_f32_16x16x32_bf16 v[168:171], a[132:135], a[196:199], v[168:171]
    ds_read_b128 a[160:163], v216 offset:52224
    v_mfma_f32_16x16x32_bf16 v[168:171], a[128:131], a[192:195], v[168:171]
    s_waitcnt lgkmcnt(5)
    v_exp_f32 v158, v158
    v_mfma_f32_16x16x32_bf16 v[84:87], a[144:147], a[0:3], 0
    s_waitcnt lgkmcnt(3)
    ds_read_b128 a[164:167], v217 offset:52224
    v_mfma_f32_16x16x32_bf16 v[84:87], a[148:151], a[4:7], v[84:87]
    v_exp_f32 v159, v159
    v_mfma_f32_16x16x32_bf16 v[116:119], a[148:151], a[68:71], 0
    ds_read_b64_tr_b16 a[168:169], v233 offset:16384
    v_cvt_pk_bf16_f32 v187, v158, v159
    v_mfma_f32_16x16x32_bf16 v[116:119], a[144:147], a[64:67], v[116:119]
    s_waitcnt lgkmcnt(4)
    v_exp_f32 v152, v152
    v_mfma_f32_16x16x32_bf16 v[172:175], a[152:155], a[176:179], v[202:205]
    s_waitcnt lgkmcnt(3)
    buffer_load_dwordx4 v245, s[16:19], s43 offen offset:2048 nt lds
    v_mfma_f32_16x16x32_bf16 v[172:175], a[156:159], a[180:183], v[172:175]
    s_waitcnt lgkmcnt(2)
    ds_read_b64_tr_b16 a[170:171], v233 offset:17408
    ds_read_b64_tr_b16 a[172:173], v233 offset:18432
    v_mfma_f32_16x16x32_bf16 v[172:175], a[160:163], a[184:187], v[172:175]
    s_waitcnt lgkmcnt(3)
    ds_read_b64_tr_b16 a[174:175], v233 offset:19456
    ds_read_b64_tr_b16 a[128:129], v234 offset:16384
    v_mfma_f32_16x16x32_bf16 v[172:175], a[164:167], a[188:191], v[172:175]
    ds_read_b64_tr_b16 a[130:131], v234 offset:17408
    ds_read_b64_tr_b16 a[132:133], v234 offset:18432
    v_mfma_f32_16x16x32_bf16 v[176:179], a[164:167], a[204:207], v[206:209]
    v_exp_f32 v153, v153
    v_mfma_f32_16x16x32_bf16 v[176:179], a[160:163], a[200:203], v[176:179]
    ds_read_b64_tr_b16 a[134:135], v234 offset:19456
    v_cvt_pk_bf16_f32 v188, v152, v153
    v_mfma_f32_16x16x32_bf16 v[176:179], a[156:159], a[196:199], v[176:179]
L_pad2:
    s_cbranch_execz L_back0
    ds_read_b64_tr_b16 a[136:137], v235 offset:16384
    ds_read_b64_tr_b16 a[138:139], v235 offset:17408
    v_mfma_f32_16x16x32_bf16 v[176:179], a[152:155], a[192:195], v[176:179]
    s_waitcnt lgkmcnt(8)
    ds_read_b64_tr_b16 a[140:141], v235 offset:18432
    ds_read_b64_tr_b16 a[142:143], v235 offset:19456
    v_mfma_f32_16x16x32_bf16 v[88:91], a[168:171], a[0:3], 0
    s_waitcnt lgkmcnt(8)
    v_exp_f32 v154, v154
    v_mfma_f32_16x16x32_bf16 v[88:91], a[172:175], a[4:7], v[88:91]
    ds_read_b64_tr_b16 a[144:145], v236 offset:16384
    ds_read_b64_tr_b16 a[146:147], v236 offset:17408
    v_mfma_f32_16x16x32_bf16 v[120:123], a[172:175], a[68:71], 0
    ds_read_b64_tr_b16 a[148:149], v236 offset:18432
    ds_read_b64_tr_b16 a[150:151], v236 offset:19456
    v_mfma_f32_16x16x32_bf16 v[120:123], a[168:171], a[64:67], v[120:123]
    s_waitcnt lgkmcnt(10)
    v_exp_f32 v155, v155
    v_mfma_f32_16x16x32_bf16 v[92:95], a[128:131], a[0:3], 0
    s_waitcnt lgkmcnt(8)
    ds_read_b64_tr_b16 a[152:153], v237 offset:16384
    v_cvt_pk_bf16_f32 v189, v154, v155
    v_mfma_f32_16x16x32_bf16 v[92:95], a[132:135], a[4:7], v[92:95]
    ds_read_b64_tr_b16 a[154:155], v237 offset:17408
    ds_read_b64_tr_b16 a[156:157], v237 offset:18432
    v_mfma_f32_16x16x32_bf16 v[124:127], a[132:135], a[68:71], 0
    buffer_load_dwordx4 v245, s[16:19], s43 offen offset:3072 nt lds
    v_mfma_f32_16x16x32_bf16 v[124:127], a[128:131], a[64:67], v[124:127]
    s_waitcnt lgkmcnt(9)
    ds_write_b64 v243, v[200:201] offset:0
    ds_read_b64_tr_b16 a[158:159], v237 offset:19456
    v_mfma_f32_16x16x32_bf16 v[96:99], a[136:139], a[0:3], 0
    s_waitcnt lgkmcnt(9)
    v_exp_f32 v160, v160
    v_mfma_f32_16x16x32_bf16 v[96:99], a[140:143], a[4:7], v[96:99]
    s_add_u32 m0, s39, 16384
    v_exp_f32 v161, v161
    v_mfma_f32_16x16x32_bf16 v[128:131], a[140:143], a[68:71], 0
    s_add_u32 s43, s57, 256
    v_exp_f32 v162, v162
    v_mfma_f32_16x16x32_bf16 v[128:131], a[136:139], a[64:67], v[128:131]
    s_waitcnt vmcnt(4) lgkmcnt(0)
    s_barrier
    v_mfma_f32_16x16x32_bf16 v[100:103], a[144:147], a[0:3], 0
    ds_read_b64_tr_b16 a[160:161], v222 offset:16384
    v_cvt_pk_bf16_f32 v190, v160, v161
    v_mfma_f32_16x16x32_bf16 v[100:103], a[148:151], a[4:7], v[100:103]
    ds_read_b64_tr_b16 a[162:163], v222 offset:17408
    ds_read_b64_tr_b16 a[164:165], v222 offset:18432
    v_mfma_f32_16x16x32_bf16 v[132:135], a[148:151], a[68:71], 0
    ds_read_b64_tr_b16 a[166:167], v222 offset:19456
    v_mfma_f32_16x16x32_bf16 v[132:135], a[144:147], a[64:67], v[132:135]
    v_exp_f32 v163, v163
    v_mfma_f32_16x16x32_bf16 v[104:107], a[152:155], a[0:3], 0
    ds_read_b128 a[232:235], v240 offset:0
    v_cvt_pk_bf16_f32 v191, v162, v163
    v_mfma_f32_16x16x32_bf16 v[104:107], a[156:159], a[4:7], v[104:107]
    ds_read_b128 a[236:239], v241 offset:0
    ds_read_b64_tr_b16 a[168:169], v222 offset:49152
    v_mfma_f32_16x16x32_bf16 v[136:139], a[156:159], a[68:71], 0
    v_exp_f32 v164, v164
    v_mfma_f32_16x16x32_bf16 v[136:139], a[152:155], a[64:67], v[136:139]
    s_waitcnt lgkmcnt(5)
    ds_read_b64_tr_b16 a[170:171], v222 offset:50176
    ds_read_b64_tr_b16 a[172:173], v223 offset:49152
    v_mfma_f32_16x16x32_bf16 v[76:79], a[160:163], a[8:11], v[76:79]
    s_waitcnt lgkmcnt(5)
    v_exp_f32 v165, v165
    v_mfma_f32_16x16x32_bf16 v[76:79], a[164:167], a[12:15], v[76:79]
    buffer_load_dwordx4 v246, s[20:23], s43 offen offset:0  lds
    v_mfma_f32_16x16x32_bf16 v[108:111], a[164:167], a[76:79], v[108:111]
    s_add_u32 s43, s57, 32000
    ds_read_b64_tr_b16 a[174:175], v223 offset:50176
    v_cvt_pk_bf16_f32 v192, v164, v165
    v_mfma_f32_16x16x32_bf16 v[108:111], a[160:163], a[72:75], v[108:111]
    s_waitcnt lgkmcnt(5)
    ds_read_b64_tr_b16 a[128:129], v224 offset:49152
    ds_read_b64_tr_b16 a[130:131], v224 offset:50176
    v_mfma_f32_16x16x32_bf16 v[140:143], a[160:163], a[232:235], v[140:143]
    s_waitcnt lgkmcnt(6)
    buffer_load_dwordx4 v246, s[20:23], s43 offen offset:1024  lds
    v_mfma_f32_16x16x32_bf16 v[140:143], a[164:167], a[236:239], v[140:143]
    s_waitcnt lgkmcnt(4)
    ds_read_b64_tr_b16 a[132:133], v225 offset:49152
    ds_read_b64_tr_b16 a[134:135], v225 offset:50176
    v_mfma_f32_16x16x32_bf16 v[4:7], a[168:171], v[184:187], 0
    s_add_u32 s43, s57, 63744
    v_exp_f32 v166, v166
    v_mfma_f32_16x16x32_bf16 v[36:39], a[168:171], v[188:191], 0
    s_waitcnt lgkmcnt(4)
    ds_read_b64_tr_b16 a[136:137], v226 offset:49152
    ds_read_b64_tr_b16 a[138:139], v226 offset:50176
    v_mfma_f32_16x16x32_bf16 v[8:11], a[172:175], v[184:187], 0
    buffer_load_dwordx4 v246, s[20:23], s43 offen offset:2048  lds
    v_mfma_f32_16x16x32_bf16 v[40:43], a[172:175], v[188:191], 0
    s_add_u32 s43, s57, 95488
    ds_read_b64_tr_b16 a[140:141], v227 offset:49152
    ds_read_b64_tr_b16 a[142:143], v227 offset:50176
    v_mfma_f32_16x16x32_bf16 a[244:247], a[240:243], v[184:187], 0
    s_waitcnt lgkmcnt(6)
    v_exp_f32 v167, v167
    v_mfma_f32_16x16x32_bf16 v[12:15], a[128:131], v[184:187], 0
    ds_read_b128 a[224:227], v242 offset:16384
    v_cvt_pk_bf16_f32 v193, v166, v167
    v_mfma_f32_16x16x32_bf16 v[44:47], a[128:131], v[188:191], 0
    s_waitcnt lgkmcnt(5)
    buffer_load_dwordx4 v246, s[20:23], s43 offen offset:3072  lds
    v_mfma_f32_16x16x32_bf16 v[16:19], a[132:135], v[184:187], 0
    s_add_u32 m0, s39, 0
    ds_read_b64_tr_b16 a[144:145], v223 offset:16384
    ds_read_b64_tr_b16 a[146:147], v223 offset:17408
    v_mfma_f32_16x16x32_bf16 v[48:51], a[132:135], v[188:191], 0
    s_add_u32 s43, s40, 32768
    ds_read_b64_tr_b16 a[148:149], v223 offset:18432
    ds_read_b64_tr_b16 a[150:151], v223 offset:19456
    v_mfma_f32_16x16x32_bf16 a[248:251], a[240:243], v[188:191], 0
    s_waitcnt lgkmcnt(7)
    v_exp_f32 v172, v172
    v_mfma_f32_16x16x32_bf16 v[20:23], a[136:139], v[184:187], 0
    buffer_load_dwordx4 v244, s[12:15], s43 offen offset:0 nt lds
    v_mfma_f32_16x16x32_bf16 v[52:55], a[136:139], v[188:191], 0
    s_waitcnt lgkmcnt(5)
    v_exp_f32 v173, v173
    v_mfma_f32_16x16x32_bf16 v[24:27], a[140:143], v[184:187], 0
    ds_read_b64_tr_b16 a[152:153], v228 offset:49152
    v_cvt_pk_bf16_f32 v194, v172, v173
    v_mfma_f32_16x16x32_bf16 v[56:59], a[140:143], v[188:191], 0
    s_waitcnt lgkmcnt(5)
    v_exp_f32 v174, v174
    v_mfma_f32_16x16x32_bf16 a[252:255], a[240:243], a[224:227], 0
    s_waitcnt lgkmcnt(3)
    ds_read_b64_tr_b16 a[154:155], v228 offset:50176
    v_mfma_f32_16x16x32_bf16 v[80:83], a[144:147], a[8:11], v[80:83]
    s_waitcnt lgkmcnt(2)
    buffer_load_dwordx4 v244, s[12:15], s43 offen offset:1024 nt lds
    v_mfma_f32_16x16x32_bf16 v[80:83], a[148:151], a[12:15], v[80:83]
    ds_read_b64_tr_b16 a[156:157], v229 offset:49152
    ds_read_b64_tr_b16 a[158:159], v229 offset:50176
    v_mfma_f32_16x16x32_bf16 v[112:115], a[148:151], a[76:79], v[112:115]
    v_exp_f32 v175, v175
    v_mfma_f32_16x16x32_bf16 v[112:115], a[144:147], a[72:75], v[112:115]
    ds_read_b128 a[160:163], v218 offset:32768
    v_cvt_pk_bf16_f32 v195, v174, v175
    v_mfma_f32_16x16x32_bf16 v[144:147], a[144:147], a[232:235], v[144:147]
    v_exp_f32 v168, v168
    v_mfma_f32_16x16x32_bf16 v[144:147], a[148:151], a[236:239], v[144:147]
    s_waitcnt lgkmcnt(3)
    ds_read_b128 a[164:167], v219 offset:32768
    v_mfma_f32_16x16x32_bf16 v[28:31], a[152:155], v[184:187], 0
    ds_read_b128 a[168:171], v220 offset:32768
    v_mfma_f32_16x16x32_bf16 v[60:63], a[152:155], v[188:191], 0
    ds_read_b128 a[172:175], v221 offset:32768
    v_mfma_f32_16x16x32_bf16 v[68:71], a[152:155], a[224:227], 0
    s_waitcnt lgkmcnt(4)
    ds_read_b128 a[128:131], v214 offset:32768
    v_mfma_f32_16x16x32_bf16 v[32:35], a[156:159], v[184:187], 0
    ds_read_b128 a[132:135], v215 offset:32768
    v_mfma_f32_16x16x32_bf16 v[64:67], a[156:159], v[188:191], 0
    ds_read_b128 a[136:139], v216 offset:32768
    v_mfma_f32_16x16x32_bf16 v[72:75], a[156:159], a[224:227], 0
    s_waitcnt lgkmcnt(6)
    v_exp_f32 v169, v169
    v_mfma_f32_16x16x32_bf16 v[180:183], a[160:163], a[208:211], v[210:213]
    s_waitcnt lgkmcnt(5)
    ds_read_b128 a[140:143], v217 offset:32768
    v_cvt_pk_bf16_f32 v196, v168, v169
    v_mfma_f32_16x16x32_bf16 v[180:183], a[164:167], a[212:215], v[180:183]
    s_waitcnt lgkmcnt(5)
    v_exp_f32 v170, v170
    v_mfma_f32_16x16x32_bf16 v[180:183], a[168:171], a[216:219], v[180:183]
    s_waitcnt lgkmcnt(4)
    v_exp_f32 v171, v171
    v_mfma_f32_16x16x32_bf16 v[180:183], a[172:175], a[220:223], v[180:183]
    s_waitcnt lgkmcnt(3)
    buffer_load_dwordx4 v244, s[12:15], s43 offen offset:2048 nt lds
    v_mfma_f32_16x16x32_bf16 v[148:151], a[128:131], a[176:179], v[202:205]
    s_waitcnt lgkmcnt(2)
    ds_read_b64_tr_b16 a[144:145], v224 offset:16384
    v_cvt_pk_bf16_f32 v197, v170, v171
    v_mfma_f32_16x16x32_bf16 v[148:151], a[132:135], a[180:183], v[148:151]
    s_waitcnt lgkmcnt(2)
    ds_read_b64_tr_b16 a[146:147], v224 offset:17408
    ds_read_b64_tr_b16 a[148:149], v224 offset:18432
    v_mfma_f32_16x16x32_bf16 v[148:151], a[136:139], a[184:187], v[148:151]
    s_waitcnt lgkmcnt(3)
    ds_read_b64_tr_b16 a[150:151], v224 offset:19456
    v_mfma_f32_16x16x32_bf16 v[148:151], a[140:143], a[188:191], v[148:151]
    buffer_atomic_add v0, v248, s[84:87], s41 offen sc1
    v_mfma_f32_16x16x32_bf16 v[152:155], a[140:143], a[204:207], v[206:209]
    ds_read_b128 a[152:155], v214 offset:33792
    v_mfma_f32_16x16x32_bf16 v[152:155], a[136:139], a[200:203], v[152:155]
    ds_read_b128 a[156:159], v215 offset:33792
    v_mfma_f32_16x16x32_bf16 v[152:155], a[132:135], a[196:199], v[152:155]
    ds_read_b128 a[160:163], v216 offset:33792
    v_mfma_f32_16x16x32_bf16 v[152:155], a[128:131], a[192:195], v[152:155]
    s_waitcnt lgkmcnt(5)
    v_exp_f32 v176, v176
    v_mfma_f32_16x16x32_bf16 v[84:87], a[144:147], a[8:11], v[84:87]
    s_waitcnt lgkmcnt(3)
    ds_read_b128 a[164:167], v217 offset:33792
    v_mfma_f32_16x16x32_bf16 v[84:87], a[148:151], a[12:15], v[84:87]
    v_exp_f32 v177, v177
    v_mfma_f32_16x16x32_bf16 v[116:119], a[148:151], a[76:79], v[116:119]
    buffer_load_dwordx4 v244, s[12:15], s43 offen offset:3072 nt lds
    v_mfma_f32_16x16x32_bf16 v[116:119], a[144:147], a[72:75], v[116:119]
    s_waitcnt lgkmcnt(3)
    ds_read_b64_tr_b16 a[168:169], v225 offset:16384
    v_cvt_pk_bf16_f32 v198, v176, v177
    v_mfma_f32_16x16x32_bf16 v[156:159], a[152:155], a[176:179], v[202:205]
    s_waitcnt lgkmcnt(3)
    ds_read_b64_tr_b16 a[170:171], v225 offset:17408
    ds_read_b64_tr_b16 a[172:173], v225 offset:18432
    v_mfma_f32_16x16x32_bf16 v[156:159], a[156:159], a[180:183], v[156:159]
    s_waitcnt lgkmcnt(4)
    v_exp_f32 v178, v178
    v_mfma_f32_16x16x32_bf16 v[156:159], a[160:163], a[184:187], v[156:159]
    s_waitcnt lgkmcnt(3)
    ds_read_b64_tr_b16 a[174:175], v225 offset:19456
    v_mfma_f32_16x16x32_bf16 v[156:159], a[164:167], a[188:191], v[156:159]
    s_add_u32 m0, s39, 65536
    ds_read_b64_tr_b16 a[128:129], v222 offset:51200
    ds_read_b64_tr_b16 a[130:131], v222 offset:52224
    v_mfma_f32_16x16x32_bf16 v[160:163], a[164:167], a[204:207], v[206:209]
    v_exp_f32 v179, v179
    v_mfma_f32_16x16x32_bf16 v[160:163], a[160:163], a[200:203], v[160:163]
    ds_read_b64_tr_b16 a[132:133], v223 offset:51200
    v_cvt_pk_bf16_f32 v199, v178, v179
    v_mfma_f32_16x16x32_bf16 v[160:163], a[156:159], a[196:199], v[160:163]
    v_exp_f32 v180, v180
    v_mfma_f32_16x16x32_bf16 v[160:163], a[152:155], a[192:195], v[160:163]
    s_waitcnt lgkmcnt(5)
    ds_read_b64_tr_b16 a[134:135], v223 offset:52224
    ds_read_b64_tr_b16 a[136:137], v226 offset:16384
    v_mfma_f32_16x16x32_bf16 v[88:91], a[168:171], a[8:11], v[88:91]
    s_waitcnt lgkmcnt(5)
    v_exp_f32 v181, v181
    v_mfma_f32_16x16x32_bf16 v[88:91], a[172:175], a[12:15], v[88:91]
    ds_read_b64_tr_b16 a[138:139], v226 offset:17408
    v_cvt_pk_bf16_f32 v200, v180, v181
    v_mfma_f32_16x16x32_bf16 v[120:123], a[172:175], a[76:79], v[120:123]
    ds_read_b64_tr_b16 a[140:141], v226 offset:18432
    ds_read_b64_tr_b16 a[142:143], v226 offset:19456
    v_mfma_f32_16x16x32_bf16 v[120:123], a[168:171], a[72:75], v[120:123]
    s_waitcnt lgkmcnt(6)
    v_exp_f32 v182, v182
    v_mfma_f32_16x16x32_bf16 v[4:7], a[128:131], v[192:195], v[4:7]
    ds_read_b64_tr_b16 a[144:145], v224 offset:51200
    ds_read_b64_tr_b16 a[146:147], v224 offset:52224
    v_mfma_f32_16x16x32_bf16 v[36:39], a[128:131], v[196:199], v[36:39]
    s_waitcnt lgkmcnt(6)
    buffer_load_dwordx4 v245, s[16:19], s43 offen offset:0 nt lds
    v_mfma_f32_16x16x32_bf16 v[8:11], a[132:135], v[192:195], v[8:11]
    ds_read_b64_tr_b16 a[148:149], v225 offset:51200
    ds_read_b64_tr_b16 a[150:151], v225 offset:52224
    v_mfma_f32_16x16x32_bf16 v[40:43], a[132:135], v[196:199], v[40:43]
    v_exp_f32 v183, v183
    v_mfma_f32_16x16x32_bf16 a[244:247], a[240:243], v[192:195], a[244:247]
    s_waitcnt lgkmcnt(6)
    ds_read_b64_tr_b16 a[152:153], v226 offset:51200
    v_cvt_pk_bf16_f32 v201, v182, v183
    v_mfma_f32_16x16x32_bf16 v[92:95], a[136:139], a[8:11], v[92:95]
    s_waitcnt lgkmcnt(5)
    v_exp_f32 v148, v148
    v_mfma_f32_16x16x32_bf16 v[92:95], a[140:143], a[12:15], v[92:95]
    ds_read_b64_tr_b16 a[154:155], v226 offset:52224
    ds_read_b64_tr_b16 a[156:157], v227 offset:16384
    v_mfma_f32_16x16x32_bf16 v[124:127], a[140:143], a[76:79], v[124:127]
    v_exp_f32 v149, v149
    v_mfma_f32_16x16x32_bf16 v[124:127], a[136:139], a[72:75], v[124:127]
    s_waitcnt lgkmcnt(5)
    ds_read_b64_tr_b16 a[158:159], v227 offset:17408
    v_cvt_pk_bf16_f32 v184, v148, v149
    v_mfma_f32_16x16x32_bf16 v[12:15], a[144:147], v[192:195], v[12:15]
    ds_read_b64_tr_b16 a[160:161], v227 offset:18432
    ds_read_b64_tr_b16 a[162:163], v227 offset:19456
    v_mfma_f32_16x16x32_bf16 v[44:47], a[144:147], v[196:199], v[44:47]
    s_waitcnt lgkmcnt(6)
    v_exp_f32 v150, v150
    v_mfma_f32_16x16x32_bf16 v[16:19], a[148:151], v[192:195], v[16:19]
    ds_read_b64_tr_b16 a[164:165], v227 offset:51200
    ds_read_b64_tr_b16 a[166:167], v227 offset:52224
    v_mfma_f32_16x16x32_bf16 v[48:51], a[148:151], v[196:199], v[48:51]
    v_exp_f32 v151, v151
    v_mfma_f32_16x16x32_bf16 a[248:251], a[240:243], v[196:199], a[248:251]
    s_waitcnt lgkmcnt(6)
    ds_read_b128 a[228:231], v242 offset:17408
    v_cvt_pk_bf16_f32 v185, v150, v151
    v_mfma_f32_16x16x32_bf16 v[20:23], a[152:155], v[192:195], v[20:23]
    ds_read_b64_tr_b16 a[168:169], v228 offset:51200
    ds_read_b64_tr_b16 a[170:171], v228 offset:52224
    v_mfma_f32_16x16x32_bf16 v[52:55], a[152:155], v[196:199], v[52:55]
    s_waitcnt lgkmcnt(7)
    buffer_load_dwordx4 v245, s[16:19], s43 offen offset:1024 nt lds
    v_mfma_f32_16x16x32_bf16 v[96:99], a[156:159], a[8:11], v[96:99]
    s_waitcnt lgkmcnt(5)
    v_exp_f32 v156, v156
    v_mfma_f32_16x16x32_bf16 v[96:99], a[160:163], a[12:15], v[96:99]
    ds_read_b64_tr_b16 a[172:173], v229 offset:51200
    ds_read_b64_tr_b16 a[174:175], v229 offset:52224
    v_mfma_f32_16x16x32_bf16 v[128:131], a[160:163], a[76:79], v[128:131]
    v_exp_f32 v157, v157
    v_mfma_f32_16x16x32_bf16 v[128:131], a[156:159], a[72:75], v[128:131]
    s_waitcnt lgkmcnt(5)
    ds_read_b64_tr_b16 a[128:129], v228 offset:16384
    v_cvt_pk_bf16_f32 v186, v156, v157
    v_mfma_f32_16x16x32_bf16 v[24:27], a[164:167], v[192:195], v[24:27]
    v_exp_f32 v158, v158
    v_mfma_f32_16x16x32_bf16 v[56:59], a[164:167], v[196:199], v[56:59]
    s_waitcnt lgkmcnt(5)
    ds_read_b64_tr_b16 a[130:131], v228 offset:17408
    ds_read_b64_tr_b16 a[132:133], v228 offset:18432
    v_mfma_f32_16x16x32_bf16 a[252:255], a[240:243], a[228:231], a[252:255]
    s_waitcnt lgkmcnt(5)
    v_exp_f32 v159, v159
    v_mfma_f32_16x16x32_bf16 v[28:31], a[168:171], v[192:195], v[28:31]
    ds_read_b64_tr_b16 a[134:135], v228 offset:19456
    v_cvt_pk_bf16_f32 v187, v158, v159
    v_mfma_f32_16x16x32_bf16 v[60:63], a[168:171], v[196:199], v[60:63]
    v_exp_f32 v152, v152
    v_mfma_f32_16x16x32_bf16 v[68:71], a[168:171], a[228:231], v[68:71]
    s_waitcnt lgkmcnt(4)
    ds_read_b128 a[136:139], v214 offset:34816
    v_mfma_f32_16x16x32_bf16 v[32:35], a[172:175], v[192:195], v[32:35]
    ds_read_b128 a[140:143], v215 offset:34816
    v_mfma_f32_16x16x32_bf16 v[64:67], a[172:175], v[196:199], v[64:67]
    ds_read_b128 a[144:147], v216 offset:34816
    v_mfma_f32_16x16x32_bf16 v[72:75], a[172:175], a[228:231], v[72:75]
    s_waitcnt lgkmcnt(5)
    v_exp_f32 v153, v153
    v_mfma_f32_16x16x32_bf16 v[100:103], a[128:131], a[8:11], v[100:103]
    s_waitcnt lgkmcnt(3)
    ds_read_b128 a[148:151], v217 offset:34816
    v_cvt_pk_bf16_f32 v188, v152, v153
    v_mfma_f32_16x16x32_bf16 v[100:103], a[132:135], a[12:15], v[100:103]
    buffer_load_dwordx4 v245, s[16:19], s43 offen offset:2048 nt lds
    v_mfma_f32_16x16x32_bf16 v[132:135], a[132:135], a[76:79], v[132:135]
    s_add_u32 m0, s39, 81920
    v_exp_f32 v154, v154
    v_mfma_f32_16x16x32_bf16 v[132:135], a[128:131], a[72:75], v[132:135]
    s_waitcnt lgkmcnt(3)
    ds_read_b64_tr_b16 a[152:153], v229 offset:16384
    ds_read_b64_tr_b16 a[154:155], v229 offset:17408
    v_mfma_f32_16x16x32_bf16 v[164:167], a[136:139], a[176:179], v[202:205]
    s_waitcnt lgkmcnt(4)
    ds_read_b64_tr_b16 a[156:157], v229 offset:18432
    ds_read_b64_tr_b16 a[158:159], v229 offset:19456
    v_mfma_f32_16x16x32_bf16 v[164:167], a[140:143], a[180:183], v[164:167]
    s_waitcnt lgkmcnt(5)
    v_exp_f32 v155, v155
    v_mfma_f32_16x16x32_bf16 v[164:167], a[144:147], a[184:187], v[164:167]
    s_waitcnt lgkmcnt(4)
    ds_read_b128 a[160:163], v214 offset:35840
    v_cvt_pk_bf16_f32 v189, v154, v155
    v_mfma_f32_16x16x32_bf16 v[164:167], a[148:151], a[188:191], v[164:167]
    s_add_u32 s43, s57, 524544
    v_exp_f32 v160, v160
    v_mfma_f32_16x16x32_bf16 v[168:171], a[148:151], a[204:207], v[206:209]
    v_exp_f32 v161, v161
    v_mfma_f32_16x16x32_bf16 v[168:171], a[144:147], a[200:203], v[168:171]
    ds_read_b128 a[164:167], v215 offset:35840
    v_cvt_pk_bf16_f32 v190, v160, v161
    v_mfma_f32_16x16x32_bf16 v[168:171], a[140:143], a[196:199], v[168:171]
    ds_read_b128 a[168:171], v216 offset:35840
    ds_write_b64 v243, v[200:201] offset:2048
    v_mfma_f32_16x16x32_bf16 v[168:171], a[136:139], a[192:195], v[168:171]
    s_waitcnt lgkmcnt(6)
    ds_read_b128 a[172:175], v217 offset:35840
    v_mfma_f32_16x16x32_bf16 v[104:107], a[152:155], a[8:11], v[104:107]
    s_waitcnt lgkmcnt(5)
    v_exp_f32 v162, v162
    v_mfma_f32_16x16x32_bf16 v[104:107], a[156:159], a[12:15], v[104:107]
    v_exp_f32 v163, v163
    v_mfma_f32_16x16x32_bf16 v[136:139], a[156:159], a[76:79], v[136:139]
    v_exp_f32 v164, v164
    v_mfma_f32_16x16x32_bf16 v[136:139], a[152:155], a[72:75], v[136:139]
    s_waitcnt vmcnt(3) lgkmcnt(0)
    s_barrier
    v_mfma_f32_16x16x32_bf16 v[172:175], a[160:163], a[176:179], v[202:205]
    buffer_load_dwordx4 v246, s[20:23], s43 offen offset:0  lds
    v_mfma_f32_16x16x32_bf16 v[172:175], a[164:167], a[180:183], v[172:175]
    ds_read_b64_tr_b16 a[128:129], v230 offset:16384
    ds_read_b64_tr_b16 a[130:131], v230 offset:17408
    v_mfma_f32_16x16x32_bf16 v[172:175], a[168:171], a[184:187], v[172:175]
    ds_read_b64_tr_b16 a[132:133], v230 offset:18432
    ds_read_b64_tr_b16 a[134:135], v230 offset:19456
    v_mfma_f32_16x16x32_bf16 v[172:175], a[172:175], a[188:191], v[172:175]
    s_add_u32 s43, s57, 556288
    ds_read_b128 a[232:235], v238 offset:4096
    v_cvt_pk_bf16_f32 v191, v162, v163
    v_mfma_f32_16x16x32_bf16 v[176:179], a[172:175], a[204:207], v[206:209]
    buffer_load_dwordx4 v246, s[20:23], s43 offen offset:1024  lds
    v_mfma_f32_16x16x32_bf16 v[176:179], a[168:171], a[200:203], v[176:179]
    s_add_u32 s43, s57, 588032
    ds_read_b128 a[236:239], v239 offset:4096
    ds_read_b64_tr_b16 a[136:137], v222 offset:32768
    v_mfma_f32_16x16x32_bf16 v[176:179], a[164:167], a[196:199], v[176:179]
    v_exp_f32 v165, v165
    v_mfma_f32_16x16x32_bf16 v[176:179], a[160:163], a[192:195], v[176:179]
    s_waitcnt lgkmcnt(5)
    buffer_load_dwordx4 v246, s[20:23], s43 offen offset:2048  lds
    v_mfma_f32_16x16x32_bf16 v[76:79], a[128:131], a[16:19], v[76:79]
    s_waitcnt lgkmcnt(3)
    ds_read_b64_tr_b16 a[138:139], v222 offset:33792
    v_cvt_pk_bf16_f32 v192, v164, v165
    v_mfma_f32_16x16x32_bf16 v[76:79], a[132:135], a[20:23], v[76:79]
    s_add_u32 s43, s57, 619776
    ds_read_b64_tr_b16 a[140:141], v223 offset:32768
    ds_read_b64_tr_b16 a[142:143], v223 offset:33792
    v_mfma_f32_16x16x32_bf16 v[108:111], a[132:135], a[84:87], v[108:111]
    ds_read_b64_tr_b16 a[144:145], v224 offset:32768
    ds_read_b64_tr_b16 a[146:147], v224 offset:33792
    v_mfma_f32_16x16x32_bf16 v[108:111], a[128:131], a[80:83], v[108:111]
    s_waitcnt lgkmcnt(7)
    buffer_load_dwordx4 v246, s[20:23], s43 offen offset:3072  lds
    v_mfma_f32_16x16x32_bf16 v[140:143], a[128:131], a[232:235], v[140:143]
    s_waitcnt lgkmcnt(6)
    ds_read_b64_tr_b16 a[148:149], v225 offset:32768
    ds_read_b64_tr_b16 a[150:151], v225 offset:33792
    v_mfma_f32_16x16x32_bf16 v[140:143], a[132:135], a[236:239], v[140:143]
    s_waitcnt lgkmcnt(6)
    v_exp_f32 v166, v166
    v_mfma_f32_16x16x32_bf16 v[4:7], a[136:139], v[184:187], v[4:7]
    s_add_u32 m0, s39, 68608
    s_add_u32 s43, s40, 35840
    ds_read_b64_tr_b16 a[152:153], v226 offset:32768
    v_mfma_f32_16x16x32_bf16 v[36:39], a[136:139], v[188:191], v[36:39]
    s_waitcnt lgkmcnt(5)
    buffer_load_dwordx4 v245, s[16:19], s43 offen offset:0 nt lds
    v_mfma_f32_16x16x32_bf16 v[8:11], a[140:143], v[184:187], v[8:11]
    s_add_u32 m0, s39, 49152
    v_exp_f32 v167, v167
    v_mfma_f32_16x16x32_bf16 v[40:43], a[140:143], v[188:191], v[40:43]
    s_add_u32 s43, s40, 49152
    ds_read_b64_tr_b16 a[154:155], v226 offset:33792
    v_cvt_pk_bf16_f32 v193, v166, v167
    v_mfma_f32_16x16x32_bf16 a[244:247], a[240:243], v[184:187], a[244:247]
    s_waitcnt lgkmcnt(4)
    ds_read_b64_tr_b16 a[156:157], v227 offset:32768
    ds_read_b64_tr_b16 a[158:159], v227 offset:33792
    v_mfma_f32_16x16x32_bf16 v[12:15], a[144:147], v[184:187], v[12:15]
    ds_read_b128 a[224:227], v242 offset:18432
    ds_read_b64_tr_b16 a[160:161], v231 offset:16384
    v_mfma_f32_16x16x32_bf16 v[44:47], a[144:147], v[188:191], v[44:47]
    s_waitcnt lgkmcnt(6)
    buffer_load_dwordx4 v244, s[12:15], s43 offen offset:0 nt lds
    v_mfma_f32_16x16x32_bf16 v[16:19], a[148:151], v[184:187], v[16:19]
    ds_read_b64_tr_b16 a[162:163], v231 offset:17408
    ds_read_b64_tr_b16 a[164:165], v231 offset:18432
    v_mfma_f32_16x16x32_bf16 v[48:51], a[148:151], v[188:191], v[48:51]
    v_exp_f32 v172, v172
    v_mfma_f32_16x16x32_bf16 a[248:251], a[240:243], v[188:191], a[248:251]
    s_waitcnt lgkmcnt(6)
    ds_read_b64_tr_b16 a[166:167], v231 offset:19456
    v_mfma_f32_16x16x32_bf16 v[20:23], a[152:155], v[184:187], v[20:23]
    v_exp_f32 v173, v173
    v_mfma_f32_16x16x32_bf16 v[52:55], a[152:155], v[188:191], v[52:55]
    s_waitcnt lgkmcnt(5)
    ds_read_b64_tr_b16 a[168:169], v228 offset:32768
    v_cvt_pk_bf16_f32 v194, v172, v173
    v_mfma_f32_16x16x32_bf16 v[24:27], a[156:159], v[184:187], v[24:27]
    v_exp_f32 v174, v174
    v_mfma_f32_16x16x32_bf16 v[56:59], a[156:159], v[188:191], v[56:59]
    s_waitcnt lgkmcnt(5)
    v_exp_f32 v175, v175
    v_mfma_f32_16x16x32_bf16 a[252:255], a[240:243], a[224:227], a[252:255]
    s_waitcnt lgkmcnt(3)
    ds_read_b64_tr_b16 a[170:171], v228 offset:33792
    v_cvt_pk_bf16_f32 v195, v174, v175
    v_mfma_f32_16x16x32_bf16 v[80:83], a[160:163], a[16:19], v[80:83]
    s_waitcnt lgkmcnt(2)
    ds_read_b64_tr_b16 a[172:173], v229 offset:32768
    ds_read_b64_tr_b16 a[174:175], v229 offset:33792
    v_mfma_f32_16x16x32_bf16 v[80:83], a[164:167], a[20:23], v[80:83]
    v_exp_f32 v168, v168
    v_mfma_f32_16x16x32_bf16 v[112:115], a[164:167], a[84:87], v[112:115]
    v_exp_f32 v169, v169
    v_mfma_f32_16x16x32_bf16 v[112:115], a[160:163], a[80:83], v[112:115]
    ds_read_b128 a[128:131], v218 offset:0
    v_cvt_pk_bf16_f32 v196, v168, v169
    v_mfma_f32_16x16x32_bf16 v[144:147], a[160:163], a[232:235], v[144:147]
    v_exp_f32 v170, v170
    v_mfma_f32_16x16x32_bf16 v[144:147], a[164:167], a[236:239], v[144:147]
    s_waitcnt lgkmcnt(3)
    ds_read_b128 a[132:135], v219 offset:0
    v_mfma_f32_16x16x32_bf16 v[28:31], a[168:171], v[184:187], v[28:31]
    buffer_load_dwordx4 v244, s[12:15], s43 offen offset:1024 nt lds
    v_mfma_f32_16x16x32_bf16 v[60:63], a[168:171], v[188:191], v[60:63]
    ds_read_b128 a[136:139], v220 offset:0
    v_mfma_f32_16x16x32_bf16 v[68:71], a[168:171], a[224:227], v[68:71]
    s_waitcnt lgkmcnt(3)
    ds_read_b128 a[140:143], v221 offset:0
    v_mfma_f32_16x16x32_bf16 v[32:35], a[172:175], v[184:187], v[32:35]
    ds_read_b128 a[144:147], v214 offset:0
    v_mfma_f32_16x16x32_bf16 v[64:67], a[172:175], v[188:191], v[64:67]
    ds_read_b128 a[148:151], v215 offset:0
    v_mfma_f32_16x16x32_bf16 v[72:75], a[172:175], a[224:227], v[72:75]
    s_waitcnt lgkmcnt(5)
    ds_read_b128 a[152:155], v216 offset:0
    v_mfma_f32_16x16x32_bf16 v[180:183], a[128:131], a[208:211], v[210:213]
    s_waitcnt lgkmcnt(5)
    ds_read_b128 a[156:159], v217 offset:0
    v_mfma_f32_16x16x32_bf16 v[180:183], a[132:135], a[212:215], v[180:183]
    s_waitcnt lgkmcnt(5)
    v_exp_f32 v171, v171
    v_mfma_f32_16x16x32_bf16 v[180:183], a[136:139], a[216:219], v[180:183]
    s_waitcnt lgkmcnt(4)
    ds_read_b64_tr_b16 a[160:161], v232 offset:16384
    v_cvt_pk_bf16_f32 v197, v170, v171
    v_mfma_f32_16x16x32_bf16 v[180:183], a[140:143], a[220:223], v[180:183]
    s_waitcnt lgkmcnt(4)
    v_exp_f32 v176, v176
    v_mfma_f32_16x16x32_bf16 v[148:151], a[144:147], a[176:179], v[202:205]
    s_waitcnt lgkmcnt(3)
    ds_read_b64_tr_b16 a[162:163], v232 offset:17408
    ds_read_b64_tr_b16 a[164:165], v232 offset:18432
    v_mfma_f32_16x16x32_bf16 v[148:151], a[148:151], a[180:183], v[148:151]
    s_waitcnt lgkmcnt(4)
    v_exp_f32 v177, v177
    v_mfma_f32_16x16x32_bf16 v[148:151], a[152:155], a[184:187], v[148:151]
    s_waitcnt lgkmcnt(3)
    ds_read_b64_tr_b16 a[166:167], v232 offset:19456
    v_cvt_pk_bf16_f32 v198, v176, v177
    v_mfma_f32_16x16x32_bf16 v[148:151], a[156:159], a[188:191], v[148:151]
    buffer_atomic_add v0, v249, s[84:87], s41 offen sc1
    v_mfma_f32_16x16x32_bf16 v[152:155], a[156:159], a[204:207], v[206:209]
    ds_read_b128 a[168:171], v214 offset:1024
    v_mfma_f32_16x16x32_bf16 v[152:155], a[152:155], a[200:203], v[152:155]
    buffer_load_dwordx4 v244, s[12:15], s43 offen offset:2048 nt lds
    v_mfma_f32_16x16x32_bf16 v[152:155], a[148:151], a[196:199], v[152:155]
    ds_read_b128 a[172:175], v215 offset:1024
    v_mfma_f32_16x16x32_bf16 v[152:155], a[144:147], a[192:195], v[152:155]
    s_waitcnt lgkmcnt(4)
    ds_read_b128 a[128:131], v216 offset:1024
    v_mfma_f32_16x16x32_bf16 v[84:87], a[160:163], a[16:19], v[84:87]
    s_waitcnt lgkmcnt(3)
    ds_read_b128 a[132:135], v217 offset:1024
    v_mfma_f32_16x16x32_bf16 v[84:87], a[164:167], a[20:23], v[84:87]
    v_exp_f32 v178, v178
    v_mfma_f32_16x16x32_bf16 v[116:119], a[164:167], a[84:87], v[116:119]
    buffer_load_dwordx4 v244, s[12:15], s43 offen offset:3072 nt lds
    v_mfma_f32_16x16x32_bf16 v[116:119], a[160:163], a[80:83], v[116:119]
    s_waitcnt lgkmcnt(3)
    ds_read_b64_tr_b16 a[136:137], v233 offset:16384
    ds_read_b64_tr_b16 a[138:139], v233 offset:17408
    v_mfma_f32_16x16x32_bf16 v[156:159], a[168:171], a[176:179], v[202:205]
    s_waitcnt lgkmcnt(4)
    ds_read_b64_tr_b16 a[140:141], v233 offset:18432
    ds_read_b64_tr_b16 a[142:143], v233 offset:19456
    v_mfma_f32_16x16x32_bf16 v[156:159], a[172:175], a[180:183], v[156:159]
    s_waitcnt lgkmcnt(5)
    v_exp_f32 v179, v179
    v_mfma_f32_16x16x32_bf16 v[156:159], a[128:131], a[184:187], v[156:159]
    s_waitcnt lgkmcnt(4)
    ds_read_b64_tr_b16 a[144:145], v222 offset:34816
    v_cvt_pk_bf16_f32 v199, v178, v179
    v_mfma_f32_16x16x32_bf16 v[156:159], a[132:135], a[188:191], v[156:159]
    s_add_u32 m0, s39, 114688
    v_exp_f32 v180, v180
    v_mfma_f32_16x16x32_bf16 v[160:163], a[132:135], a[204:207], v[206:209]
    v_exp_f32 v181, v181
    v_mfma_f32_16x16x32_bf16 v[160:163], a[128:131], a[200:203], v[160:163]
    ds_read_b64_tr_b16 a[146:147], v222 offset:35840
    v_cvt_pk_bf16_f32 v200, v180, v181
    v_mfma_f32_16x16x32_bf16 v[160:163], a[172:175], a[196:199], v[160:163]
    ds_read_b64_tr_b16 a[148:149], v223 offset:34816
    ds_read_b64_tr_b16 a[150:151], v223 offset:35840
    v_mfma_f32_16x16x32_bf16 v[160:163], a[168:171], a[192:195], v[160:163]
    s_waitcnt lgkmcnt(6)
    v_exp_f32 v182, v182
    v_mfma_f32_16x16x32_bf16 v[88:91], a[136:139], a[16:19], v[88:91]
    s_waitcnt lgkmcnt(4)
    ds_read_b64_tr_b16 a[152:153], v234 offset:16384
    ds_read_b64_tr_b16 a[154:155], v234 offset:17408
    v_mfma_f32_16x16x32_bf16 v[88:91], a[140:143], a[20:23], v[88:91]
    ds_read_b64_tr_b16 a[156:157], v234 offset:18432
    ds_read_b64_tr_b16 a[158:159], v234 offset:19456
    v_mfma_f32_16x16x32_bf16 v[120:123], a[140:143], a[84:87], v[120:123]
    v_exp_f32 v183, v183
    v_mfma_f32_16x16x32_bf16 v[120:123], a[136:139], a[80:83], v[120:123]
    s_waitcnt lgkmcnt(6)
    ds_read_b64_tr_b16 a[160:161], v224 offset:34816
    v_cvt_pk_bf16_f32 v201, v182, v183
    v_mfma_f32_16x16x32_bf16 v[4:7], a[144:147], v[192:195], v[4:7]
    v_exp_f32 v148, v148
    v_mfma_f32_16x16x32_bf16 v[36:39], a[144:147], v[196:199], v[36:39]
    s_waitcnt lgkmcnt(5)
    buffer_load_dwordx4 v245, s[16:19], s43 offen offset:0 nt lds
    v_mfma_f32_16x16x32_bf16 v[8:11], a[148:151], v[192:195], v[8:11]
    ds_read_b64_tr_b16 a[162:163], v224 offset:35840
    ds_read_b64_tr_b16 a[164:165], v225 offset:34816
    v_mfma_f32_16x16x32_bf16 v[40:43], a[148:151], v[196:199], v[40:43]
L_pad3:
    s_cbranch_execz L_back0
    v_exp_f32 v149, v149
    v_mfma_f32_16x16x32_bf16 a[244:247], a[240:243], v[192:195], a[244:247]
    s_waitcnt lgkmcnt(5)
    ds_read_b64_tr_b16 a[166:167], v225 offset:35840
    v_cvt_pk_bf16_f32 v184, v148, v149
    v_mfma_f32_16x16x32_bf16 v[92:95], a[152:155], a[16:19], v[92:95]
    s_waitcnt lgkmcnt(4)
    ds_read_b64_tr_b16 a[168:169], v226 offset:34816
    ds_read_b64_tr_b16 a[170:171], v226 offset:35840
    v_mfma_f32_16x16x32_bf16 v[92:95], a[156:159], a[20:23], v[92:95]
    v_exp_f32 v150, v150
    v_mfma_f32_16x16x32_bf16 v[124:127], a[156:159], a[84:87], v[124:127]
    ds_read_b64_tr_b16 a[172:173], v235 offset:16384
    ds_read_b64_tr_b16 a[174:175], v235 offset:17408
    v_mfma_f32_16x16x32_bf16 v[124:127], a[152:155], a[80:83], v[124:127]
    s_waitcnt lgkmcnt(6)
    ds_read_b64_tr_b16 a[128:129], v235 offset:18432
    ds_read_b64_tr_b16 a[130:131], v235 offset:19456
    v_mfma_f32_16x16x32_bf16 v[12:15], a[160:163], v[192:195], v[12:15]
    v_exp_f32 v151, v151
    v_mfma_f32_16x16x32_bf16 v[44:47], a[160:163], v[196:199], v[44:47]
    s_waitcnt lgkmcnt(6)
    ds_read_b64_tr_b16 a[132:133], v227 offset:34816
    v_cvt_pk_bf16_f32 v185, v150, v151
    v_mfma_f32_16x16x32_bf16 v[16:19], a[164:167], v[192:195], v[16:19]
    v_exp_f32 v156, v156
    v_mfma_f32_16x16x32_bf16 v[48:51], a[164:167], v[196:199], v[48:51]
    v_exp_f32 v157, v157
    v_mfma_f32_16x16x32_bf16 a[248:251], a[240:243], v[196:199], a[248:251]
    s_waitcnt lgkmcnt(5)
    ds_read_b64_tr_b16 a[134:135], v227 offset:35840
    v_cvt_pk_bf16_f32 v186, v156, v157
    v_mfma_f32_16x16x32_bf16 v[20:23], a[168:171], v[192:195], v[20:23]
    ds_read_b128 a[228:231], v242 offset:19456
    ds_read_b64_tr_b16 a[136:137], v228 offset:34816
    v_mfma_f32_16x16x32_bf16 v[52:55], a[168:171], v[196:199], v[52:55]
    s_waitcnt lgkmcnt(6)
    buffer_load_dwordx4 v245, s[16:19], s43 offen offset:1024 nt lds
    v_mfma_f32_16x16x32_bf16 v[96:99], a[172:175], a[16:19], v[96:99]
    s_waitcnt lgkmcnt(4)
    ds_read_b64_tr_b16 a[138:139], v228 offset:35840
    v_mfma_f32_16x16x32_bf16 v[96:99], a[128:131], a[20:23], v[96:99]
    ds_read_b64_tr_b16 a[140:141], v229 offset:34816
    ds_read_b64_tr_b16 a[142:143], v229 offset:35840
    v_mfma_f32_16x16x32_bf16 v[128:131], a[128:131], a[84:87], v[128:131]
    v_exp_f32 v158, v158
    v_mfma_f32_16x16x32_bf16 v[128:131], a[172:175], a[80:83], v[128:131]
    s_waitcnt lgkmcnt(5)
    v_exp_f32 v159, v159
    v_mfma_f32_16x16x32_bf16 v[24:27], a[132:135], v[192:195], v[24:27]
    ds_read_b64_tr_b16 a[144:145], v236 offset:16384
    v_cvt_pk_bf16_f32 v187, v158, v159
    v_mfma_f32_16x16x32_bf16 v[56:59], a[132:135], v[196:199], v[56:59]
    s_waitcnt lgkmcnt(5)
    ds_read_b64_tr_b16 a[146:147], v236 offset:17408
    ds_read_b64_tr_b16 a[148:149], v236 offset:18432
    v_mfma_f32_16x16x32_bf16 a[252:255], a[240:243], a[228:231], a[252:255]
    s_waitcnt lgkmcnt(5)
    v_exp_f32 v152, v152
    v_mfma_f32_16x16x32_bf16 v[28:31], a[136:139], v[192:195], v[28:31]
    ds_read_b64_tr_b16 a[150:151], v236 offset:19456
    v_mfma_f32_16x16x32_bf16 v[60:63], a[136:139], v[196:199], v[60:63]
    v_exp_f32 v153, v153
    v_mfma_f32_16x16x32_bf16 v[68:71], a[136:139], a[228:231], v[68:71]
    s_waitcnt lgkmcnt(4)
    ds_read_b128 a[152:155], v214 offset:2048
    v_cvt_pk_bf16_f32 v188, v152, v153
    v_mfma_f32_16x16x32_bf16 v[32:35], a[140:143], v[192:195], v[32:35]
    ds_read_b128 a[156:159], v215 offset:2048
    v_mfma_f32_16x16x32_bf16 v[64:67], a[140:143], v[196:199], v[64:67]
    ds_read_b128 a[160:163], v216 offset:2048
    v_mfma_f32_16x16x32_bf16 v[72:75], a[140:143], a[228:231], v[72:75]
    s_waitcnt lgkmcnt(5)
    v_exp_f32 v154, v154
    v_mfma_f32_16x16x32_bf16 v[100:103], a[144:147], a[16:19], v[100:103]
    s_waitcnt lgkmcnt(3)
    ds_read_b128 a[164:167], v217 offset:2048
    v_mfma_f32_16x16x32_bf16 v[100:103], a[148:151], a[20:23], v[100:103]
    buffer_load_dwordx4 v245, s[16:19], s43 offen offset:2048 nt lds
    v_mfma_f32_16x16x32_bf16 v[132:135], a[148:151], a[84:87], v[132:135]
    s_add_u32 m0, s39, 0
    v_exp_f32 v155, v155
    v_mfma_f32_16x16x32_bf16 v[132:135], a[144:147], a[80:83], v[132:135]
    s_waitcnt lgkmcnt(3)
    ds_read_b64_tr_b16 a[168:169], v237 offset:16384
    v_cvt_pk_bf16_f32 v189, v154, v155
    v_mfma_f32_16x16x32_bf16 v[164:167], a[152:155], a[176:179], v[202:205]
    s_waitcnt lgkmcnt(3)
    ds_read_b64_tr_b16 a[170:171], v237 offset:17408
    ds_read_b64_tr_b16 a[172:173], v237 offset:18432
    v_mfma_f32_16x16x32_bf16 v[164:167], a[156:159], a[180:183], v[164:167]
    s_waitcnt lgkmcnt(4)
    v_exp_f32 v160, v160
    v_mfma_f32_16x16x32_bf16 v[164:167], a[160:163], a[184:187], v[164:167]
    s_waitcnt lgkmcnt(3)
    ds_read_b64_tr_b16 a[174:175], v237 offset:19456
    v_mfma_f32_16x16x32_bf16 v[164:167], a[164:167], a[188:191], v[164:167]
    s_add_u32 s43, s58, 256
    v_exp_f32 v161, v161
    v_mfma_f32_16x16x32_bf16 v[168:171], a[164:167], a[204:207], v[206:209]
    ds_read_b128 a[128:131], v214 offset:3072
    v_cvt_pk_bf16_f32 v190, v160, v161
    v_mfma_f32_16x16x32_bf16 v[168:171], a[160:163], a[200:203], v[168:171]
    ds_read_b128 a[132:135], v215 offset:3072
    ds_write_b64 v243, v[200:201] offset:0
    v_mfma_f32_16x16x32_bf16 v[168:171], a[156:159], a[196:199], v[168:171]
    ds_read_b128 a[136:139], v216 offset:3072
    v_mfma_f32_16x16x32_bf16 v[168:171], a[152:155], a[192:195], v[168:171]
    s_waitcnt lgkmcnt(6)
    ds_read_b128 a[140:143], v217 offset:3072
    v_mfma_f32_16x16x32_bf16 v[104:107], a[168:171], a[16:19], v[104:107]
    s_waitcnt lgkmcnt(5)
    v_exp_f32 v162, v162
    v_mfma_f32_16x16x32_bf16 v[104:107], a[172:175], a[20:23], v[104:107]
    v_exp_f32 v163, v163
    v_mfma_f32_16x16x32_bf16 v[136:139], a[172:175], a[84:87], v[136:139]
    v_exp_f32 v164, v164
    v_mfma_f32_16x16x32_bf16 v[136:139], a[168:171], a[80:83], v[136:139]
    s_mov_b64 exec, 0
    s_cmp_eq_u32 s36, 0
    s_cbranch_scc1 L_pad4
    s_cmp_eq_u32 s36, 1
    s_cbranch_scc1 L_pad5
    s_cmp_eq_u32 s36, 2
    s_cbranch_scc1 L_pad6
    s_branch L_pad7
L_back1:
    s_mov_b64 exec, -1
    s_waitcnt vmcnt(3) lgkmcnt(0)
    s_barrier
    v_mfma_f32_16x16x32_bf16 v[172:175], a[128:131], a[176:179], v[202:205]
    buffer_load_dwordx4 v246, s[20:23], s43 offen offset:0  lds
    v_mfma_f32_16x16x32_bf16 v[172:175], a[132:135], a[180:183], v[172:175]
    ds_read_b64_tr_b16 a[144:145], v222 offset:16384
    ds_read_b64_tr_b16 a[146:147], v222 offset:17408
    v_mfma_f32_16x16x32_bf16 v[172:175], a[136:139], a[184:187], v[172:175]
    ds_read_b64_tr_b16 a[148:149], v222 offset:18432
    ds_read_b64_tr_b16 a[150:151], v222 offset:19456
    v_mfma_f32_16x16x32_bf16 v[172:175], a[140:143], a[188:191], v[172:175]
    s_add_u32 s43, s58, 32000
    ds_read_b128 a[232:235], v240 offset:4096
    v_cvt_pk_bf16_f32 v191, v162, v163
    v_mfma_f32_16x16x32_bf16 v[176:179], a[140:143], a[204:207], v[206:209]
    buffer_load_dwordx4 v246, s[20:23], s43 offen offset:1024  lds
    v_mfma_f32_16x16x32_bf16 v[176:179], a[136:139], a[200:203], v[176:179]
    s_add_u32 s43, s58, 63744
    ds_read_b128 a[236:239], v241 offset:4096
    ds_read_b64_tr_b16 a[152:153], v222 offset:0
    v_mfma_f32_16x16x32_bf16 v[176:179], a[132:135], a[196:199], v[176:179]
    v_exp_f32 v165, v165
    v_mfma_f32_16x16x32_bf16 v[176:179], a[128:131], a[192:195], v[176:179]
    s_waitcnt lgkmcnt(5)
    buffer_load_dwordx4 v246, s[20:23], s43 offen offset:2048  lds
    v_mfma_f32_16x16x32_bf16 v[76:79], a[144:147], a[24:27], v[76:79]
    s_waitcnt lgkmcnt(3)
    ds_read_b64_tr_b16 a[154:155], v222 offset:1024
    v_cvt_pk_bf16_f32 v192, v164, v165
    v_mfma_f32_16x16x32_bf16 v[76:79], a[148:151], a[28:31], v[76:79]
    s_add_u32 s43, s58, 95488
    ds_read_b64_tr_b16 a[156:157], v223 offset:0
    ds_read_b64_tr_b16 a[158:159], v223 offset:1024
    v_mfma_f32_16x16x32_bf16 v[108:111], a[148:151], a[92:95], v[108:111]
    ds_read_b64_tr_b16 a[160:161], v224 offset:0
    ds_read_b64_tr_b16 a[162:163], v224 offset:1024
    v_mfma_f32_16x16x32_bf16 v[108:111], a[144:147], a[88:91], v[108:111]
    s_waitcnt lgkmcnt(7)
    buffer_load_dwordx4 v246, s[20:23], s43 offen offset:3072  lds
    v_mfma_f32_16x16x32_bf16 v[140:143], a[144:147], a[232:235], v[140:143]
    s_waitcnt lgkmcnt(6)
    ds_read_b64_tr_b16 a[164:165], v225 offset:0
    ds_read_b64_tr_b16 a[166:167], v225 offset:1024
    v_mfma_f32_16x16x32_bf16 v[140:143], a[148:151], a[236:239], v[140:143]
    s_waitcnt lgkmcnt(6)
    v_exp_f32 v166, v166
    v_mfma_f32_16x16x32_bf16 v[4:7], a[152:155], v[184:187], v[4:7]
    s_add_u32 m0, s39, 117760
    s_add_u32 s43, s40, 52224
    ds_read_b64_tr_b16 a[168:169], v226 offset:0
    v_mfma_f32_16x16x32_bf16 v[36:39], a[152:155], v[188:191], v[36:39]
    s_waitcnt lgkmcnt(5)
    buffer_load_dwordx4 v245, s[16:19], s43 offen offset:0 nt lds
    v_mfma_f32_16x16x32_bf16 v[8:11], a[156:159], v[184:187], v[8:11]
    s_add_u32 m0, s39, 32768
    v_exp_f32 v167, v167
    v_mfma_f32_16x16x32_bf16 v[40:43], a[156:159], v[188:191], v[40:43]
    s_add_u32 s43, s40, 65536
    ds_read_b64_tr_b16 a[170:171], v226 offset:1024
    v_cvt_pk_bf16_f32 v193, v166, v167
    v_mfma_f32_16x16x32_bf16 a[244:247], a[240:243], v[184:187], a[244:247]
    s_waitcnt lgkmcnt(4)
    ds_read_b64_tr_b16 a[172:173], v227 offset:0
    ds_read_b64_tr_b16 a[174:175], v227 offset:1024
    v_mfma_f32_16x16x32_bf16 v[12:15], a[160:163], v[184:187], v[12:15]
    ds_read_b128 a[224:227], v242 offset:16384
    ds_read_b64_tr_b16 a[128:129], v223 offset:16384
    v_mfma_f32_16x16x32_bf16 v[44:47], a[160:163], v[188:191], v[44:47]
    s_waitcnt lgkmcnt(6)
    buffer_load_dwordx4 v244, s[12:15], s43 offen offset:0 nt lds
    v_mfma_f32_16x16x32_bf16 v[16:19], a[164:167], v[184:187], v[16:19]
    ds_read_b64_tr_b16 a[130:131], v223 offset:17408
    ds_read_b64_tr_b16 a[132:133], v223 offset:18432
    v_mfma_f32_16x16x32_bf16 v[48:51], a[164:167], v[188:191], v[48:51]
    v_exp_f32 v172, v172
    v_mfma_f32_16x16x32_bf16 a[248:251], a[240:243], v[188:191], a[248:251]
    s_waitcnt lgkmcnt(6)
    ds_read_b64_tr_b16 a[134:135], v223 offset:19456
    v_mfma_f32_16x16x32_bf16 v[20:23], a[168:171], v[184:187], v[20:23]
    v_exp_f32 v173, v173
    v_mfma_f32_16x16x32_bf16 v[52:55], a[168:171], v[188:191], v[52:55]
    s_waitcnt lgkmcnt(5)
    ds_read_b64_tr_b16 a[136:137], v228 offset:0
    v_cvt_pk_bf16_f32 v194, v172, v173
    v_mfma_f32_16x16x32_bf16 v[24:27], a[172:175], v[184:187], v[24:27]
    v_exp_f32 v174, v174
    v_mfma_f32_16x16x32_bf16 v[56:59], a[172:175], v[188:191], v[56:59]
    s_waitcnt lgkmcnt(5)
    v_exp_f32 v175, v175
    v_mfma_f32_16x16x32_bf16 a[252:255], a[240:243], a[224:227], a[252:255]
    s_waitcnt lgkmcnt(3)
    ds_read_b64_tr_b16 a[138:139], v228 offset:1024
    v_cvt_pk_bf16_f32 v195, v174, v175
    v_mfma_f32_16x16x32_bf16 v[80:83], a[128:131], a[24:27], v[80:83]
    s_waitcnt lgkmcnt(2)
    ds_read_b64_tr_b16 a[140:141], v229 offset:0
    ds_read_b64_tr_b16 a[142:143], v229 offset:1024
    v_mfma_f32_16x16x32_bf16 v[80:83], a[132:135], a[28:31], v[80:83]
    v_exp_f32 v168, v168
    v_mfma_f32_16x16x32_bf16 v[112:115], a[132:135], a[92:95], v[112:115]
    v_exp_f32 v169, v169
    v_mfma_f32_16x16x32_bf16 v[112:115], a[128:131], a[88:91], v[112:115]
    ds_read_b128 a[144:147], v218 offset:49152
    v_cvt_pk_bf16_f32 v196, v168, v169
    v_mfma_f32_16x16x32_bf16 v[144:147], a[128:131], a[232:235], v[144:147]
    v_exp_f32 v170, v170
    v_mfma_f32_16x16x32_bf16 v[144:147], a[132:135], a[236:239], v[144:147]
    s_waitcnt lgkmcnt(3)
    ds_read_b128 a[148:151], v219 offset:49152
    v_mfma_f32_16x16x32_bf16 v[28:31], a[136:139], v[184:187], v[28:31]
    buffer_load_dwordx4 v244, s[12:15], s43 offen offset:1024 nt lds
    v_mfma_f32_16x16x32_bf16 v[60:63], a[136:139], v[188:191], v[60:63]
    ds_read_b128 a[152:155], v220 offset:49152
    v_mfma_f32_16x16x32_bf16 v[68:71], a[136:139], a[224:227], v[68:71]
    s_waitcnt lgkmcnt(3)
    ds_read_b128 a[156:159], v221 offset:49152
    v_mfma_f32_16x16x32_bf16 v[32:35], a[140:143], v[184:187], v[32:35]
    ds_read_b128 a[160:163], v214 offset:49152
    v_mfma_f32_16x16x32_bf16 v[64:67], a[140:143], v[188:191], v[64:67]
    ds_read_b128 a[164:167], v215 offset:49152
    v_mfma_f32_16x16x32_bf16 v[72:75], a[140:143], a[224:227], v[72:75]
    s_waitcnt lgkmcnt(5)
    ds_read_b128 a[168:171], v216 offset:49152
    v_mfma_f32_16x16x32_bf16 v[180:183], a[144:147], a[208:211], v[210:213]
    s_waitcnt lgkmcnt(5)
    ds_read_b128 a[172:175], v217 offset:49152
    v_mfma_f32_16x16x32_bf16 v[180:183], a[148:151], a[212:215], v[180:183]
    s_waitcnt lgkmcnt(5)
    v_exp_f32 v171, v171
    v_mfma_f32_16x16x32_bf16 v[180:183], a[152:155], a[216:219], v[180:183]
    s_waitcnt lgkmcnt(4)
    ds_read_b64_tr_b16 a[128:129], v224 offset:16384
    v_cvt_pk_bf16_f32 v197, v170, v171
    v_mfma_f32_16x16x32_bf16 v[180:183], a[156:159], a[220:223], v[180:183]
    s_waitcnt lgkmcnt(4)
    v_exp_f32 v176, v176
    v_mfma_f32_16x16x32_bf16 v[148:151], a[160:163], a[176:179], v[202:205]
    s_waitcnt lgkmcnt(3)
    ds_read_b64_tr_b16 a[130:131], v224 offset:17408
    ds_read_b64_tr_b16 a[132:133], v224 offset:18432
    v_mfma_f32_16x16x32_bf16 v[148:151], a[164:167], a[180:183], v[148:151]
    s_waitcnt lgkmcnt(4)
    v_exp_f32 v177, v177
    v_mfma_f32_16x16x32_bf16 v[148:151], a[168:171], a[184:187], v[148:151]
    s_waitcnt lgkmcnt(3)
    ds_read_b64_tr_b16 a[134:135], v224 offset:19456
    v_cvt_pk_bf16_f32 v198, v176, v177
    v_mfma_f32_16x16x32_bf16 v[148:151], a[172:175], a[188:191], v[148:151]
    v_exp_f32 v178, v178
    v_mfma_f32_16x16x32_bf16 v[152:155], a[172:175], a[204:207], v[206:209]
    ds_read_b128 a[136:139], v214 offset:50176
    v_mfma_f32_16x16x32_bf16 v[152:155], a[168:171], a[200:203], v[152:155]
    buffer_load_dwordx4 v244, s[12:15], s43 offen offset:2048 nt lds
    v_mfma_f32_16x16x32_bf16 v[152:155], a[164:167], a[196:199], v[152:155]
    ds_read_b128 a[140:143], v215 offset:50176
    v_mfma_f32_16x16x32_bf16 v[152:155], a[160:163], a[192:195], v[152:155]
    s_waitcnt lgkmcnt(4)
    ds_read_b128 a[144:147], v216 offset:50176
    v_mfma_f32_16x16x32_bf16 v[84:87], a[128:131], a[24:27], v[84:87]
    s_waitcnt lgkmcnt(3)
    ds_read_b128 a[148:151], v217 offset:50176
    v_mfma_f32_16x16x32_bf16 v[84:87], a[132:135], a[28:31], v[84:87]
    v_exp_f32 v179, v179
    v_mfma_f32_16x16x32_bf16 v[116:119], a[132:135], a[92:95], v[116:119]
    buffer_load_dwordx4 v244, s[12:15], s43 offen offset:3072 nt lds
    v_mfma_f32_16x16x32_bf16 v[116:119], a[128:131], a[88:91], v[116:119]
    s_waitcnt lgkmcnt(3)
    ds_read_b64_tr_b16 a[152:153], v225 offset:16384
    v_cvt_pk_bf16_f32 v199, v178, v179
    v_mfma_f32_16x16x32_bf16 v[156:159], a[136:139], a[176:179], v[202:205]
    s_waitcnt lgkmcnt(3)
    ds_read_b64_tr_b16 a[154:155], v225 offset:17408
    ds_read_b64_tr_b16 a[156:157], v225 offset:18432
    v_mfma_f32_16x16x32_bf16 v[156:159], a[140:143], a[180:183], v[156:159]
    s_waitcnt lgkmcnt(4)
    v_exp_f32 v180, v180
    v_mfma_f32_16x16x32_bf16 v[156:159], a[144:147], a[184:187], v[156:159]
    s_waitcnt lgkmcnt(3)
    ds_read_b64_tr_b16 a[158:159], v225 offset:19456
    v_mfma_f32_16x16x32_bf16 v[156:159], a[148:151], a[188:191], v[156:159]
    s_add_u32 m0, s39, 98304
    ds_read_b64_tr_b16 a[160:161], v222 offset:2048
    ds_read_b64_tr_b16 a[162:163], v222 offset:3072
    v_mfma_f32_16x16x32_bf16 v[160:163], a[148:151], a[204:207], v[206:209]
    v_exp_f32 v181, v181
    v_mfma_f32_16x16x32_bf16 v[160:163], a[144:147], a[200:203], v[160:163]
    ds_read_b64_tr_b16 a[164:165], v223 offset:2048
    v_cvt_pk_bf16_f32 v200, v180, v181
    v_mfma_f32_16x16x32_bf16 v[160:163], a[140:143], a[196:199], v[160:163]
    v_exp_f32 v182, v182
    v_mfma_f32_16x16x32_bf16 v[160:163], a[136:139], a[192:195], v[160:163]
    s_waitcnt lgkmcnt(5)
    ds_read_b64_tr_b16 a[166:167], v223 offset:3072
    ds_read_b64_tr_b16 a[168:169], v226 offset:16384
    v_mfma_f32_16x16x32_bf16 v[88:91], a[152:155], a[24:27], v[88:91]
    s_waitcnt lgkmcnt(5)
    v_exp_f32 v183, v183
    v_mfma_f32_16x16x32_bf16 v[88:91], a[156:159], a[28:31], v[88:91]
    ds_read_b64_tr_b16 a[170:171], v226 offset:17408
    v_cvt_pk_bf16_f32 v201, v182, v183
    v_mfma_f32_16x16x32_bf16 v[120:123], a[156:159], a[92:95], v[120:123]
    ds_read_b64_tr_b16 a[172:173], v226 offset:18432
    ds_read_b64_tr_b16 a[174:175], v226 offset:19456
    v_mfma_f32_16x16x32_bf16 v[120:123], a[152:155], a[88:91], v[120:123]
    s_waitcnt lgkmcnt(6)
    v_exp_f32 v148, v148
    v_mfma_f32_16x16x32_bf16 v[4:7], a[160:163], v[192:195], v[4:7]
    ds_read_b64_tr_b16 a[128:129], v224 offset:2048
    ds_read_b64_tr_b16 a[130:131], v224 offset:3072
    v_mfma_f32_16x16x32_bf16 v[36:39], a[160:163], v[196:199], v[36:39]
    s_waitcnt lgkmcnt(6)
    buffer_load_dwordx4 v245, s[16:19], s43 offen offset:0 nt lds
    v_mfma_f32_16x16x32_bf16 v[8:11], a[164:167], v[192:195], v[8:11]
    ds_read_b64_tr_b16 a[132:133], v225 offset:2048
    ds_read_b64_tr_b16 a[134:135], v225 offset:3072
    v_mfma_f32_16x16x32_bf16 v[40:43], a[164:167], v[196:199], v[40:43]
    v_exp_f32 v149, v149
    v_mfma_f32_16x16x32_bf16 a[244:247], a[240:243], v[192:195], a[244:247]
    s_waitcnt lgkmcnt(6)
    ds_read_b64_tr_b16 a[136:137], v226 offset:2048
    v_cvt_pk_bf16_f32 v184, v148, v149
    v_mfma_f32_16x16x32_bf16 v[92:95], a[168:171], a[24:27], v[92:95]
    s_waitcnt lgkmcnt(5)
    v_exp_f32 v150, v150
    v_mfma_f32_16x16x32_bf16 v[92:95], a[172:175], a[28:31], v[92:95]
    ds_read_b64_tr_b16 a[138:139], v226 offset:3072
    ds_read_b64_tr_b16 a[140:141], v227 offset:16384
    v_mfma_f32_16x16x32_bf16 v[124:127], a[172:175], a[92:95], v[124:127]
    v_exp_f32 v151, v151
    v_mfma_f32_16x16x32_bf16 v[124:127], a[168:171], a[88:91], v[124:127]
    s_waitcnt lgkmcnt(5)
    ds_read_b64_tr_b16 a[142:143], v227 offset:17408
    v_cvt_pk_bf16_f32 v185, v150, v151
    v_mfma_f32_16x16x32_bf16 v[12:15], a[128:131], v[192:195], v[12:15]
    ds_read_b64_tr_b16 a[144:145], v227 offset:18432
    ds_read_b64_tr_b16 a[146:147], v227 offset:19456
    v_mfma_f32_16x16x32_bf16 v[44:47], a[128:131], v[196:199], v[44:47]
    s_waitcnt lgkmcnt(6)
    v_exp_f32 v156, v156
    v_mfma_f32_16x16x32_bf16 v[16:19], a[132:135], v[192:195], v[16:19]
    ds_read_b64_tr_b16 a[148:149], v227 offset:2048
    ds_read_b64_tr_b16 a[150:151], v227 offset:3072
    v_mfma_f32_16x16x32_bf16 v[48:51], a[132:135], v[196:199], v[48:51]
    v_exp_f32 v157, v157
    v_mfma_f32_16x16x32_bf16 a[248:251], a[240:243], v[196:199], a[248:251]
    s_waitcnt lgkmcnt(6)
    ds_read_b128 a[228:231], v242 offset:17408
    v_cvt_pk_bf16_f32 v186, v156, v157
    v_mfma_f32_16x16x32_bf16 v[20:23], a[136:139], v[192:195], v[20:23]
    ds_read_b64_tr_b16 a[152:153], v228 offset:2048
    ds_read_b64_tr_b16 a[154:155], v228 offset:3072
    v_mfma_f32_16x16x32_bf16 v[52:55], a[136:139], v[196:199], v[52:55]
    s_waitcnt lgkmcnt(7)
    buffer_load_dwordx4 v245, s[16:19], s43 offen offset:1024 nt lds
    v_mfma_f32_16x16x32_bf16 v[96:99], a[140:143], a[24:27], v[96:99]
    s_waitcnt lgkmcnt(5)
    v_exp_f32 v158, v158
    v_mfma_f32_16x16x32_bf16 v[96:99], a[144:147], a[28:31], v[96:99]
    ds_read_b64_tr_b16 a[156:157], v229 offset:2048
    ds_read_b64_tr_b16 a[158:159], v229 offset:3072
    v_mfma_f32_16x16x32_bf16 v[128:131], a[144:147], a[92:95], v[128:131]
    v_exp_f32 v159, v159
    v_mfma_f32_16x16x32_bf16 v[128:131], a[140:143], a[88:91], v[128:131]
    s_waitcnt lgkmcnt(5)
    ds_read_b64_tr_b16 a[160:161], v228 offset:16384
    v_cvt_pk_bf16_f32 v187, v158, v159
    v_mfma_f32_16x16x32_bf16 v[24:27], a[148:151], v[192:195], v[24:27]
    v_exp_f32 v152, v152
    v_mfma_f32_16x16x32_bf16 v[56:59], a[148:151], v[196:199], v[56:59]
    s_waitcnt lgkmcnt(5)
    ds_read_b64_tr_b16 a[162:163], v228 offset:17408
    ds_read_b64_tr_b16 a[164:165], v228 offset:18432
    v_mfma_f32_16x16x32_bf16 a[252:255], a[240:243], a[228:231], a[252:255]
    s_waitcnt lgkmcnt(5)
    v_exp_f32 v153, v153
    v_mfma_f32_16x16x32_bf16 v[28:31], a[152:155], v[192:195], v[28:31]
    ds_read_b64_tr_b16 a[166:167], v228 offset:19456
    v_cvt_pk_bf16_f32 v188, v152, v153
    v_mfma_f32_16x16x32_bf16 v[60:63], a[152:155], v[196:199], v[60:63]
    v_exp_f32 v154, v154
    v_mfma_f32_16x16x32_bf16 v[68:71], a[152:155], a[228:231], v[68:71]
    s_waitcnt lgkmcnt(4)
    ds_read_b128 a[168:171], v214 offset:51200
    v_mfma_f32_16x16x32_bf16 v[32:35], a[156:159], v[192:195], v[32:35]
    ds_read_b128 a[172:175], v215 offset:51200
    v_mfma_f32_16x16x32_bf16 v[64:67], a[156:159], v[196:199], v[64:67]
    ds_read_b128 a[128:131], v216 offset:51200
    v_mfma_f32_16x16x32_bf16 v[72:75], a[156:159], a[228:231], v[72:75]
    s_waitcnt lgkmcnt(5)
    v_exp_f32 v155, v155
    v_mfma_f32_16x16x32_bf16 v[100:103], a[160:163], a[24:27], v[100:103]
    s_waitcnt lgkmcnt(3)
    buffer_load_dwordx4 v245, s[16:19], s43 offen offset:2048 nt lds
    v_mfma_f32_16x16x32_bf16 v[100:103], a[164:167], a[28:31], v[100:103]
    ds_read_b128 a[132:135], v217 offset:51200
    v_cvt_pk_bf16_f32 v189, v154, v155
    v_mfma_f32_16x16x32_bf16 v[132:135], a[164:167], a[92:95], v[132:135]
    v_exp_f32 v160, v160
    v_mfma_f32_16x16x32_bf16 v[132:135], a[160:163], a[88:91], v[132:135]
    s_waitcnt lgkmcnt(3)
    ds_read_b64_tr_b16 a[136:137], v229 offset:16384
    ds_read_b64_tr_b16 a[138:139], v229 offset:17408
    v_mfma_f32_16x16x32_bf16 v[164:167], a[168:171], a[176:179], v[202:205]
    s_waitcnt lgkmcnt(4)
    ds_read_b64_tr_b16 a[140:141], v229 offset:18432
    ds_read_b64_tr_b16 a[142:143], v229 offset:19456
    v_mfma_f32_16x16x32_bf16 v[164:167], a[172:175], a[180:183], v[164:167]
    s_waitcnt lgkmcnt(5)
    v_exp_f32 v161, v161
    v_mfma_f32_16x16x32_bf16 v[164:167], a[128:131], a[184:187], v[164:167]
    s_waitcnt lgkmcnt(4)
    ds_read_b128 a[144:147], v214 offset:52224
    v_cvt_pk_bf16_f32 v190, v160, v161
    v_mfma_f32_16x16x32_bf16 v[164:167], a[132:135], a[188:191], v[164:167]
    v_exp_f32 v162, v162
    v_mfma_f32_16x16x32_bf16 v[168:171], a[132:135], a[204:207], v[206:209]
    v_exp_f32 v163, v163
    v_mfma_f32_16x16x32_bf16 v[168:171], a[128:131], a[200:203], v[168:171]
    ds_read_b128 a[148:151], v215 offset:52224
    v_cvt_pk_bf16_f32 v191, v162, v163
    v_mfma_f32_16x16x32_bf16 v[168:171], a[172:175], a[196:199], v[168:171]
    ds_read_b128 a[152:155], v216 offset:52224
    ds_write_b64 v243, v[200:201] offset:2048
    v_mfma_f32_16x16x32_bf16 v[168:171], a[168:171], a[192:195], v[168:171]
    s_waitcnt lgkmcnt(6)
    ds_read_b128 a[156:159], v217 offset:52224
    v_mfma_f32_16x16x32_bf16 v[104:107], a[136:139], a[24:27], v[104:107]
    s_waitcnt lgkmcnt(5)
    v_exp_f32 v164, v164
    v_mfma_f32_16x16x32_bf16 v[104:107], a[140:143], a[28:31], v[104:107]
    buffer_load_dwordx4 v245, s[16:19], s43 offen offset:3072 nt lds
    v_mfma_f32_16x16x32_bf16 v[136:139], a[140:143], a[92:95], v[136:139]
    s_add_u32 m0, s39, 65536
    v_exp_f32 v165, v165
    v_mfma_f32_16x16x32_bf16 v[136:139], a[136:139], a[88:91], v[136:139]
    s_waitcnt vmcnt(4) lgkmcnt(0)
    s_barrier
    v_mfma_f32_16x16x32_bf16 v[172:175], a[144:147], a[176:179], v[202:205]
    ds_read_b64_tr_b16 a[160:161], v230 offset:0
    v_cvt_pk_bf16_f32 v192, v164, v165
    v_mfma_f32_16x16x32_bf16 v[172:175], a[148:151], a[180:183], v[172:175]
    ds_read_b64_tr_b16 a[162:163], v230 offset:1024
    ds_read_b64_tr_b16 a[164:165], v230 offset:2048
    v_mfma_f32_16x16x32_bf16 v[172:175], a[152:155], a[184:187], v[172:175]
    ds_read_b64_tr_b16 a[166:167], v230 offset:3072
    v_mfma_f32_16x16x32_bf16 v[172:175], a[156:159], a[188:191], v[172:175]
    s_add_u32 s43, s58, 524544
    v_exp_f32 v166, v166
    v_mfma_f32_16x16x32_bf16 v[176:179], a[156:159], a[204:207], v[206:209]
    ds_read_b128 a[232:235], v238 offset:8192
    v_mfma_f32_16x16x32_bf16 v[176:179], a[152:155], a[200:203], v[176:179]
    ds_read_b128 a[236:239], v239 offset:8192
    ds_read_b64_tr_b16 a[168:169], v222 offset:49152
    v_mfma_f32_16x16x32_bf16 v[176:179], a[148:151], a[196:199], v[176:179]
    v_exp_f32 v167, v167
    v_mfma_f32_16x16x32_bf16 v[176:179], a[144:147], a[192:195], v[176:179]
    s_waitcnt lgkmcnt(5)
    ds_read_b64_tr_b16 a[170:171], v222 offset:50176
    v_cvt_pk_bf16_f32 v193, v166, v167
    v_mfma_f32_16x16x32_bf16 v[76:79], a[160:163], a[32:35], v[76:79]
    s_waitcnt lgkmcnt(4)
    ds_read_b64_tr_b16 a[172:173], v223 offset:49152
    ds_read_b64_tr_b16 a[174:175], v223 offset:50176
    v_mfma_f32_16x16x32_bf16 v[76:79], a[164:167], a[36:39], v[76:79]
    v_exp_f32 v172, v172
    v_mfma_f32_16x16x32_bf16 v[108:111], a[164:167], a[100:103], v[108:111]
    buffer_load_dwordx4 v246, s[20:23], s43 offen offset:0  lds
    v_mfma_f32_16x16x32_bf16 v[108:111], a[160:163], a[96:99], v[108:111]
    s_waitcnt lgkmcnt(5)
    ds_read_b64_tr_b16 a[128:129], v224 offset:49152
    ds_read_b64_tr_b16 a[130:131], v224 offset:50176
    v_mfma_f32_16x16x32_bf16 v[140:143], a[160:163], a[232:235], v[140:143]
    s_waitcnt lgkmcnt(6)
    ds_read_b64_tr_b16 a[132:133], v225 offset:49152
    ds_read_b64_tr_b16 a[134:135], v225 offset:50176
    v_mfma_f32_16x16x32_bf16 v[140:143], a[164:167], a[236:239], v[140:143]
    s_waitcnt lgkmcnt(6)
    s_add_u32 s43, s58, 556288
    ds_read_b64_tr_b16 a[136:137], v226 offset:49152
    v_mfma_f32_16x16x32_bf16 v[4:7], a[168:171], v[184:187], v[4:7]
    buffer_load_dwordx4 v246, s[20:23], s43 offen offset:1024  lds
    v_mfma_f32_16x16x32_bf16 v[36:39], a[168:171], v[188:191], v[36:39]
    s_waitcnt lgkmcnt(5)
    v_exp_f32 v173, v173
    v_mfma_f32_16x16x32_bf16 v[8:11], a[172:175], v[184:187], v[8:11]
    s_add_u32 s43, s58, 588032
    ds_read_b64_tr_b16 a[138:139], v226 offset:50176
    v_cvt_pk_bf16_f32 v194, v172, v173
    v_mfma_f32_16x16x32_bf16 v[40:43], a[172:175], v[188:191], v[40:43]
    buffer_load_dwordx4 v246, s[20:23], s43 offen offset:2048  lds
    v_mfma_f32_16x16x32_bf16 a[244:247], a[240:243], v[184:187], a[244:247]
    s_waitcnt lgkmcnt(4)
    ds_read_b64_tr_b16 a[140:141], v227 offset:49152
    ds_read_b64_tr_b16 a[142:143], v227 offset:50176
    v_mfma_f32_16x16x32_bf16 v[12:15], a[128:131], v[184:187], v[12:15]
    s_add_u32 m0, s39, 16384
    ds_read_b128 a[224:227], v242 offset:18432
    ds_read_b64_tr_b16 a[144:145], v231 offset:0
    v_mfma_f32_16x16x32_bf16 v[44:47], a[128:131], v[188:191], v[44:47]
    s_waitcnt lgkmcnt(6)
    s_add_u32 s43, s40, 81920
    ds_read_b64_tr_b16 a[146:147], v231 offset:1024
    v_mfma_f32_16x16x32_bf16 v[16:19], a[132:135], v[184:187], v[16:19]
    buffer_load_dwordx4 v244, s[12:15], s43 offen offset:0 nt lds
    v_mfma_f32_16x16x32_bf16 v[48:51], a[132:135], v[188:191], v[48:51]
    s_add_u32 m0, s39, 68608
    ds_read_b64_tr_b16 a[148:149], v231 offset:2048
    ds_read_b64_tr_b16 a[150:151], v231 offset:3072
    v_mfma_f32_16x16x32_bf16 a[248:251], a[240:243], v[188:191], a[248:251]
    s_waitcnt lgkmcnt(7)
    v_exp_f32 v174, v174
    v_mfma_f32_16x16x32_bf16 v[20:23], a[136:139], v[184:187], v[20:23]
    s_add_u32 s43, s58, 622848
    v_exp_f32 v175, v175
    v_mfma_f32_16x16x32_bf16 v[52:55], a[136:139], v[188:191], v[52:55]
    s_waitcnt lgkmcnt(5)
    ds_read_b64_tr_b16 a[152:153], v228 offset:49152
    v_cvt_pk_bf16_f32 v195, v174, v175
    v_mfma_f32_16x16x32_bf16 v[24:27], a[140:143], v[184:187], v[24:27]
    v_exp_f32 v168, v168
    v_mfma_f32_16x16x32_bf16 v[56:59], a[140:143], v[188:191], v[56:59]
    s_waitcnt lgkmcnt(5)
    buffer_load_dwordx4 v246, s[20:23], s43 offen offset:0  lds
    v_mfma_f32_16x16x32_bf16 a[252:255], a[240:243], a[224:227], a[252:255]
    s_waitcnt lgkmcnt(3)
    ds_read_b64_tr_b16 a[154:155], v228 offset:50176
    v_mfma_f32_16x16x32_bf16 v[80:83], a[144:147], a[32:35], v[80:83]
    s_waitcnt lgkmcnt(2)
    ds_read_b64_tr_b16 a[156:157], v229 offset:49152
    ds_read_b64_tr_b16 a[158:159], v229 offset:50176
    v_mfma_f32_16x16x32_bf16 v[80:83], a[148:151], a[36:39], v[80:83]
    s_add_u32 m0, s39, 17408
    s_add_u32 s43, s40, 82944
    ds_read_b128 a[160:163], v218 offset:32768
    v_mfma_f32_16x16x32_bf16 v[112:115], a[148:151], a[100:103], v[112:115]
    buffer_load_dwordx4 v244, s[12:15], s43 offen offset:0 nt lds
    v_mfma_f32_16x16x32_bf16 v[112:115], a[144:147], a[96:99], v[112:115]
    v_exp_f32 v169, v169
    v_mfma_f32_16x16x32_bf16 v[144:147], a[144:147], a[232:235], v[144:147]
    ds_read_b128 a[164:167], v219 offset:32768
    v_cvt_pk_bf16_f32 v196, v168, v169
    v_mfma_f32_16x16x32_bf16 v[144:147], a[148:151], a[236:239], v[144:147]
    s_waitcnt lgkmcnt(4)
    v_exp_f32 v170, v170
    v_mfma_f32_16x16x32_bf16 v[28:31], a[152:155], v[184:187], v[28:31]
    ds_read_b128 a[168:171], v220 offset:32768
    v_mfma_f32_16x16x32_bf16 v[60:63], a[152:155], v[188:191], v[60:63]
    ds_read_b128 a[172:175], v221 offset:32768
    v_mfma_f32_16x16x32_bf16 v[68:71], a[152:155], a[224:227], v[68:71]
    s_waitcnt lgkmcnt(4)
    ds_read_b128 a[128:131], v214 offset:32768
    v_mfma_f32_16x16x32_bf16 v[32:35], a[156:159], v[184:187], v[32:35]
    ds_read_b128 a[132:135], v215 offset:32768
    v_mfma_f32_16x16x32_bf16 v[64:67], a[156:159], v[188:191], v[64:67]
    ds_read_b128 a[136:139], v216 offset:32768
    v_mfma_f32_16x16x32_bf16 v[72:75], a[156:159], a[224:227], v[72:75]
    s_waitcnt lgkmcnt(6)
    v_exp_f32 v171, v171
    v_mfma_f32_16x16x32_bf16 v[180:183], a[160:163], a[208:211], v[210:213]
    s_waitcnt lgkmcnt(5)
    ds_read_b128 a[140:143], v217 offset:32768
    v_cvt_pk_bf16_f32 v197, v170, v171
    v_mfma_f32_16x16x32_bf16 v[180:183], a[164:167], a[212:215], v[180:183]
    s_waitcnt lgkmcnt(5)
    buffer_load_dwordx4 v244, s[12:15], s43 offen offset:1024 nt lds
    v_mfma_f32_16x16x32_bf16 v[180:183], a[168:171], a[216:219], v[180:183]
    s_waitcnt lgkmcnt(4)
    v_exp_f32 v176, v176
    v_mfma_f32_16x16x32_bf16 v[180:183], a[172:175], a[220:223], v[180:183]
L_pad4:
    s_cbranch_execz L_back1
    s_waitcnt lgkmcnt(3)
    ds_read_b64_tr_b16 a[144:145], v232 offset:0
    ds_read_b64_tr_b16 a[146:147], v232 offset:1024
    v_mfma_f32_16x16x32_bf16 v[148:151], a[128:131], a[176:179], v[202:205]
    s_waitcnt lgkmcnt(4)
    ds_read_b64_tr_b16 a[148:149], v232 offset:2048
    ds_read_b64_tr_b16 a[150:151], v232 offset:3072
    v_mfma_f32_16x16x32_bf16 v[148:151], a[132:135], a[180:183], v[148:151]
    s_waitcnt lgkmcnt(5)
    v_exp_f32 v177, v177
    v_mfma_f32_16x16x32_bf16 v[148:151], a[136:139], a[184:187], v[148:151]
    s_waitcnt lgkmcnt(4)
    ds_read_b128 a[152:155], v214 offset:33792
    v_cvt_pk_bf16_f32 v198, v176, v177
    v_mfma_f32_16x16x32_bf16 v[148:151], a[140:143], a[188:191], v[148:151]
    v_exp_f32 v178, v178
    v_mfma_f32_16x16x32_bf16 v[152:155], a[140:143], a[204:207], v[206:209]
    v_exp_f32 v179, v179
    v_mfma_f32_16x16x32_bf16 v[152:155], a[136:139], a[200:203], v[152:155]
    ds_read_b128 a[156:159], v215 offset:33792
    v_cvt_pk_bf16_f32 v199, v178, v179
    v_mfma_f32_16x16x32_bf16 v[152:155], a[132:135], a[196:199], v[152:155]
    ds_read_b128 a[160:163], v216 offset:33792
    v_mfma_f32_16x16x32_bf16 v[152:155], a[128:131], a[192:195], v[152:155]
    s_waitcnt lgkmcnt(5)
    v_exp_f32 v180, v180
    v_mfma_f32_16x16x32_bf16 v[84:87], a[144:147], a[32:35], v[84:87]
    s_waitcnt lgkmcnt(3)
    ds_read_b128 a[164:167], v217 offset:33792
    v_mfma_f32_16x16x32_bf16 v[84:87], a[148:151], a[36:39], v[84:87]
    v_exp_f32 v181, v181
    v_mfma_f32_16x16x32_bf16 v[116:119], a[148:151], a[100:103], v[116:119]
    buffer_load_dwordx4 v244, s[12:15], s43 offen offset:2048 nt lds
    v_mfma_f32_16x16x32_bf16 v[116:119], a[144:147], a[96:99], v[116:119]
    s_waitcnt lgkmcnt(3)
    ds_read_b64_tr_b16 a[168:169], v233 offset:0
    v_cvt_pk_bf16_f32 v200, v180, v181
    v_mfma_f32_16x16x32_bf16 v[156:159], a[152:155], a[176:179], v[202:205]
    s_waitcnt lgkmcnt(3)
    ds_read_b64_tr_b16 a[170:171], v233 offset:1024
    ds_read_b64_tr_b16 a[172:173], v233 offset:2048
    v_mfma_f32_16x16x32_bf16 v[156:159], a[156:159], a[180:183], v[156:159]
    s_waitcnt lgkmcnt(4)
    v_exp_f32 v182, v182
    v_mfma_f32_16x16x32_bf16 v[156:159], a[160:163], a[184:187], v[156:159]
    s_waitcnt lgkmcnt(3)
    ds_read_b64_tr_b16 a[174:175], v233 offset:3072
    v_mfma_f32_16x16x32_bf16 v[156:159], a[164:167], a[188:191], v[156:159]
    s_add_u32 m0, s39, 81920
    ds_read_b64_tr_b16 a[128:129], v222 offset:51200
    ds_read_b64_tr_b16 a[130:131], v222 offset:52224
    v_mfma_f32_16x16x32_bf16 v[160:163], a[164:167], a[204:207], v[206:209]
    s_add_u32 s43, s40, 81920
    v_exp_f32 v183, v183
    v_mfma_f32_16x16x32_bf16 v[160:163], a[160:163], a[200:203], v[160:163]
    ds_read_b64_tr_b16 a[132:133], v223 offset:51200
    v_cvt_pk_bf16_f32 v201, v182, v183
    v_mfma_f32_16x16x32_bf16 v[160:163], a[156:159], a[196:199], v[160:163]
    v_exp_f32 v148, v148
    v_mfma_f32_16x16x32_bf16 v[160:163], a[152:155], a[192:195], v[160:163]
    s_waitcnt lgkmcnt(5)
    ds_read_b64_tr_b16 a[134:135], v223 offset:52224
    ds_read_b64_tr_b16 a[136:137], v234 offset:0
    v_mfma_f32_16x16x32_bf16 v[88:91], a[168:171], a[32:35], v[88:91]
    s_waitcnt lgkmcnt(5)
    v_exp_f32 v149, v149
    v_mfma_f32_16x16x32_bf16 v[88:91], a[172:175], a[36:39], v[88:91]
    ds_read_b64_tr_b16 a[138:139], v234 offset:1024
    v_cvt_pk_bf16_f32 v184, v148, v149
    v_mfma_f32_16x16x32_bf16 v[120:123], a[172:175], a[100:103], v[120:123]
    ds_read_b64_tr_b16 a[140:141], v234 offset:2048
    ds_read_b64_tr_b16 a[142:143], v234 offset:3072
    v_mfma_f32_16x16x32_bf16 v[120:123], a[168:171], a[96:99], v[120:123]
    s_waitcnt lgkmcnt(6)
    buffer_load_dwordx4 v245, s[16:19], s43 offen offset:0 nt lds
    v_mfma_f32_16x16x32_bf16 v[4:7], a[128:131], v[192:195], v[4:7]
    ds_read_b64_tr_b16 a[144:145], v224 offset:51200
    ds_read_b64_tr_b16 a[146:147], v224 offset:52224
    v_mfma_f32_16x16x32_bf16 v[36:39], a[128:131], v[196:199], v[36:39]
    s_waitcnt lgkmcnt(6)
    v_exp_f32 v150, v150
    v_mfma_f32_16x16x32_bf16 v[8:11], a[132:135], v[192:195], v[8:11]
    ds_read_b64_tr_b16 a[148:149], v225 offset:51200
    ds_read_b64_tr_b16 a[150:151], v225 offset:52224
    v_mfma_f32_16x16x32_bf16 v[40:43], a[132:135], v[196:199], v[40:43]
    v_exp_f32 v151, v151
    v_mfma_f32_16x16x32_bf16 a[244:247], a[240:243], v[192:195], a[244:247]
    s_waitcnt lgkmcnt(6)
    ds_read_b64_tr_b16 a[152:153], v226 offset:51200
    v_cvt_pk_bf16_f32 v185, v150, v151
    v_mfma_f32_16x16x32_bf16 v[92:95], a[136:139], a[32:35], v[92:95]
    s_waitcnt lgkmcnt(5)
    v_exp_f32 v156, v156
    v_mfma_f32_16x16x32_bf16 v[92:95], a[140:143], a[36:39], v[92:95]
    ds_read_b64_tr_b16 a[154:155], v226 offset:52224
    ds_read_b64_tr_b16 a[156:157], v235 offset:0
    v_mfma_f32_16x16x32_bf16 v[124:127], a[140:143], a[100:103], v[124:127]
    v_exp_f32 v157, v157
    v_mfma_f32_16x16x32_bf16 v[124:127], a[136:139], a[96:99], v[124:127]
    s_waitcnt lgkmcnt(5)
    ds_read_b64_tr_b16 a[158:159], v235 offset:1024
    v_cvt_pk_bf16_f32 v186, v156, v157
    v_mfma_f32_16x16x32_bf16 v[12:15], a[144:147], v[192:195], v[12:15]
    ds_read_b64_tr_b16 a[160:161], v235 offset:2048
    ds_read_b64_tr_b16 a[162:163], v235 offset:3072
    v_mfma_f32_16x16x32_bf16 v[44:47], a[144:147], v[196:199], v[44:47]
    s_waitcnt lgkmcnt(6)
    v_exp_f32 v158, v158
    v_mfma_f32_16x16x32_bf16 v[16:19], a[148:151], v[192:195], v[16:19]
    ds_read_b64_tr_b16 a[164:165], v227 offset:51200
    ds_read_b64_tr_b16 a[166:167], v227 offset:52224
    v_mfma_f32_16x16x32_bf16 v[48:51], a[148:151], v[196:199], v[48:51]
    buffer_load_dwordx4 v245, s[16:19], s43 offen offset:1024 nt lds
    v_mfma_f32_16x16x32_bf16 a[248:251], a[240:243], v[196:199], a[248:251]
    s_waitcnt lgkmcnt(6)
    v_exp_f32 v159, v159
    v_mfma_f32_16x16x32_bf16 v[20:23], a[152:155], v[192:195], v[20:23]
    ds_read_b128 a[228:231], v242 offset:19456
    v_cvt_pk_bf16_f32 v187, v158, v159
    v_mfma_f32_16x16x32_bf16 v[52:55], a[152:155], v[196:199], v[52:55]
    s_waitcnt lgkmcnt(5)
    ds_read_b64_tr_b16 a[168:169], v228 offset:51200
    ds_read_b64_tr_b16 a[170:171], v228 offset:52224
    v_mfma_f32_16x16x32_bf16 v[96:99], a[156:159], a[32:35], v[96:99]
    s_waitcnt lgkmcnt(5)
    v_exp_f32 v152, v152
    v_mfma_f32_16x16x32_bf16 v[96:99], a[160:163], a[36:39], v[96:99]
    ds_read_b64_tr_b16 a[172:173], v229 offset:51200
    ds_read_b64_tr_b16 a[174:175], v229 offset:52224
    v_mfma_f32_16x16x32_bf16 v[128:131], a[160:163], a[100:103], v[128:131]
    v_exp_f32 v153, v153
    v_mfma_f32_16x16x32_bf16 v[128:131], a[156:159], a[96:99], v[128:131]
    s_waitcnt lgkmcnt(5)
    ds_read_b64_tr_b16 a[128:129], v236 offset:0
    v_cvt_pk_bf16_f32 v188, v152, v153
    v_mfma_f32_16x16x32_bf16 v[24:27], a[164:167], v[192:195], v[24:27]
    v_exp_f32 v154, v154
    v_mfma_f32_16x16x32_bf16 v[56:59], a[164:167], v[196:199], v[56:59]
    s_waitcnt lgkmcnt(5)
    ds_read_b64_tr_b16 a[130:131], v236 offset:1024
    ds_read_b64_tr_b16 a[132:133], v236 offset:2048
    v_mfma_f32_16x16x32_bf16 a[252:255], a[240:243], a[228:231], a[252:255]
    s_waitcnt lgkmcnt(5)
    v_exp_f32 v155, v155
    v_mfma_f32_16x16x32_bf16 v[28:31], a[168:171], v[192:195], v[28:31]
    ds_read_b64_tr_b16 a[134:135], v236 offset:3072
    v_cvt_pk_bf16_f32 v189, v154, v155
    v_mfma_f32_16x16x32_bf16 v[60:63], a[168:171], v[196:199], v[60:63]
    v_exp_f32 v160, v160
    v_mfma_f32_16x16x32_bf16 v[68:71], a[168:171], a[228:231], v[68:71]
    s_waitcnt lgkmcnt(4)
    buffer_load_dwordx4 v245, s[16:19], s43 offen offset:2048 nt lds
    v_mfma_f32_16x16x32_bf16 v[32:35], a[172:175], v[192:195], v[32:35]
    ds_read_b128 a[136:139], v214 offset:34816
    v_mfma_f32_16x16x32_bf16 v[64:67], a[172:175], v[196:199], v[64:67]
    ds_read_b128 a[140:143], v215 offset:34816
    v_mfma_f32_16x16x32_bf16 v[72:75], a[172:175], a[228:231], v[72:75]
    s_waitcnt lgkmcnt(4)
    ds_read_b128 a[144:147], v216 offset:34816
    v_mfma_f32_16x16x32_bf16 v[100:103], a[128:131], a[32:35], v[100:103]
    s_waitcnt lgkmcnt(3)
    ds_read_b128 a[148:151], v217 offset:34816
    v_mfma_f32_16x16x32_bf16 v[100:103], a[132:135], a[36:39], v[100:103]
    v_exp_f32 v161, v161
    v_mfma_f32_16x16x32_bf16 v[132:135], a[132:135], a[100:103], v[132:135]
    ds_read_b64_tr_b16 a[152:153], v237 offset:0
    v_cvt_pk_bf16_f32 v190, v160, v161
    v_mfma_f32_16x16x32_bf16 v[132:135], a[128:131], a[96:99], v[132:135]
    s_waitcnt lgkmcnt(4)
    v_exp_f32 v162, v162
    v_mfma_f32_16x16x32_bf16 v[164:167], a[136:139], a[176:179], v[202:205]
    s_waitcnt lgkmcnt(3)
    ds_read_b64_tr_b16 a[154:155], v237 offset:1024
    ds_read_b64_tr_b16 a[156:157], v237 offset:2048
    v_mfma_f32_16x16x32_bf16 v[164:167], a[140:143], a[180:183], v[164:167]
    s_waitcnt lgkmcnt(4)
    v_exp_f32 v163, v163
    v_mfma_f32_16x16x32_bf16 v[164:167], a[144:147], a[184:187], v[164:167]
    s_waitcnt lgkmcnt(3)
    ds_read_b64_tr_b16 a[158:159], v237 offset:3072
    v_cvt_pk_bf16_f32 v191, v162, v163
    v_mfma_f32_16x16x32_bf16 v[164:167], a[148:151], a[188:191], v[164:167]
    ds_read_b128 a[160:163], v214 offset:35840
    v_mfma_f32_16x16x32_bf16 v[168:171], a[148:151], a[204:207], v[206:209]
    ds_read_b128 a[164:167], v215 offset:35840
    v_mfma_f32_16x16x32_bf16 v[168:171], a[144:147], a[200:203], v[168:171]
    ds_read_b128 a[168:171], v216 offset:35840
    ds_write_b64 v243, v[200:201] offset:0
    v_mfma_f32_16x16x32_bf16 v[168:171], a[140:143], a[196:199], v[168:171]
    buffer_load_dwordx4 v245, s[16:19], s43 offen offset:3072 nt lds
    v_mfma_f32_16x16x32_bf16 v[168:171], a[136:139], a[192:195], v[168:171]
    s_waitcnt lgkmcnt(6)
    ds_read_b128 a[172:175], v217 offset:35840
    v_mfma_f32_16x16x32_bf16 v[104:107], a[152:155], a[32:35], v[104:107]
    s_waitcnt lgkmcnt(5)
    v_exp_f32 v164, v164
    v_mfma_f32_16x16x32_bf16 v[104:107], a[156:159], a[36:39], v[104:107]
    s_add_u32 m0, s39, 0
    v_exp_f32 v165, v165
    v_mfma_f32_16x16x32_bf16 v[136:139], a[156:159], a[100:103], v[136:139]
    s_add_u32 s43, s59, 256
    v_exp_f32 v166, v166
    v_mfma_f32_16x16x32_bf16 v[136:139], a[152:155], a[96:99], v[136:139]
    s_waitcnt vmcnt(4) lgkmcnt(0)
    s_barrier
    v_mfma_f32_16x16x32_bf16 v[172:175], a[160:163], a[176:179], v[202:205]
    ds_read_b64_tr_b16 a[128:129], v222 offset:0
    v_cvt_pk_bf16_f32 v192, v164, v165
    v_mfma_f32_16x16x32_bf16 v[172:175], a[164:167], a[180:183], v[172:175]
    ds_read_b64_tr_b16 a[130:131], v222 offset:1024
    ds_read_b64_tr_b16 a[132:133], v222 offset:2048
    v_mfma_f32_16x16x32_bf16 v[172:175], a[168:171], a[184:187], v[172:175]
    ds_read_b64_tr_b16 a[134:135], v222 offset:3072
    v_mfma_f32_16x16x32_bf16 v[172:175], a[172:175], a[188:191], v[172:175]
    v_exp_f32 v167, v167
    v_mfma_f32_16x16x32_bf16 v[176:179], a[172:175], a[204:207], v[206:209]
    ds_read_b128 a[232:235], v240 offset:8192
    v_cvt_pk_bf16_f32 v193, v166, v167
    v_mfma_f32_16x16x32_bf16 v[176:179], a[168:171], a[200:203], v[176:179]
    ds_read_b128 a[236:239], v241 offset:8192
    ds_read_b64_tr_b16 a[136:137], v222 offset:32768
    v_mfma_f32_16x16x32_bf16 v[176:179], a[164:167], a[196:199], v[176:179]
    v_exp_f32 v168, v168
    v_mfma_f32_16x16x32_bf16 v[176:179], a[160:163], a[192:195], v[176:179]
    s_waitcnt lgkmcnt(5)
    buffer_load_dwordx4 v246, s[20:23], s43 offen offset:0  lds
    v_mfma_f32_16x16x32_bf16 v[76:79], a[128:131], a[40:43], v[76:79]
    s_waitcnt lgkmcnt(3)
    ds_read_b64_tr_b16 a[138:139], v222 offset:33792
    ds_read_b64_tr_b16 a[140:141], v223 offset:32768
    v_mfma_f32_16x16x32_bf16 v[76:79], a[132:135], a[44:47], v[76:79]
    s_add_u32 s43, s59, 32000
    buffer_load_dword v250, v1, s[84:87], 0 offen offset:0 sc1
    v_mfma_f32_16x16x32_bf16 v[108:111], a[132:135], a[108:111], v[108:111]
    ds_read_b64_tr_b16 a[142:143], v223 offset:33792
    ds_read_b64_tr_b16 a[144:145], v224 offset:32768
    v_mfma_f32_16x16x32_bf16 v[108:111], a[128:131], a[104:107], v[108:111]
    s_waitcnt lgkmcnt(6)
    buffer_load_dwordx4 v246, s[20:23], s43 offen offset:1024  lds
    v_mfma_f32_16x16x32_bf16 v[140:143], a[128:131], a[232:235], v[140:143]
    s_waitcnt lgkmcnt(5)
    ds_read_b64_tr_b16 a[146:147], v224 offset:33792
    ds_read_b64_tr_b16 a[148:149], v225 offset:32768
    v_mfma_f32_16x16x32_bf16 v[140:143], a[132:135], a[236:239], v[140:143]
    s_waitcnt lgkmcnt(5)
    v_exp_f32 v172, v172
    v_mfma_f32_16x16x32_bf16 v[4:7], a[136:139], v[184:187], v[4:7]
    s_add_u32 s43, s59, 63744
    ds_read_b64_tr_b16 a[150:151], v225 offset:33792
    v_mfma_f32_16x16x32_bf16 v[36:39], a[136:139], v[188:191], v[36:39]
    s_waitcnt lgkmcnt(4)
    buffer_load_dwordx4 v246, s[20:23], s43 offen offset:2048  lds
    v_mfma_f32_16x16x32_bf16 v[8:11], a[140:143], v[184:187], v[8:11]
    s_add_u32 m0, s39, 49152
    ds_read_b64_tr_b16 a[152:153], v226 offset:32768
    ds_read_b64_tr_b16 a[154:155], v226 offset:33792
    v_mfma_f32_16x16x32_bf16 v[40:43], a[140:143], v[188:191], v[40:43]
    s_add_u32 s43, s40, 98304
    ds_read_b64_tr_b16 a[156:157], v227 offset:32768
    ds_read_b64_tr_b16 a[158:159], v227 offset:33792
    v_mfma_f32_16x16x32_bf16 a[244:247], a[240:243], v[184:187], a[244:247]
    s_waitcnt lgkmcnt(6)
    buffer_load_dwordx4 v244, s[12:15], s43 offen offset:0 nt lds
    v_mfma_f32_16x16x32_bf16 v[12:15], a[144:147], v[184:187], v[12:15]
    s_add_u32 m0, s39, 3072
    ds_read_b128 a[224:227], v242 offset:16384
    ds_read_b64_tr_b16 a[160:161], v223 offset:0
    v_mfma_f32_16x16x32_bf16 v[44:47], a[144:147], v[188:191], v[44:47]
    s_waitcnt lgkmcnt(6)
    v_exp_f32 v173, v173
    v_mfma_f32_16x16x32_bf16 v[16:19], a[148:151], v[184:187], v[16:19]
    s_add_u32 s43, s59, 98560
    ds_read_b64_tr_b16 a[162:163], v223 offset:1024
    v_cvt_pk_bf16_f32 v194, v172, v173
    v_mfma_f32_16x16x32_bf16 v[48:51], a[148:151], v[188:191], v[48:51]
    ds_read_b64_tr_b16 a[164:165], v223 offset:2048
    ds_read_b64_tr_b16 a[166:167], v223 offset:3072
    v_mfma_f32_16x16x32_bf16 a[248:251], a[240:243], v[188:191], a[248:251]
    s_waitcnt lgkmcnt(7)
    v_exp_f32 v174, v174
    v_mfma_f32_16x16x32_bf16 v[20:23], a[152:155], v[184:187], v[20:23]
    buffer_load_dwordx4 v246, s[20:23], s43 offen offset:0  lds
    v_mfma_f32_16x16x32_bf16 v[52:55], a[152:155], v[188:191], v[52:55]
    s_waitcnt lgkmcnt(5)
    v_exp_f32 v175, v175
    v_mfma_f32_16x16x32_bf16 v[24:27], a[156:159], v[184:187], v[24:27]
    s_add_u32 m0, s39, 50176
    ds_read_b64_tr_b16 a[168:169], v228 offset:32768
    v_cvt_pk_bf16_f32 v195, v174, v175
    v_mfma_f32_16x16x32_bf16 v[56:59], a[156:159], v[188:191], v[56:59]
    s_waitcnt lgkmcnt(5)
    s_add_u32 s43, s40, 99328
    ds_read_b64_tr_b16 a[170:171], v228 offset:33792
    v_mfma_f32_16x16x32_bf16 a[252:255], a[240:243], a[224:227], a[252:255]
    s_waitcnt lgkmcnt(4)
    buffer_load_dwordx4 v244, s[12:15], s43 offen offset:0 nt lds
    v_mfma_f32_16x16x32_bf16 v[80:83], a[160:163], a[40:43], v[80:83]
    s_waitcnt lgkmcnt(2)
    ds_read_b64_tr_b16 a[172:173], v229 offset:32768
    ds_read_b64_tr_b16 a[174:175], v229 offset:33792
    v_mfma_f32_16x16x32_bf16 v[80:83], a[164:167], a[44:47], v[80:83]
    v_exp_f32 v169, v169
    v_mfma_f32_16x16x32_bf16 v[112:115], a[164:167], a[108:111], v[112:115]
    ds_read_b128 a[128:131], v218 offset:16384
    v_cvt_pk_bf16_f32 v196, v168, v169
    v_mfma_f32_16x16x32_bf16 v[112:115], a[160:163], a[104:107], v[112:115]
    v_exp_f32 v170, v170
    v_mfma_f32_16x16x32_bf16 v[144:147], a[160:163], a[232:235], v[144:147]
    v_exp_f32 v171, v171
    v_mfma_f32_16x16x32_bf16 v[144:147], a[164:167], a[236:239], v[144:147]
    s_waitcnt lgkmcnt(3)
    ds_read_b128 a[132:135], v219 offset:16384
    v_cvt_pk_bf16_f32 v197, v170, v171
    v_mfma_f32_16x16x32_bf16 v[28:31], a[168:171], v[184:187], v[28:31]
    ds_read_b128 a[136:139], v220 offset:16384
    v_mfma_f32_16x16x32_bf16 v[60:63], a[168:171], v[188:191], v[60:63]
    ds_read_b128 a[140:143], v221 offset:16384
    v_mfma_f32_16x16x32_bf16 v[68:71], a[168:171], a[224:227], v[68:71]
    s_waitcnt lgkmcnt(4)
    ds_read_b128 a[144:147], v214 offset:16384
    v_mfma_f32_16x16x32_bf16 v[32:35], a[172:175], v[184:187], v[32:35]
    ds_read_b128 a[148:151], v215 offset:16384
    v_mfma_f32_16x16x32_bf16 v[64:67], a[172:175], v[188:191], v[64:67]
    buffer_load_dwordx4 v244, s[12:15], s43 offen offset:1024 nt lds
    v_mfma_f32_16x16x32_bf16 v[72:75], a[172:175], a[224:227], v[72:75]
    s_waitcnt lgkmcnt(5)
    ds_read_b128 a[152:155], v216 offset:16384
    v_mfma_f32_16x16x32_bf16 v[180:183], a[128:131], a[208:211], v[210:213]
    s_waitcnt lgkmcnt(5)
    ds_read_b128 a[156:159], v217 offset:16384
    v_mfma_f32_16x16x32_bf16 v[180:183], a[132:135], a[212:215], v[180:183]
    s_waitcnt lgkmcnt(5)
    v_exp_f32 v176, v176
    v_mfma_f32_16x16x32_bf16 v[180:183], a[136:139], a[216:219], v[180:183]
    s_waitcnt lgkmcnt(4)
    v_exp_f32 v177, v177
    v_mfma_f32_16x16x32_bf16 v[180:183], a[140:143], a[220:223], v[180:183]
    s_waitcnt lgkmcnt(3)
    ds_read_b64_tr_b16 a[160:161], v224 offset:0
    v_cvt_pk_bf16_f32 v198, v176, v177
    v_mfma_f32_16x16x32_bf16 v[148:151], a[144:147], a[176:179], v[202:205]
    s_waitcnt lgkmcnt(3)
    ds_read_b64_tr_b16 a[162:163], v224 offset:1024
    ds_read_b64_tr_b16 a[164:165], v224 offset:2048
    v_mfma_f32_16x16x32_bf16 v[148:151], a[148:151], a[180:183], v[148:151]
    s_waitcnt lgkmcnt(4)
    v_exp_f32 v178, v178
    v_mfma_f32_16x16x32_bf16 v[148:151], a[152:155], a[184:187], v[148:151]
    s_waitcnt lgkmcnt(3)
    ds_read_b64_tr_b16 a[166:167], v224 offset:3072
    v_mfma_f32_16x16x32_bf16 v[148:151], a[156:159], a[188:191], v[148:151]
    v_exp_f32 v179, v179
    v_mfma_f32_16x16x32_bf16 v[152:155], a[156:159], a[204:207], v[206:209]
    ds_read_b128 a[168:171], v214 offset:17408
    v_cvt_pk_bf16_f32 v199, v178, v179
    v_mfma_f32_16x16x32_bf16 v[152:155], a[152:155], a[200:203], v[152:155]
    ds_read_b128 a[172:175], v215 offset:17408
    v_mfma_f32_16x16x32_bf16 v[152:155], a[148:151], a[196:199], v[152:155]
    ds_read_b128 a[128:131], v216 offset:17408
    v_mfma_f32_16x16x32_bf16 v[152:155], a[144:147], a[192:195], v[152:155]
    s_waitcnt lgkmcnt(5)
    v_exp_f32 v180, v180
    v_mfma_f32_16x16x32_bf16 v[84:87], a[160:163], a[40:43], v[84:87]
    s_waitcnt lgkmcnt(3)
    buffer_load_dwordx4 v244, s[12:15], s43 offen offset:2048 nt lds
    v_mfma_f32_16x16x32_bf16 v[84:87], a[164:167], a[44:47], v[84:87]
    s_add_u32 m0, s39, 114688
    ds_read_b128 a[132:135], v217 offset:17408
    v_mfma_f32_16x16x32_bf16 v[116:119], a[164:167], a[108:111], v[116:119]
    s_add_u32 s43, s40, 98304
    v_exp_f32 v181, v181
    v_mfma_f32_16x16x32_bf16 v[116:119], a[160:163], a[104:107], v[116:119]
    s_waitcnt lgkmcnt(3)
    ds_read_b64_tr_b16 a[136:137], v225 offset:0
    v_cvt_pk_bf16_f32 v200, v180, v181
    v_mfma_f32_16x16x32_bf16 v[156:159], a[168:171], a[176:179], v[202:205]
    s_waitcnt lgkmcnt(3)
    ds_read_b64_tr_b16 a[138:139], v225 offset:1024
    ds_read_b64_tr_b16 a[140:141], v225 offset:2048
    v_mfma_f32_16x16x32_bf16 v[156:159], a[172:175], a[180:183], v[156:159]
    s_waitcnt lgkmcnt(4)
    v_exp_f32 v182, v182
    v_mfma_f32_16x16x32_bf16 v[156:159], a[128:131], a[184:187], v[156:159]
    s_waitcnt lgkmcnt(3)
    ds_read_b64_tr_b16 a[142:143], v225 offset:3072
    v_mfma_f32_16x16x32_bf16 v[156:159], a[132:135], a[188:191], v[156:159]
    ds_read_b64_tr_b16 a[144:145], v222 offset:34816
    ds_read_b64_tr_b16 a[146:147], v222 offset:35840
    v_mfma_f32_16x16x32_bf16 v[160:163], a[132:135], a[204:207], v[206:209]
    v_exp_f32 v183, v183
    v_mfma_f32_16x16x32_bf16 v[160:163], a[128:131], a[200:203], v[160:163]
    ds_read_b64_tr_b16 a[148:149], v223 offset:34816
    v_cvt_pk_bf16_f32 v201, v182, v183
    v_mfma_f32_16x16x32_bf16 v[160:163], a[172:175], a[196:199], v[160:163]
    v_exp_f32 v148, v148
    v_mfma_f32_16x16x32_bf16 v[160:163], a[168:171], a[192:195], v[160:163]
    s_waitcnt lgkmcnt(5)
    ds_read_b64_tr_b16 a[150:151], v223 offset:35840
    ds_read_b64_tr_b16 a[152:153], v226 offset:0
    v_mfma_f32_16x16x32_bf16 v[88:91], a[136:139], a[40:43], v[88:91]
    s_waitcnt lgkmcnt(5)
    v_exp_f32 v149, v149
    v_mfma_f32_16x16x32_bf16 v[88:91], a[140:143], a[44:47], v[88:91]
    buffer_load_dwordx4 v245, s[16:19], s43 offen offset:0 nt lds
    v_mfma_f32_16x16x32_bf16 v[120:123], a[140:143], a[108:111], v[120:123]
    ds_read_b64_tr_b16 a[154:155], v226 offset:1024
    v_cvt_pk_bf16_f32 v184, v148, v149
    v_mfma_f32_16x16x32_bf16 v[120:123], a[136:139], a[104:107], v[120:123]
    s_waitcnt lgkmcnt(4)
    ds_read_b64_tr_b16 a[156:157], v226 offset:2048
    ds_read_b64_tr_b16 a[158:159], v226 offset:3072
    v_mfma_f32_16x16x32_bf16 v[4:7], a[144:147], v[192:195], v[4:7]
    ds_read_b64_tr_b16 a[160:161], v224 offset:34816
    ds_read_b64_tr_b16 a[162:163], v224 offset:35840
    v_mfma_f32_16x16x32_bf16 v[36:39], a[144:147], v[196:199], v[36:39]
    s_waitcnt lgkmcnt(6)
    v_exp_f32 v150, v150
    v_mfma_f32_16x16x32_bf16 v[8:11], a[148:151], v[192:195], v[8:11]
    ds_read_b64_tr_b16 a[164:165], v225 offset:34816
    ds_read_b64_tr_b16 a[166:167], v225 offset:35840
    v_mfma_f32_16x16x32_bf16 v[40:43], a[148:151], v[196:199], v[40:43]
    v_exp_f32 v151, v151
    v_mfma_f32_16x16x32_bf16 a[244:247], a[240:243], v[192:195], a[244:247]
    s_waitcnt lgkmcnt(6)
    ds_read_b64_tr_b16 a[168:169], v226 offset:34816
    v_cvt_pk_bf16_f32 v185, v150, v151
    v_mfma_f32_16x16x32_bf16 v[92:95], a[152:155], a[40:43], v[92:95]
    s_waitcnt lgkmcnt(5)
    v_exp_f32 v156, v156
    v_mfma_f32_16x16x32_bf16 v[92:95], a[156:159], a[44:47], v[92:95]
    ds_read_b64_tr_b16 a[170:171], v226 offset:35840
    ds_read_b64_tr_b16 a[172:173], v227 offset:0
    v_mfma_f32_16x16x32_bf16 v[124:127], a[156:159], a[108:111], v[124:127]
    v_exp_f32 v157, v157
    v_mfma_f32_16x16x32_bf16 v[124:127], a[152:155], a[104:107], v[124:127]
    s_waitcnt lgkmcnt(5)
    ds_read_b64_tr_b16 a[174:175], v227 offset:1024
    v_cvt_pk_bf16_f32 v186, v156, v157
    v_mfma_f32_16x16x32_bf16 v[12:15], a[160:163], v[192:195], v[12:15]
    ds_read_b64_tr_b16 a[128:129], v227 offset:2048
    ds_read_b64_tr_b16 a[130:131], v227 offset:3072
    v_mfma_f32_16x16x32_bf16 v[44:47], a[160:163], v[196:199], v[44:47]
    s_waitcnt lgkmcnt(6)
    buffer_load_dwordx4 v245, s[16:19], s43 offen offset:1024 nt lds
    v_mfma_f32_16x16x32_bf16 v[16:19], a[164:167], v[192:195], v[16:19]
    ds_read_b64_tr_b16 a[132:133], v227 offset:34816
    ds_read_b64_tr_b16 a[134:135], v227 offset:35840
    v_mfma_f32_16x16x32_bf16 v[48:51], a[164:167], v[196:199], v[48:51]
    v_exp_f32 v158, v158
    v_mfma_f32_16x16x32_bf16 a[248:251], a[240:243], v[196:199], a[248:251]
    s_waitcnt lgkmcnt(6)
    v_exp_f32 v159, v159
    v_mfma_f32_16x16x32_bf16 v[20:23], a[168:171], v[192:195], v[20:23]
    ds_read_b128 a[228:231], v242 offset:17408
    v_cvt_pk_bf16_f32 v187, v158, v159
    v_mfma_f32_16x16x32_bf16 v[52:55], a[168:171], v[196:199], v[52:55]
    s_waitcnt lgkmcnt(5)
    ds_read_b64_tr_b16 a[136:137], v228 offset:34816
    ds_read_b64_tr_b16 a[138:139], v228 offset:35840
    v_mfma_f32_16x16x32_bf16 v[96:99], a[172:175], a[40:43], v[96:99]
    s_waitcnt lgkmcnt(5)
    v_exp_f32 v152, v152
    v_mfma_f32_16x16x32_bf16 v[96:99], a[128:131], a[44:47], v[96:99]
    ds_read_b64_tr_b16 a[140:141], v229 offset:34816
    ds_read_b64_tr_b16 a[142:143], v229 offset:35840
    v_mfma_f32_16x16x32_bf16 v[128:131], a[128:131], a[108:111], v[128:131]
    v_exp_f32 v153, v153
    v_mfma_f32_16x16x32_bf16 v[128:131], a[172:175], a[104:107], v[128:131]
    s_waitcnt lgkmcnt(5)
    ds_read_b64_tr_b16 a[144:145], v228 offset:0
    v_cvt_pk_bf16_f32 v188, v152, v153
    v_mfma_f32_16x16x32_bf16 v[24:27], a[132:135], v[192:195], v[24:27]
    v_exp_f32 v154, v154
    v_mfma_f32_16x16x32_bf16 v[56:59], a[132:135], v[196:199], v[56:59]
    s_waitcnt lgkmcnt(5)
    ds_read_b64_tr_b16 a[146:147], v228 offset:1024
    ds_read_b64_tr_b16 a[148:149], v228 offset:2048
    v_mfma_f32_16x16x32_bf16 a[252:255], a[240:243], a[228:231], a[252:255]
    s_waitcnt lgkmcnt(5)
    v_exp_f32 v155, v155
    v_mfma_f32_16x16x32_bf16 v[28:31], a[136:139], v[192:195], v[28:31]
    buffer_load_dwordx4 v245, s[16:19], s43 offen offset:2048 nt lds
    v_mfma_f32_16x16x32_bf16 v[60:63], a[136:139], v[196:199], v[60:63]
    ds_read_b64_tr_b16 a[150:151], v228 offset:3072
    v_cvt_pk_bf16_f32 v189, v154, v155
    v_mfma_f32_16x16x32_bf16 v[68:71], a[136:139], a[228:231], v[68:71]
    s_waitcnt lgkmcnt(4)
    ds_read_b128 a[152:155], v214 offset:18432
    v_mfma_f32_16x16x32_bf16 v[32:35], a[140:143], v[192:195], v[32:35]
    ds_read_b128 a[156:159], v215 offset:18432
    v_mfma_f32_16x16x32_bf16 v[64:67], a[140:143], v[196:199], v[64:67]
    ds_read_b128 a[160:163], v216 offset:18432
    v_mfma_f32_16x16x32_bf16 v[72:75], a[140:143], a[228:231], v[72:75]
    s_waitcnt lgkmcnt(5)
    v_exp_f32 v160, v160
    v_mfma_f32_16x16x32_bf16 v[100:103], a[144:147], a[40:43], v[100:103]
    s_waitcnt lgkmcnt(3)
    ds_read_b128 a[164:167], v217 offset:18432
    v_mfma_f32_16x16x32_bf16 v[100:103], a[148:151], a[44:47], v[100:103]
    v_exp_f32 v161, v161
    v_mfma_f32_16x16x32_bf16 v[132:135], a[148:151], a[108:111], v[132:135]
    ds_read_b64_tr_b16 a[168:169], v229 offset:0
    v_cvt_pk_bf16_f32 v190, v160, v161
    v_mfma_f32_16x16x32_bf16 v[132:135], a[144:147], a[104:107], v[132:135]
    s_waitcnt lgkmcnt(4)
    v_exp_f32 v162, v162
    v_mfma_f32_16x16x32_bf16 v[164:167], a[152:155], a[176:179], v[202:205]
    s_waitcnt lgkmcnt(3)
    ds_read_b64_tr_b16 a[170:171], v229 offset:1024
    ds_read_b64_tr_b16 a[172:173], v229 offset:2048
    v_mfma_f32_16x16x32_bf16 v[164:167], a[156:159], a[180:183], v[164:167]
    s_waitcnt lgkmcnt(4)
    v_exp_f32 v163, v163
    v_mfma_f32_16x16x32_bf16 v[164:167], a[160:163], a[184:187], v[164:167]
    s_waitcnt lgkmcnt(3)
    ds_read_b64_tr_b16 a[174:175], v229 offset:3072
    v_cvt_pk_bf16_f32 v191, v162, v163
    v_mfma_f32_16x16x32_bf16 v[164:167], a[164:167], a[188:191], v[164:167]
    buffer_load_dwordx4 v245, s[16:19], s43 offen offset:3072 nt lds
    v_mfma_f32_16x16x32_bf16 v[168:171], a[164:167], a[204:207], v[206:209]
    s_add_u32 m0, s39, 65536
    ds_read_b128 a[128:131], v214 offset:19456
    v_mfma_f32_16x16x32_bf16 v[168:171], a[160:163], a[200:203], v[168:171]
    s_add_u32 s43, s59, 524544
    ds_read_b128 a[132:135], v215 offset:19456
    ds_write_b64 v243, v[200:201] offset:2048
    v_mfma_f32_16x16x32_bf16 v[168:171], a[156:159], a[196:199], v[168:171]
    ds_read_b128 a[136:139], v216 offset:19456
    v_mfma_f32_16x16x32_bf16 v[168:171], a[152:155], a[192:195], v[168:171]
    s_waitcnt lgkmcnt(6)
    ds_read_b128 a[140:143], v217 offset:19456
    v_mfma_f32_16x16x32_bf16 v[104:107], a[168:171], a[40:43], v[104:107]
    s_waitcnt lgkmcnt(5)
    v_exp_f32 v164, v164
    v_mfma_f32_16x16x32_bf16 v[104:107], a[172:175], a[44:47], v[104:107]
    v_exp_f32 v165, v165
    v_mfma_f32_16x16x32_bf16 v[136:139], a[172:175], a[108:111], v[136:139]
    v_exp_f32 v166, v166
    v_mfma_f32_16x16x32_bf16 v[136:139], a[168:171], a[104:107], v[136:139]
    s_waitcnt vmcnt(4) lgkmcnt(0)
    s_barrier
    v_mfma_f32_16x16x32_bf16 v[172:175], a[128:131], a[176:179], v[202:205]
    ds_read_b64_tr_b16 a[144:145], v230 offset:0
    v_cvt_pk_bf16_f32 v192, v164, v165
    v_mfma_f32_16x16x32_bf16 v[172:175], a[132:135], a[180:183], v[172:175]
    ds_read_b64_tr_b16 a[146:147], v230 offset:1024
    ds_read_b64_tr_b16 a[148:149], v230 offset:2048
    v_mfma_f32_16x16x32_bf16 v[172:175], a[136:139], a[184:187], v[172:175]
    ds_read_b64_tr_b16 a[150:151], v230 offset:3072
    v_mfma_f32_16x16x32_bf16 v[172:175], a[140:143], a[188:191], v[172:175]
    v_exp_f32 v167, v167
    v_mfma_f32_16x16x32_bf16 v[176:179], a[140:143], a[204:207], v[206:209]
    buffer_load_dwordx4 v246, s[20:23], s43 offen offset:0  lds
    v_mfma_f32_16x16x32_bf16 v[176:179], a[136:139], a[200:203], v[176:179]
    s_add_u32 s43, s59, 556288
    ds_read_b128 a[232:235], v238 offset:12288
    v_cvt_pk_bf16_f32 v193, v166, v167
    v_mfma_f32_16x16x32_bf16 v[176:179], a[132:135], a[196:199], v[176:179]
    ds_read_b128 a[236:239], v239 offset:12288
    ds_read_b64_tr_b16 a[152:153], v222 offset:16384
    v_mfma_f32_16x16x32_bf16 v[176:179], a[128:131], a[192:195], v[176:179]
    s_waitcnt lgkmcnt(5)
    ds_read_b64_tr_b16 a[154:155], v222 offset:17408
    ds_read_b64_tr_b16 a[156:157], v223 offset:16384
    v_mfma_f32_16x16x32_bf16 v[76:79], a[144:147], a[48:51], v[76:79]
    s_waitcnt lgkmcnt(5)
    buffer_load_dwordx4 v246, s[20:23], s43 offen offset:1024  lds
    v_mfma_f32_16x16x32_bf16 v[76:79], a[148:151], a[52:55], v[76:79]
    s_add_u32 s43, s59, 588032
    ds_read_b64_tr_b16 a[158:159], v223 offset:17408
    v_mfma_f32_16x16x32_bf16 v[108:111], a[148:151], a[116:119], v[108:111]
    ds_read_b64_tr_b16 a[160:161], v224 offset:16384
    ds_read_b64_tr_b16 a[162:163], v224 offset:17408
    v_mfma_f32_16x16x32_bf16 v[108:111], a[144:147], a[112:115], v[108:111]
    s_waitcnt lgkmcnt(7)
    v_exp_f32 v172, v172
    v_mfma_f32_16x16x32_bf16 v[140:143], a[144:147], a[232:235], v[140:143]
    s_waitcnt lgkmcnt(6)
    buffer_load_dwordx4 v246, s[20:23], s43 offen offset:2048  lds
    v_mfma_f32_16x16x32_bf16 v[140:143], a[148:151], a[236:239], v[140:143]
    s_waitcnt lgkmcnt(4)
    ds_read_b64_tr_b16 a[164:165], v225 offset:16384
    ds_read_b64_tr_b16 a[166:167], v225 offset:17408
    v_mfma_f32_16x16x32_bf16 v[4:7], a[152:155], v[184:187], v[4:7]
    s_add_u32 m0, s39, 32768
    v_exp_f32 v173, v173
    v_mfma_f32_16x16x32_bf16 v[36:39], a[152:155], v[188:191], v[36:39]
    s_waitcnt lgkmcnt(4)
    s_add_u32 s43, s40, 114688
    ds_read_b64_tr_b16 a[168:169], v226 offset:16384
    v_mfma_f32_16x16x32_bf16 v[8:11], a[156:159], v[184:187], v[8:11]
L_pad5:
    s_cbranch_execz L_back1
    buffer_load_dwordx4 v244, s[12:15], s43 offen offset:0 nt lds
    v_mfma_f32_16x16x32_bf16 v[40:43], a[156:159], v[188:191], v[40:43]
    s_add_u32 m0, s39, 68608
    ds_read_b64_tr_b16 a[170:171], v226 offset:17408
    v_cvt_pk_bf16_f32 v194, v172, v173
    v_mfma_f32_16x16x32_bf16 a[244:247], a[240:243], v[184:187], a[244:247]
    s_waitcnt lgkmcnt(4)
    ds_read_b64_tr_b16 a[172:173], v227 offset:16384
    ds_read_b64_tr_b16 a[174:175], v227 offset:17408
    v_mfma_f32_16x16x32_bf16 v[12:15], a[160:163], v[184:187], v[12:15]
    s_add_u32 s43, s59, 622848
    ds_read_b128 a[224:227], v242 offset:18432
    ds_read_b64_tr_b16 a[128:129], v231 offset:0
    v_mfma_f32_16x16x32_bf16 v[44:47], a[160:163], v[188:191], v[44:47]
    s_waitcnt lgkmcnt(6)
    v_exp_f32 v174, v174
    v_mfma_f32_16x16x32_bf16 v[16:19], a[164:167], v[184:187], v[16:19]
    ds_read_b64_tr_b16 a[130:131], v231 offset:1024
    ds_read_b64_tr_b16 a[132:133], v231 offset:2048
    v_mfma_f32_16x16x32_bf16 v[48:51], a[164:167], v[188:191], v[48:51]
    buffer_load_dwordx4 v246, s[20:23], s43 offen offset:0  lds
    v_mfma_f32_16x16x32_bf16 a[248:251], a[240:243], v[188:191], a[248:251]
    s_waitcnt lgkmcnt(6)
    ds_read_b64_tr_b16 a[134:135], v231 offset:3072
    v_bfe_u32 v246, v245, 8, 2
    v_mfma_f32_16x16x32_bf16 v[20:23], a[168:171], v[184:187], v[20:23]
    s_add_u32 m0, s39, 33792
    ds_read_b64_tr_b16 a[136:137], v228 offset:16384
    v_add_u32 v246, s3, v246
    v_mfma_f32_16x16x32_bf16 v[52:55], a[168:171], v[188:191], v[52:55]
    s_waitcnt lgkmcnt(6)
    s_add_u32 s43, s40, 115712
    ds_read_b64_tr_b16 a[138:139], v228 offset:17408
    v_mfma_f32_16x16x32_bf16 v[24:27], a[172:175], v[184:187], v[24:27]
    s_and_b32 s3, s80, 1024
    buffer_load_dwordx4 v244, s[12:15], s43 offen offset:0 nt lds
    v_mfma_f32_16x16x32_bf16 v[56:59], a[172:175], v[188:191], v[56:59]
    s_waitcnt lgkmcnt(6)
    v_exp_f32 v175, v175
    v_mfma_f32_16x16x32_bf16 a[252:255], a[240:243], a[224:227], a[252:255]
    s_waitcnt lgkmcnt(4)
    ds_read_b64_tr_b16 a[140:141], v229 offset:16384
    v_cvt_pk_bf16_f32 v195, v174, v175
    v_mfma_f32_16x16x32_bf16 v[80:83], a[128:131], a[48:51], v[80:83]
    s_waitcnt lgkmcnt(3)
    v_exp_f32 v168, v168
    v_mfma_f32_16x16x32_bf16 v[80:83], a[132:135], a[52:55], v[80:83]
    s_lshl_b32 s3, s3, 1
    v_exp_f32 v169, v169
    v_mfma_f32_16x16x32_bf16 v[112:115], a[132:135], a[116:119], v[112:115]
    ds_read_b64_tr_b16 a[142:143], v229 offset:17408
    v_cvt_pk_bf16_f32 v196, v168, v169
    v_mfma_f32_16x16x32_bf16 v[112:115], a[128:131], a[112:115], v[112:115]
    v_exp_f32 v170, v170
    v_mfma_f32_16x16x32_bf16 v[144:147], a[128:131], a[232:235], v[144:147]
    ds_read_b128 a[144:147], v218 offset:49152
    v_mfma_f32_16x16x32_bf16 v[144:147], a[132:135], a[236:239], v[144:147]
    s_waitcnt lgkmcnt(3)
    ds_read_b128 a[148:151], v219 offset:49152
    v_mfma_f32_16x16x32_bf16 v[28:31], a[136:139], v[184:187], v[28:31]
    ds_read_b128 a[152:155], v220 offset:49152
    v_mfma_f32_16x16x32_bf16 v[60:63], a[136:139], v[188:191], v[60:63]
    ds_read_b128 a[156:159], v221 offset:49152
    v_mfma_f32_16x16x32_bf16 v[68:71], a[136:139], a[224:227], v[68:71]
    s_waitcnt lgkmcnt(4)
    buffer_load_dwordx4 v244, s[12:15], s43 offen offset:1024 nt lds
    v_mfma_f32_16x16x32_bf16 v[32:35], a[140:143], v[184:187], v[32:35]
    ds_read_b128 a[160:163], v214 offset:49152
    v_mfma_f32_16x16x32_bf16 v[64:67], a[140:143], v[188:191], v[64:67]
    ds_read_b128 a[164:167], v215 offset:49152
    v_mfma_f32_16x16x32_bf16 v[72:75], a[140:143], a[224:227], v[72:75]
    s_waitcnt lgkmcnt(5)
    ds_read_b128 a[168:171], v216 offset:49152
    v_mfma_f32_16x16x32_bf16 v[180:183], a[144:147], a[208:211], v[210:213]
    s_waitcnt lgkmcnt(5)
    ds_read_b128 a[172:175], v217 offset:49152
    v_mfma_f32_16x16x32_bf16 v[180:183], a[148:151], a[212:215], v[180:183]
    s_waitcnt lgkmcnt(5)
    v_exp_f32 v171, v171
    v_mfma_f32_16x16x32_bf16 v[180:183], a[152:155], a[216:219], v[180:183]
    s_waitcnt lgkmcnt(4)
    ds_read_b64_tr_b16 a[128:129], v232 offset:0
    v_cvt_pk_bf16_f32 v197, v170, v171
    v_mfma_f32_16x16x32_bf16 v[180:183], a[156:159], a[220:223], v[180:183]
    s_waitcnt lgkmcnt(4)
    v_cmp_gt_u32 vcc, s101, v250
    s_cbranch_vccnz L_spin_ini
L_ret_ini:
    v_mfma_f32_16x16x32_bf16 v[148:151], a[160:163], a[176:179], v[202:205]
    s_waitcnt lgkmcnt(3)
    ds_read_b64_tr_b16 a[130:131], v232 offset:1024
    v_bfe_u32 v1, v247, 5, 2
    v_mfma_f32_16x16x32_bf16 v[148:151], a[164:167], a[180:183], v[148:151]
    s_waitcnt lgkmcnt(3)
    ds_read_b64_tr_b16 a[132:133], v232 offset:2048
    v_lshlrev_b32 v1, 10, v1
    v_mfma_f32_16x16x32_bf16 v[148:151], a[168:171], a[184:187], v[148:151]
    s_waitcnt lgkmcnt(3)
    ds_read_b64_tr_b16 a[134:135], v232 offset:3072
    v_mfma_f32_16x16x32_bf16 v[148:151], a[172:175], a[188:191], v[148:151]
    v_exp_f32 v176, v176
    v_mfma_f32_16x16x32_bf16 v[152:155], a[172:175], a[204:207], v[206:209]
    ds_read_b128 a[136:139], v214 offset:50176
    v_mfma_f32_16x16x32_bf16 v[152:155], a[168:171], a[200:203], v[152:155]
    buffer_load_dwordx4 v244, s[12:15], s43 offen offset:2048 nt lds
    v_mfma_f32_16x16x32_bf16 v[152:155], a[164:167], a[196:199], v[152:155]
    s_add_u32 m0, s39, 98304
    ds_read_b128 a[140:143], v215 offset:50176
    v_mfma_f32_16x16x32_bf16 v[152:155], a[160:163], a[192:195], v[152:155]
    s_waitcnt lgkmcnt(4)
    ds_read_b128 a[144:147], v216 offset:50176
    v_mfma_f32_16x16x32_bf16 v[84:87], a[128:131], a[48:51], v[84:87]
    s_waitcnt lgkmcnt(3)
    ds_read_b128 a[148:151], v217 offset:50176
    v_mfma_f32_16x16x32_bf16 v[84:87], a[132:135], a[52:55], v[84:87]
    s_add_u32 s43, s40, 114688
    v_exp_f32 v177, v177
    v_mfma_f32_16x16x32_bf16 v[116:119], a[132:135], a[116:119], v[116:119]
    ds_read_b64_tr_b16 a[152:153], v233 offset:0
    v_cvt_pk_bf16_f32 v198, v176, v177
    v_mfma_f32_16x16x32_bf16 v[116:119], a[128:131], a[112:115], v[116:119]
    s_waitcnt lgkmcnt(4)
    v_exp_f32 v178, v178
    v_mfma_f32_16x16x32_bf16 v[156:159], a[136:139], a[176:179], v[202:205]
    s_waitcnt lgkmcnt(3)
    ds_read_b64_tr_b16 a[154:155], v233 offset:1024
    ds_read_b64_tr_b16 a[156:157], v233 offset:2048
    v_mfma_f32_16x16x32_bf16 v[156:159], a[140:143], a[180:183], v[156:159]
    s_waitcnt lgkmcnt(4)
    v_exp_f32 v179, v179
    v_mfma_f32_16x16x32_bf16 v[156:159], a[144:147], a[184:187], v[156:159]
    s_waitcnt lgkmcnt(3)
    ds_read_b64_tr_b16 a[158:159], v233 offset:3072
    v_cvt_pk_bf16_f32 v199, v178, v179
    v_mfma_f32_16x16x32_bf16 v[156:159], a[148:151], a[188:191], v[156:159]
    ds_read_b64_tr_b16 a[160:161], v222 offset:18432
    ds_read_b64_tr_b16 a[162:163], v222 offset:19456
    v_mfma_f32_16x16x32_bf16 v[160:163], a[148:151], a[204:207], v[206:209]
    v_exp_f32 v180, v180
    v_mfma_f32_16x16x32_bf16 v[160:163], a[144:147], a[200:203], v[160:163]
    ds_read_b64_tr_b16 a[164:165], v223 offset:18432
    ds_read_b64_tr_b16 a[166:167], v223 offset:19456
    v_mfma_f32_16x16x32_bf16 v[160:163], a[140:143], a[196:199], v[160:163]
    v_exp_f32 v181, v181
    v_mfma_f32_16x16x32_bf16 v[160:163], a[136:139], a[192:195], v[160:163]
    s_waitcnt lgkmcnt(6)
    buffer_load_dwordx4 v245, s[16:19], s43 offen offset:0 nt lds
    v_mfma_f32_16x16x32_bf16 v[88:91], a[152:155], a[48:51], v[88:91]
    s_waitcnt lgkmcnt(4)
    ds_read_b64_tr_b16 a[168:169], v234 offset:0
    v_cvt_pk_bf16_f32 v200, v180, v181
    v_mfma_f32_16x16x32_bf16 v[88:91], a[156:159], a[52:55], v[88:91]
    ds_read_b64_tr_b16 a[170:171], v234 offset:1024
    ds_read_b64_tr_b16 a[172:173], v234 offset:2048
    v_mfma_f32_16x16x32_bf16 v[120:123], a[156:159], a[116:119], v[120:123]
    v_exp_f32 v182, v182
    v_mfma_f32_16x16x32_bf16 v[120:123], a[152:155], a[112:115], v[120:123]
    s_waitcnt lgkmcnt(5)
    ds_read_b64_tr_b16 a[174:175], v234 offset:3072
    v_mfma_f32_16x16x32_bf16 v[4:7], a[160:163], v[192:195], v[4:7]
    ds_read_b64_tr_b16 a[128:129], v224 offset:18432
    ds_read_b64_tr_b16 a[130:131], v224 offset:19456
    v_mfma_f32_16x16x32_bf16 v[36:39], a[160:163], v[196:199], v[36:39]
    s_waitcnt lgkmcnt(6)
    v_exp_f32 v183, v183
    v_mfma_f32_16x16x32_bf16 v[8:11], a[164:167], v[192:195], v[8:11]
    ds_read_b64_tr_b16 a[132:133], v225 offset:18432
    v_cvt_pk_bf16_f32 v201, v182, v183
    v_mfma_f32_16x16x32_bf16 v[40:43], a[164:167], v[196:199], v[40:43]
    v_exp_f32 v148, v148
    v_mfma_f32_16x16x32_bf16 a[244:247], a[240:243], v[192:195], a[244:247]
    s_waitcnt lgkmcnt(5)
    ds_read_b64_tr_b16 a[134:135], v225 offset:19456
    v_mfma_f32_16x16x32_bf16 v[92:95], a[168:171], a[48:51], v[92:95]
    s_waitcnt lgkmcnt(4)
    ds_read_b64_tr_b16 a[136:137], v226 offset:18432
    ds_read_b64_tr_b16 a[138:139], v226 offset:19456
    v_mfma_f32_16x16x32_bf16 v[92:95], a[172:175], a[52:55], v[92:95]
    v_exp_f32 v149, v149
    v_mfma_f32_16x16x32_bf16 v[124:127], a[172:175], a[116:119], v[124:127]
    ds_read_b64_tr_b16 a[140:141], v235 offset:0
    v_cvt_pk_bf16_f32 v184, v148, v149
    v_mfma_f32_16x16x32_bf16 v[124:127], a[168:171], a[112:115], v[124:127]
    s_waitcnt lgkmcnt(5)
    buffer_load_dwordx4 v245, s[16:19], s43 offen offset:1024 nt lds
    v_mfma_f32_16x16x32_bf16 v[12:15], a[128:131], v[192:195], v[12:15]
    ds_read_b64_tr_b16 a[142:143], v235 offset:1024
    ds_read_b64_tr_b16 a[144:145], v235 offset:2048
    v_mfma_f32_16x16x32_bf16 v[44:47], a[128:131], v[196:199], v[44:47]
    s_waitcnt lgkmcnt(5)
    ds_read_b64_tr_b16 a[146:147], v235 offset:3072
    v_mfma_f32_16x16x32_bf16 v[16:19], a[132:135], v[192:195], v[16:19]
    ds_read_b64_tr_b16 a[148:149], v227 offset:18432
    ds_read_b64_tr_b16 a[150:151], v227 offset:19456
    v_mfma_f32_16x16x32_bf16 v[48:51], a[132:135], v[196:199], v[48:51]
    v_exp_f32 v150, v150
    v_mfma_f32_16x16x32_bf16 a[248:251], a[240:243], v[196:199], a[248:251]
    s_waitcnt lgkmcnt(6)
    v_exp_f32 v151, v151
    v_mfma_f32_16x16x32_bf16 v[20:23], a[136:139], v[192:195], v[20:23]
    ds_read_b128 a[228:231], v242 offset:19456
    v_cvt_pk_bf16_f32 v185, v150, v151
    v_mfma_f32_16x16x32_bf16 v[52:55], a[136:139], v[196:199], v[52:55]
    s_waitcnt lgkmcnt(5)
    ds_read_b64_tr_b16 a[152:153], v228 offset:18432
    ds_read_b64_tr_b16 a[154:155], v228 offset:19456
    v_mfma_f32_16x16x32_bf16 v[96:99], a[140:143], a[48:51], v[96:99]
    s_waitcnt lgkmcnt(5)
    v_exp_f32 v156, v156
    v_mfma_f32_16x16x32_bf16 v[96:99], a[144:147], a[52:55], v[96:99]
    ds_read_b64_tr_b16 a[156:157], v229 offset:18432
    ds_read_b64_tr_b16 a[158:159], v229 offset:19456
    v_mfma_f32_16x16x32_bf16 v[128:131], a[144:147], a[116:119], v[128:131]
    v_exp_f32 v157, v157
    v_mfma_f32_16x16x32_bf16 v[128:131], a[140:143], a[112:115], v[128:131]
    s_waitcnt lgkmcnt(5)
    ds_read_b64_tr_b16 a[160:161], v236 offset:0
    v_cvt_pk_bf16_f32 v186, v156, v157
    v_mfma_f32_16x16x32_bf16 v[24:27], a[148:151], v[192:195], v[24:27]
    v_exp_f32 v158, v158
    v_mfma_f32_16x16x32_bf16 v[56:59], a[148:151], v[196:199], v[56:59]
    s_waitcnt lgkmcnt(5)
    buffer_load_dwordx4 v245, s[16:19], s43 offen offset:2048 nt lds
    v_mfma_f32_16x16x32_bf16 a[252:255], a[240:243], a[228:231], a[252:255]
    s_waitcnt lgkmcnt(3)
    ds_read_b64_tr_b16 a[162:163], v236 offset:1024
    ds_read_b64_tr_b16 a[164:165], v236 offset:2048
    v_mfma_f32_16x16x32_bf16 v[28:31], a[152:155], v[192:195], v[28:31]
    ds_read_b64_tr_b16 a[166:167], v236 offset:3072
    v_mfma_f32_16x16x32_bf16 v[60:63], a[152:155], v[196:199], v[60:63]
    v_exp_f32 v159, v159
    v_mfma_f32_16x16x32_bf16 v[68:71], a[152:155], a[228:231], v[68:71]
    s_waitcnt lgkmcnt(4)
    ds_read_b128 a[168:171], v214 offset:51200
    v_cvt_pk_bf16_f32 v187, v158, v159
    v_mfma_f32_16x16x32_bf16 v[32:35], a[156:159], v[192:195], v[32:35]
    ds_read_b128 a[172:175], v215 offset:51200
    v_mfma_f32_16x16x32_bf16 v[64:67], a[156:159], v[196:199], v[64:67]
    ds_read_b128 a[128:131], v216 offset:51200
    v_mfma_f32_16x16x32_bf16 v[72:75], a[156:159], a[228:231], v[72:75]
    s_waitcnt lgkmcnt(5)
    v_exp_f32 v152, v152
    v_mfma_f32_16x16x32_bf16 v[100:103], a[160:163], a[48:51], v[100:103]
    s_waitcnt lgkmcnt(3)
    ds_read_b128 a[132:135], v217 offset:51200
    v_mfma_f32_16x16x32_bf16 v[100:103], a[164:167], a[52:55], v[100:103]
    v_exp_f32 v153, v153
    v_mfma_f32_16x16x32_bf16 v[132:135], a[164:167], a[116:119], v[132:135]
    ds_read_b64_tr_b16 a[136:137], v237 offset:0
    v_cvt_pk_bf16_f32 v188, v152, v153
    v_mfma_f32_16x16x32_bf16 v[132:135], a[160:163], a[112:115], v[132:135]
    s_waitcnt lgkmcnt(4)
    v_exp_f32 v154, v154
    v_mfma_f32_16x16x32_bf16 v[164:167], a[168:171], a[176:179], v[202:205]
    s_waitcnt lgkmcnt(3)
    ds_read_b64_tr_b16 a[138:139], v237 offset:1024
    ds_read_b64_tr_b16 a[140:141], v237 offset:2048
    v_mfma_f32_16x16x32_bf16 v[164:167], a[172:175], a[180:183], v[164:167]
    s_waitcnt lgkmcnt(4)
    buffer_load_dwordx4 v245, s[16:19], s43 offen offset:3072 nt lds
    v_mfma_f32_16x16x32_bf16 v[164:167], a[128:131], a[184:187], v[164:167]
    s_waitcnt lgkmcnt(3)
    ds_read_b64_tr_b16 a[142:143], v237 offset:3072
    v_mfma_f32_16x16x32_bf16 v[164:167], a[132:135], a[188:191], v[164:167]
    s_add_u32 m0, s39, 16384
    v_exp_f32 v155, v155
    v_mfma_f32_16x16x32_bf16 v[168:171], a[132:135], a[204:207], v[206:209]
    s_add_u32 s43, s40, 131072
    ds_read_b128 a[144:147], v214 offset:52224
    v_cvt_pk_bf16_f32 v189, v154, v155
    v_mfma_f32_16x16x32_bf16 v[168:171], a[128:131], a[200:203], v[168:171]
    ds_read_b128 a[148:151], v215 offset:52224
    ds_write_b64 v243, v[200:201] offset:0
    v_mfma_f32_16x16x32_bf16 v[168:171], a[172:175], a[196:199], v[168:171]
    ds_read_b128 a[152:155], v216 offset:52224
    v_mfma_f32_16x16x32_bf16 v[168:171], a[168:171], a[192:195], v[168:171]
    s_waitcnt lgkmcnt(6)
    ds_read_b128 a[156:159], v217 offset:52224
    v_mfma_f32_16x16x32_bf16 v[104:107], a[136:139], a[48:51], v[104:107]
    s_waitcnt lgkmcnt(5)
    v_exp_f32 v160, v160
    v_mfma_f32_16x16x32_bf16 v[104:107], a[140:143], a[52:55], v[104:107]
    v_exp_f32 v161, v161
    v_mfma_f32_16x16x32_bf16 v[136:139], a[140:143], a[116:119], v[136:139]
    v_exp_f32 v162, v162
    v_mfma_f32_16x16x32_bf16 v[136:139], a[136:139], a[112:115], v[136:139]
    s_waitcnt vmcnt(4) lgkmcnt(0)
    s_barrier
    v_mfma_f32_16x16x32_bf16 v[172:175], a[144:147], a[176:179], v[202:205]
    ds_read_b64_tr_b16 a[160:161], v222 offset:0
    v_cvt_pk_bf16_f32 v190, v160, v161
    v_mfma_f32_16x16x32_bf16 v[172:175], a[148:151], a[180:183], v[172:175]
    ds_read_b64_tr_b16 a[162:163], v222 offset:1024
    ds_read_b64_tr_b16 a[164:165], v222 offset:2048
    v_mfma_f32_16x16x32_bf16 v[172:175], a[152:155], a[184:187], v[172:175]
    buffer_load_dwordx4 v244, s[12:15], s43 offen offset:0 nt lds
    v_mfma_f32_16x16x32_bf16 v[172:175], a[156:159], a[188:191], v[172:175]
    ds_read_b64_tr_b16 a[166:167], v222 offset:3072
    ds_read_b128 a[232:235], v240 offset:12288
    v_mfma_f32_16x16x32_bf16 v[176:179], a[156:159], a[204:207], v[206:209]
    v_exp_f32 v163, v163
    v_mfma_f32_16x16x32_bf16 v[176:179], a[152:155], a[200:203], v[176:179]
    ds_read_b128 a[236:239], v241 offset:12288
    v_cvt_pk_bf16_f32 v191, v162, v163
    v_mfma_f32_16x16x32_bf16 v[176:179], a[148:151], a[196:199], v[176:179]
    ds_read_b64_tr_b16 a[168:169], v222 offset:49152
    v_add_u32 v241, s4, v247
    s_and_b32 s4, s80, 2048
    v_mfma_f32_16x16x32_bf16 v[176:179], a[144:147], a[192:195], v[176:179]
    s_waitcnt lgkmcnt(5)
    ds_read_b64_tr_b16 a[170:171], v222 offset:50176
    ds_read_b64_tr_b16 a[172:173], v223 offset:49152
    v_mfma_f32_16x16x32_bf16 v[76:79], a[160:163], a[56:59], v[76:79]
    s_waitcnt lgkmcnt(5)
    v_exp_f32 v164, v164
    v_mfma_f32_16x16x32_bf16 v[76:79], a[164:167], a[60:63], v[76:79]
    s_lshl_b32 s4, s4, 5
    ds_read_b64_tr_b16 a[174:175], v223 offset:50176
    v_mfma_f32_16x16x32_bf16 v[108:111], a[164:167], a[124:127], v[108:111]
    s_or_b32 s3, s3, s4
    ds_read_b64_tr_b16 a[128:129], v224 offset:49152
    ds_read_b64_tr_b16 a[130:131], v224 offset:50176
    v_mfma_f32_16x16x32_bf16 v[108:111], a[160:163], a[120:123], v[108:111]
    s_waitcnt lgkmcnt(7)
    v_exp_f32 v165, v165
    v_mfma_f32_16x16x32_bf16 v[140:143], a[160:163], a[232:235], v[140:143]
    s_waitcnt lgkmcnt(6)
    ds_read_b64_tr_b16 a[132:133], v223 offset:0
    v_cvt_pk_bf16_f32 v192, v164, v165
    v_mfma_f32_16x16x32_bf16 v[140:143], a[164:167], a[236:239], v[140:143]
    s_waitcnt lgkmcnt(5)
    ds_read_b64_tr_b16 a[134:135], v223 offset:1024
    v_mul_f32 v76, s42, v76
    v_mfma_f32_16x16x32_bf16 v[4:7], a[168:171], v[184:187], v[4:7]
    s_xor_b32 s4, s3, 2048
    ds_read_b64_tr_b16 a[136:137], v223 offset:2048
    v_mul_f32 v77, s42, v77
    v_mfma_f32_16x16x32_bf16 v[36:39], a[168:171], v[188:191], v[36:39]
    s_waitcnt lgkmcnt(5)
    buffer_load_dwordx4 v244, s[12:15], s43 offen offset:1024 nt lds
    v_mfma_f32_16x16x32_bf16 v[8:11], a[172:175], v[184:187], v[8:11]
    s_xor_b32 s6, s3, 67584
    ds_read_b64_tr_b16 a[138:139], v223 offset:3072
    v_mul_f32 v78, s42, v78
    v_mfma_f32_16x16x32_bf16 v[40:43], a[172:175], v[188:191], v[40:43]
    ds_read_b64_tr_b16 a[140:141], v225 offset:49152
    v_mul_f32 v140, s42, v140
    v_mfma_f32_16x16x32_bf16 a[244:247], a[240:243], v[184:187], a[244:247]
    s_waitcnt lgkmcnt(5)
    ds_read_b64_tr_b16 a[142:143], v225 offset:50176
    v_mul_f32 v141, s42, v141
    v_mfma_f32_16x16x32_bf16 v[12:15], a[128:131], v[184:187], v[12:15]
    ds_read_b64_tr_b16 a[144:145], v226 offset:49152
    v_mul_f32 v142, s42, v142
    v_mfma_f32_16x16x32_bf16 v[44:47], a[128:131], v[188:191], v[44:47]
    s_waitcnt lgkmcnt(5)
    ds_read_b64_tr_b16 a[146:147], v226 offset:50176
    v_mul_f32 v143, s42, v143
    v_mfma_f32_16x16x32_bf16 v[80:83], a[132:135], a[56:59], v[80:83]
    s_waitcnt lgkmcnt(4)
    ds_read_b64_tr_b16 a[148:149], v227 offset:49152
    v_cvt_pk_bf16_f32 v140, v140, v141
    v_mfma_f32_16x16x32_bf16 v[80:83], a[136:139], a[60:63], v[80:83]
    ds_read_b64_tr_b16 a[150:151], v227 offset:50176
    v_cvt_pk_bf16_f32 v141, v142, v143
    v_mfma_f32_16x16x32_bf16 v[112:115], a[136:139], a[124:127], v[112:115]
    ds_read_b128 a[224:227], v242 offset:16384
    v_mul_f32 v79, s42, v79
    v_mfma_f32_16x16x32_bf16 v[112:115], a[132:135], a[120:123], v[112:115]
    ds_read_b64_tr_b16 a[152:153], v224 offset:0
    v_cvt_pk_bf16_f32 v76, v76, v77
    v_mfma_f32_16x16x32_bf16 v[144:147], a[132:135], a[232:235], v[144:147]
    ds_read_b64_tr_b16 a[154:155], v224 offset:1024
    v_cvt_pk_bf16_f32 v77, v78, v79
    v_mfma_f32_16x16x32_bf16 v[144:147], a[136:139], a[236:239], v[144:147]
    s_waitcnt lgkmcnt(7)
    ds_read_b64_tr_b16 a[156:157], v224 offset:2048
    v_mul_f32 v80, s42, v80
    v_mfma_f32_16x16x32_bf16 v[16:19], a[140:143], v[184:187], v[16:19]
    ds_read_b64_tr_b16 a[158:159], v224 offset:3072
    v_mul_f32 v81, s42, v81
    v_mfma_f32_16x16x32_bf16 v[48:51], a[140:143], v[188:191], v[48:51]
    ds_read_b64_tr_b16 a[160:161], v228 offset:49152
    v_mul_f32 v82, s42, v82
    v_mfma_f32_16x16x32_bf16 a[248:251], a[240:243], v[188:191], a[248:251]
    s_waitcnt lgkmcnt(8)
    buffer_load_dwordx4 v244, s[12:15], s43 offen offset:2048 nt lds
    v_mfma_f32_16x16x32_bf16 v[20:23], a[144:147], v[184:187], v[20:23]
    ds_read_b64_tr_b16 a[162:163], v228 offset:50176
    v_mul_f32 v144, s42, v144
    v_mfma_f32_16x16x32_bf16 v[52:55], a[144:147], v[188:191], v[52:55]
    s_waitcnt lgkmcnt(7)
    ds_read_b64_tr_b16 a[164:165], v225 offset:0
    v_mul_f32 v145, s42, v145
    v_mfma_f32_16x16x32_bf16 v[24:27], a[148:151], v[184:187], v[24:27]
    ds_read_b64_tr_b16 a[166:167], v225 offset:1024
    v_mul_f32 v146, s42, v146
    v_mfma_f32_16x16x32_bf16 v[56:59], a[148:151], v[188:191], v[56:59]
    s_waitcnt lgkmcnt(8)
    ds_read_b64_tr_b16 a[168:169], v225 offset:2048
    v_mul_f32 v147, s42, v147
    v_mfma_f32_16x16x32_bf16 a[252:255], a[240:243], a[224:227], a[252:255]
    s_waitcnt lgkmcnt(7)
    ds_read_b64_tr_b16 a[170:171], v225 offset:3072
    v_cvt_pk_bf16_f32 v142, v144, v145
    v_mfma_f32_16x16x32_bf16 v[84:87], a[152:155], a[56:59], v[84:87]
    s_waitcnt lgkmcnt(6)
    ds_read_b64_tr_b16 a[172:173], v229 offset:49152
    v_cvt_pk_bf16_f32 v143, v146, v147
    v_mfma_f32_16x16x32_bf16 v[84:87], a[156:159], a[60:63], v[84:87]
    ds_read_b64_tr_b16 a[174:175], v229 offset:50176
    v_permlane16_swap_b32 v140, v142
    v_mfma_f32_16x16x32_bf16 v[116:119], a[156:159], a[124:127], v[116:119]
    ds_read_b128 a[128:131], v218 offset:32768
    v_permlane16_swap_b32 v141, v143
    v_mfma_f32_16x16x32_bf16 v[116:119], a[152:155], a[120:123], v[116:119]
    s_waitcnt lgkmcnt(7)
    ds_read_b128 a[132:135], v219 offset:32768
    v_mul_f32 v83, s42, v83
    v_mfma_f32_16x16x32_bf16 v[28:31], a[160:163], v[184:187], v[28:31]
    ds_read_b128 a[136:139], v220 offset:32768
    v_cvt_pk_bf16_f32 v78, v80, v81
    v_mfma_f32_16x16x32_bf16 v[60:63], a[160:163], v[188:191], v[60:63]
    ds_read_b128 a[140:143], v221 offset:32768
    v_cvt_pk_bf16_f32 v79, v82, v83
    v_mfma_f32_16x16x32_bf16 v[68:71], a[160:163], a[224:227], v[68:71]
    s_waitcnt lgkmcnt(8)
    ds_read_b64_tr_b16 a[144:145], v226 offset:0
    v_mul_f32 v108, s42, v108
    v_mfma_f32_16x16x32_bf16 v[88:91], a[164:167], a[56:59], v[88:91]
    s_waitcnt lgkmcnt(7)
    ds_read_b64_tr_b16 a[146:147], v226 offset:1024
    v_mul_f32 v109, s42, v109
    v_mfma_f32_16x16x32_bf16 v[88:91], a[168:171], a[60:63], v[88:91]
    buffer_load_dwordx4 v244, s[12:15], s43 offen offset:3072 nt lds
    v_mfma_f32_16x16x32_bf16 v[120:123], a[168:171], a[124:127], v[120:123]
    s_add_u32 m0, s39, 81920
    ds_read_b64_tr_b16 a[148:149], v226 offset:2048
    v_mul_f32 v110, s42, v110
    v_mfma_f32_16x16x32_bf16 v[120:123], a[164:167], a[120:123], v[120:123]
    s_waitcnt lgkmcnt(7)
    ds_read_b64_tr_b16 a[150:151], v226 offset:3072
    v_mul_f32 v111, s42, v111
    v_mfma_f32_16x16x32_bf16 v[32:35], a[172:175], v[184:187], v[32:35]
    ds_read_b128 a[152:155], v214 offset:32768
    v_mul_f32 v112, s42, v112
    v_mfma_f32_16x16x32_bf16 v[64:67], a[172:175], v[188:191], v[64:67]
    ds_read_b128 a[156:159], v215 offset:32768
    v_mul_f32 v113, s42, v113
    v_mfma_f32_16x16x32_bf16 v[72:75], a[172:175], a[224:227], v[72:75]
    s_waitcnt lgkmcnt(9)
    ds_read_b128 a[160:163], v216 offset:32768
    v_mul_f32 v114, s42, v114
    v_mfma_f32_16x16x32_bf16 v[180:183], a[128:131], a[208:211], v[210:213]
    s_waitcnt lgkmcnt(9)
    ds_read_b128 a[164:167], v217 offset:32768
    v_mul_f32 v115, s42, v115
    v_mfma_f32_16x16x32_bf16 v[180:183], a[132:135], a[212:215], v[180:183]
    s_waitcnt lgkmcnt(9)
    ds_write_b128 v252, v[140:143] offset:24576
    v_cvt_pk_bf16_f32 v108, v108, v109
    v_mfma_f32_16x16x32_bf16 v[180:183], a[136:139], a[216:219], v[180:183]
    s_waitcnt lgkmcnt(9)
    v_cvt_pk_bf16_f32 v109, v110, v111
    v_cvt_pk_bf16_f32 v110, v112, v113
    v_mfma_f32_16x16x32_bf16 v[180:183], a[140:143], a[220:223], v[180:183]
    s_waitcnt lgkmcnt(7)
    ds_read_b64_tr_b16 a[168:169], v227 offset:0
    v_cvt_pk_bf16_f32 v111, v114, v115
    v_mfma_f32_16x16x32_bf16 v[92:95], a[144:147], a[56:59], v[92:95]
    s_waitcnt lgkmcnt(6)
    ds_read_b64_tr_b16 a[170:171], v227 offset:1024
    v_mul_f32 v84, s42, v84
    v_mfma_f32_16x16x32_bf16 v[92:95], a[148:151], a[60:63], v[92:95]
    v_exp_f32 v166, v166
    v_mfma_f32_16x16x32_bf16 v[124:127], a[148:151], a[124:127], v[124:127]
    ds_read_b64_tr_b16 a[172:173], v227 offset:2048
    v_mul_f32 v85, s42, v85
    v_mfma_f32_16x16x32_bf16 v[124:127], a[144:147], a[120:123], v[124:127]
    s_waitcnt lgkmcnt(7)
    v_exp_f32 v167, v167
    v_mfma_f32_16x16x32_bf16 v[148:151], a[152:155], a[176:179], v[202:205]
    s_waitcnt lgkmcnt(6)
    buffer_load_dwordx4 v245, s[16:19], s43 offen offset:0 nt lds
    v_cvt_pk_bf16_f32 v193, v166, v167
    v_mfma_f32_16x16x32_bf16 v[148:151], a[156:159], a[180:183], v[148:151]
    s_waitcnt lgkmcnt(5)
    v_exp_f32 v172, v172
    v_mfma_f32_16x16x32_bf16 v[148:151], a[160:163], a[184:187], v[148:151]
    s_waitcnt lgkmcnt(4)
    ds_read_b64_tr_b16 a[174:175], v227 offset:3072
    v_mul_f32 v86, s42, v86
    v_mfma_f32_16x16x32_bf16 v[148:151], a[164:167], a[188:191], v[148:151]
    v_exp_f32 v173, v173
    v_mfma_f32_16x16x32_bf16 v[152:155], a[164:167], a[204:207], v[206:209]
    ds_read_b64_tr_b16 a[128:129], v228 offset:0
    v_cvt_pk_bf16_f32 v194, v172, v173
    v_mfma_f32_16x16x32_bf16 v[152:155], a[160:163], a[200:203], v[152:155]
    ds_read_b64_tr_b16 a[130:131], v228 offset:1024
    v_mul_f32 v87, s42, v87
    v_mfma_f32_16x16x32_bf16 v[152:155], a[156:159], a[196:199], v[152:155]
    v_exp_f32 v174, v174
    v_mfma_f32_16x16x32_bf16 v[152:155], a[152:155], a[192:195], v[152:155]
    s_waitcnt lgkmcnt(4)
    ds_read_b64_tr_b16 a[132:133], v228 offset:2048
    ds_read_b64_tr_b16 a[134:135], v228 offset:3072
    v_mfma_f32_16x16x32_bf16 v[96:99], a[168:171], a[56:59], v[96:99]
    s_waitcnt lgkmcnt(4)
    v_exp_f32 v175, v175
    v_mfma_f32_16x16x32_bf16 v[96:99], a[172:175], a[60:63], v[96:99]
    v_exp_f32 v168, v168
    v_cvt_pk_bf16_f32 v195, v174, v175
    v_mfma_f32_16x16x32_bf16 v[128:131], a[172:175], a[124:127], v[128:131]
    ds_read_b128 a[136:139], v214 offset:33792
    v_mul_f32 v88, s42, v88
    v_mfma_f32_16x16x32_bf16 v[128:131], a[168:171], a[120:123], v[128:131]
    s_waitcnt lgkmcnt(3)
    ds_read_b128 a[140:143], v215 offset:33792
    v_mul_f32 v89, s42, v89
    v_mfma_f32_16x16x32_bf16 v[100:103], a[128:131], a[56:59], v[100:103]
    s_waitcnt lgkmcnt(2)
    ds_read_b128 a[144:147], v216 offset:33792
    v_exp_f32 v169, v169
    v_mfma_f32_16x16x32_bf16 v[100:103], a[132:135], a[60:63], v[100:103]
    buffer_load_dwordx4 v245, s[16:19], s43 offen offset:1024 nt lds
    v_cvt_pk_bf16_f32 v196, v168, v169
    v_mfma_f32_16x16x32_bf16 v[132:135], a[132:135], a[124:127], v[132:135]
    ds_read_b128 a[148:151], v217 offset:33792
    v_mul_f32 v90, s42, v90
    v_exp_f32 v170, v170
    v_mfma_f32_16x16x32_bf16 v[132:135], a[128:131], a[120:123], v[132:135]
    s_waitcnt lgkmcnt(3)
    v_exp_f32 v171, v171
    v_mfma_f32_16x16x32_bf16 v[156:159], a[136:139], a[176:179], v[202:205]
    s_waitcnt lgkmcnt(2)
    ds_read_b64_tr_b16 a[152:153], v229 offset:0
    v_cvt_pk_bf16_f32 v197, v170, v171
    v_mfma_f32_16x16x32_bf16 v[156:159], a[140:143], a[180:183], v[156:159]
    s_waitcnt lgkmcnt(2)
    ds_read_b64_tr_b16 a[154:155], v229 offset:1024
    v_mul_f32 v91, s42, v91
    v_mfma_f32_16x16x32_bf16 v[156:159], a[144:147], a[184:187], v[156:159]
    s_waitcnt lgkmcnt(2)
    v_exp_f32 v176, v176
    v_mfma_f32_16x16x32_bf16 v[156:159], a[148:151], a[188:191], v[156:159]
    ds_read_b64_tr_b16 a[156:157], v229 offset:2048
    ds_read_b64_tr_b16 a[158:159], v229 offset:3072
    v_mfma_f32_16x16x32_bf16 v[160:163], a[148:151], a[204:207], v[206:209]
    v_exp_f32 v177, v177
    v_mfma_f32_16x16x32_bf16 v[160:163], a[144:147], a[200:203], v[160:163]
    ds_read_b64_tr_b16 a[160:161], v222 offset:51200
    v_cvt_pk_bf16_f32 v198, v176, v177
    v_mfma_f32_16x16x32_bf16 v[160:163], a[140:143], a[196:199], v[160:163]
    ds_read_b64_tr_b16 a[162:163], v222 offset:52224
    v_exp_f32 v178, v178
    v_mfma_f32_16x16x32_bf16 v[160:163], a[136:139], a[192:195], v[160:163]
    s_waitcnt lgkmcnt(4)
    ds_read_b64_tr_b16 a[164:165], v223 offset:51200
    ds_read_b64_tr_b16 a[166:167], v223 offset:52224
    v_mfma_f32_16x16x32_bf16 v[104:107], a[152:155], a[56:59], v[104:107]
    s_waitcnt lgkmcnt(4)
    v_exp_f32 v179, v179
    v_mfma_f32_16x16x32_bf16 v[104:107], a[156:159], a[60:63], v[104:107]
    v_exp_f32 v180, v180
    v_cvt_pk_bf16_f32 v199, v178, v179
    v_mfma_f32_16x16x32_bf16 v[136:139], a[156:159], a[124:127], v[136:139]
    buffer_load_dwordx4 v245, s[16:19], s43 offen offset:2048 nt lds
    v_mfma_f32_16x16x32_bf16 v[136:139], a[152:155], a[120:123], v[136:139]
    s_waitcnt lgkmcnt(2)
    ds_read_b64_tr_b16 a[168:169], v224 offset:51200
    ds_read_b64_tr_b16 a[170:171], v224 offset:52224
    v_mfma_f32_16x16x32_bf16 v[4:7], a[160:163], v[192:195], v[4:7]
    v_exp_f32 v181, v181
    v_mfma_f32_16x16x32_bf16 v[36:39], a[160:163], v[196:199], v[36:39]
    s_waitcnt lgkmcnt(2)
    ds_read_b64_tr_b16 a[172:173], v225 offset:51200
    ds_read_b64_tr_b16 a[174:175], v225 offset:52224
    v_cvt_pk_bf16_f32 v200, v180, v181
    v_mfma_f32_16x16x32_bf16 v[8:11], a[164:167], v[192:195], v[8:11]
    v_exp_f32 v182, v182
    v_cvt_pk_bf16_f32 v84, v84, v85
    v_mfma_f32_16x16x32_bf16 v[40:43], a[164:167], v[196:199], v[40:43]
    ds_read_b64_tr_b16 a[128:129], v226 offset:51200
    v_cvt_pk_bf16_f32 v85, v86, v87
    v_cvt_pk_bf16_f32 v86, v88, v89
    v_mfma_f32_16x16x32_bf16 a[244:247], a[240:243], v[192:195], a[244:247]
    s_waitcnt lgkmcnt(3)
    v_exp_f32 v183, v183
    v_cvt_pk_bf16_f32 v87, v90, v91
    v_mfma_f32_16x16x32_bf16 v[12:15], a[168:171], v[192:195], v[12:15]
    ds_read_b64_tr_b16 a[130:131], v226 offset:52224
    v_cvt_pk_bf16_f32 v201, v182, v183
    v_mul_f32 v116, s42, v116
    v_mul_f32 v117, s42, v117
    v_mfma_f32_16x16x32_bf16 v[44:47], a[168:171], v[196:199], v[44:47]
    s_waitcnt lgkmcnt(2)
    ds_read_b64_tr_b16 a[132:133], v227 offset:51200
    v_mul_f32 v118, s42, v118
    v_mul_f32 v119, s42, v119
    v_mfma_f32_16x16x32_bf16 v[16:19], a[172:175], v[192:195], v[16:19]
    v_exp_f32 v148, v148
    v_mul_f32 v120, s42, v120
    v_mul_f32 v121, s42, v121
    v_mfma_f32_16x16x32_bf16 v[48:51], a[172:175], v[196:199], v[48:51]
    ds_read_b64_tr_b16 a[134:135], v227 offset:52224
    v_mul_f32 v122, s42, v122
    v_mul_f32 v123, s42, v123
    v_mfma_f32_16x16x32_bf16 a[248:251], a[240:243], v[196:199], a[248:251]
    s_waitcnt lgkmcnt(2)
    ds_read_b128 a[228:231], v242 offset:17408
    v_cvt_pk_bf16_f32 v116, v116, v117
    v_cvt_pk_bf16_f32 v117, v118, v119
    v_exp_f32 v149, v149
    v_mfma_f32_16x16x32_bf16 v[20:23], a[128:131], v[192:195], v[20:23]
L_pad6:
    s_cbranch_execz L_back1
    buffer_load_dwordx4 v245, s[16:19], s43 offen offset:3072 nt lds
    ds_read_b64_tr_b16 a[136:137], v228 offset:51200
    v_cvt_pk_bf16_f32 v184, v148, v149
    v_mfma_f32_16x16x32_bf16 v[52:55], a[128:131], v[196:199], v[52:55]
    s_waitcnt lgkmcnt(2)
    ds_read_b64_tr_b16 a[138:139], v228 offset:52224
    v_cvt_pk_bf16_f32 v118, v120, v121
    v_cvt_pk_bf16_f32 v119, v122, v123
    v_mul_f32 v92, s42, v92
    v_mfma_f32_16x16x32_bf16 v[24:27], a[132:135], v[192:195], v[24:27]
    s_add_u32 m0, s39, 0
    v_exp_f32 v150, v150
    v_mul_f32 v93, s42, v93
    v_mul_f32 v94, s42, v94
    v_mfma_f32_16x16x32_bf16 v[56:59], a[132:135], v[196:199], v[56:59]
    s_waitcnt lgkmcnt(2)
    ds_read_b64_tr_b16 a[140:141], v229 offset:51200
    v_mul_f32 v95, s42, v95
    v_mul_f32 v96, s42, v96
    v_exp_f32 v151, v151
    v_mfma_f32_16x16x32_bf16 a[252:255], a[240:243], a[228:231], a[252:255]
    s_waitcnt lgkmcnt(1)
    ds_read_b64_tr_b16 a[142:143], v229 offset:52224
    v_cvt_pk_bf16_f32 v185, v150, v151
    v_mul_f32 v97, s42, v97
    v_mul_f32 v98, s42, v98
    v_mfma_f32_16x16x32_bf16 v[28:31], a[136:139], v[192:195], v[28:31]
    s_add_u32 s43, s40, 147456
    v_exp_f32 v156, v156
    v_mul_f32 v99, s42, v99
    v_cvt_pk_bf16_f32 v92, v92, v93
    v_mfma_f32_16x16x32_bf16 v[60:63], a[136:139], v[196:199], v[60:63]
    ds_read_b128 a[144:147], v214 offset:34816
    v_cvt_pk_bf16_f32 v93, v94, v95
    v_cvt_pk_bf16_f32 v94, v96, v97
    v_cvt_pk_bf16_f32 v95, v98, v99
    v_mfma_f32_16x16x32_bf16 v[68:71], a[136:139], a[228:231], v[68:71]
    s_waitcnt lgkmcnt(1)
    v_exp_f32 v157, v157
    v_mul_f32 v124, s42, v124
    v_mul_f32 v125, s42, v125
    v_mfma_f32_16x16x32_bf16 v[32:35], a[140:143], v[192:195], v[32:35]
    ds_read_b128 a[148:151], v215 offset:34816
    v_cvt_pk_bf16_f32 v186, v156, v157
    v_mul_f32 v126, s42, v126
    v_mul_f32 v127, s42, v127
    v_mfma_f32_16x16x32_bf16 v[64:67], a[140:143], v[196:199], v[64:67]
    ds_read_b128 a[152:155], v216 offset:34816
    v_mul_f32 v128, s42, v128
    v_mul_f32 v129, s42, v129
    v_exp_f32 v158, v158
    v_mfma_f32_16x16x32_bf16 v[72:75], a[140:143], a[228:231], v[72:75]
    s_waitcnt lgkmcnt(2)
    buffer_load_dwordx4 v244, s[12:15], s43 offen offset:0 nt lds
    ds_read_b128 a[156:159], v217 offset:34816
    v_mul_f32 v130, s42, v130
    v_mfma_f32_16x16x32_bf16 v[164:167], a[144:147], a[176:179], v[202:205]
    s_waitcnt lgkmcnt(2)
    v_exp_f32 v159, v159
    v_mul_f32 v131, s42, v131
    v_cvt_pk_bf16_f32 v124, v124, v125
    v_mfma_f32_16x16x32_bf16 v[164:167], a[148:151], a[180:183], v[164:167]
    s_waitcnt lgkmcnt(1)
    v_exp_f32 v152, v152
    v_cvt_pk_bf16_f32 v187, v158, v159
    v_cvt_pk_bf16_f32 v125, v126, v127
    v_mfma_f32_16x16x32_bf16 v[164:167], a[152:155], a[184:187], v[164:167]
    s_waitcnt lgkmcnt(0)
    ds_read_b128 a[160:163], v214 offset:35840
    v_cvt_pk_bf16_f32 v126, v128, v129
    v_cvt_pk_bf16_f32 v127, v130, v131
    v_mul_f32 v100, s42, v100
    v_mfma_f32_16x16x32_bf16 v[164:167], a[156:159], a[188:191], v[164:167]
    ds_read_b128 a[164:167], v215 offset:35840
    v_mul_f32 v101, s42, v101
    v_mul_f32 v102, s42, v102
    v_mul_f32 v103, s42, v103
    v_mfma_f32_16x16x32_bf16 v[168:171], a[156:159], a[204:207], v[206:209]
    v_exp_f32 v153, v153
    v_mul_f32 v104, s42, v104
    v_mul_f32 v105, s42, v105
    v_mfma_f32_16x16x32_bf16 v[168:171], a[152:155], a[200:203], v[168:171]
    ds_read_b128 a[168:171], v216 offset:35840
    ds_write_b64 v243, v[200:201] offset:2048
    v_cvt_pk_bf16_f32 v188, v152, v153
    v_mul_f32 v106, s42, v106
    v_mfma_f32_16x16x32_bf16 v[168:171], a[148:151], a[196:199], v[168:171]
    ds_read_b128 a[172:175], v217 offset:35840
    v_mul_f32 v107, s42, v107
    v_cvt_pk_bf16_f32 v100, v100, v101
    v_exp_f32 v154, v154
    v_mfma_f32_16x16x32_bf16 v[168:171], a[144:147], a[192:195], v[168:171]
    s_waitcnt vmcnt(5) lgkmcnt(0)
    s_barrier
    v_cvt_pk_bf16_f32 v101, v102, v103
    v_cvt_pk_bf16_f32 v102, v104, v105
    v_mfma_f32_16x16x32_bf16 v[172:175], a[160:163], a[176:179], v[202:205]
    v_exp_f32 v155, v155
    v_cvt_pk_bf16_f32 v103, v106, v107
    v_mul_f32 v132, s42, v132
    v_mfma_f32_16x16x32_bf16 v[172:175], a[164:167], a[180:183], v[172:175]
    buffer_load_dwordx4 v244, s[12:15], s43 offen offset:1024 nt lds
    v_cvt_pk_bf16_f32 v189, v154, v155
    v_mul_f32 v133, s42, v133
    v_mfma_f32_16x16x32_bf16 v[172:175], a[168:171], a[184:187], v[172:175]
    v_exp_f32 v160, v160
    v_mul_f32 v134, s42, v134
    v_mul_f32 v135, s42, v135
    v_mfma_f32_16x16x32_bf16 v[172:175], a[172:175], a[188:191], v[172:175]
    ds_read_b64_tr_b16 a[128:129], v222 offset:32768
    v_mul_f32 v136, s42, v136
    v_mul_f32 v137, s42, v137
    v_mul_f32 v138, s42, v138
    v_mfma_f32_16x16x32_bf16 v[176:179], a[172:175], a[204:207], v[206:209]
    ds_read_b64_tr_b16 a[130:131], v222 offset:33792
    v_mul_f32 v139, s42, v139
    v_cvt_pk_bf16_f32 v132, v132, v133
    v_exp_f32 v161, v161
    v_mfma_f32_16x16x32_bf16 v[176:179], a[168:171], a[200:203], v[176:179]
    ds_read_b64_tr_b16 a[132:133], v223 offset:32768
    v_cvt_pk_bf16_f32 v190, v160, v161
    v_cvt_pk_bf16_f32 v133, v134, v135
    v_cvt_pk_bf16_f32 v134, v136, v137
    v_mfma_f32_16x16x32_bf16 v[176:179], a[164:167], a[196:199], v[176:179]
    ds_read_b64_tr_b16 a[134:135], v223 offset:33792
    v_cvt_pk_bf16_f32 v135, v138, v139
    v_permlane16_swap_b32 v76, v78
    v_permlane16_swap_b32 v77, v79
    v_mfma_f32_16x16x32_bf16 v[176:179], a[160:163], a[192:195], v[176:179]
    s_waitcnt lgkmcnt(2)
    v_exp_f32 v162, v162
    v_accvgpr_write_b32 a0, v76
    v_accvgpr_write_b32 a1, v77
    v_mfma_f32_16x16x32_bf16 v[4:7], a[128:131], v[184:187], v[4:7]
    ds_read_b64_tr_b16 a[136:137], v224 offset:32768
    v_exp_f32 v163, v163
    s_nop 0
    v_cvt_pk_bf16_f32 v191, v162, v163
    v_accvgpr_write_b32 a2, v78
    s_nop 0
    v_mfma_f32_16x16x32_bf16 v[36:39], a[128:131], v[188:191], v[36:39]
    s_waitcnt lgkmcnt(1)
    ds_read_b64_tr_b16 a[138:139], v224 offset:33792
    v_accvgpr_write_b32 a3, v79
    v_permlane16_swap_b32 v108, v110
    v_permlane16_swap_b32 v109, v111
    v_mfma_f32_16x16x32_bf16 v[8:11], a[132:135], v[184:187], v[8:11]
    buffer_load_dwordx4 v244, s[12:15], s43 offen offset:2048 nt lds
    ds_read_b64_tr_b16 a[140:141], v225 offset:32768
    v_accvgpr_write_b32 a64, v108
    v_mfma_f32_16x16x32_bf16 v[40:43], a[132:135], v[188:191], v[40:43]
    ds_read_b64_tr_b16 a[142:143], v225 offset:33792
    v_accvgpr_write_b32 a65, v109
    v_accvgpr_write_b32 a66, v110
    v_accvgpr_write_b32 a67, v111
    v_mfma_f32_16x16x32_bf16 a[244:247], a[240:243], v[184:187], a[244:247]
    s_waitcnt lgkmcnt(2)
    ds_read_b64_tr_b16 a[144:145], v226 offset:32768
    v_permlane16_swap_b32 v84, v86
    v_permlane16_swap_b32 v85, v87
    v_mfma_f32_16x16x32_bf16 v[12:15], a[136:139], v[184:187], v[12:15]
    ds_read_b64_tr_b16 a[146:147], v226 offset:33792
    v_accvgpr_write_b32 a4, v84
    v_accvgpr_write_b32 a5, v85
    v_mfma_f32_16x16x32_bf16 v[44:47], a[136:139], v[188:191], v[44:47]
    s_waitcnt lgkmcnt(2)
    ds_read_b64_tr_b16 a[148:149], v227 offset:32768
    v_accvgpr_write_b32 a6, v86
    v_accvgpr_write_b32 a7, v87
    v_mfma_f32_16x16x32_bf16 v[16:19], a[140:143], v[184:187], v[16:19]
    ds_read_b64_tr_b16 a[150:151], v227 offset:33792
    v_permlane16_swap_b32 v116, v118
    v_permlane16_swap_b32 v117, v119
    v_mfma_f32_16x16x32_bf16 v[48:51], a[140:143], v[188:191], v[48:51]
    ds_read_b128 a[224:227], v242 offset:18432
    v_accvgpr_write_b32 a68, v116
    v_accvgpr_write_b32 a69, v117
    v_exp_f32 v164, v164
    v_mfma_f32_16x16x32_bf16 a[248:251], a[240:243], v[188:191], a[248:251]
    s_waitcnt lgkmcnt(3)
    ds_read_b64_tr_b16 a[152:153], v228 offset:32768
    v_accvgpr_write_b32 a70, v118
    v_accvgpr_write_b32 a71, v119
    v_mfma_f32_16x16x32_bf16 v[20:23], a[144:147], v[184:187], v[20:23]
    ds_read_b64_tr_b16 a[154:155], v228 offset:33792
    v_permlane16_swap_b32 v92, v94
    v_permlane16_swap_b32 v93, v95
    v_exp_f32 v165, v165
    v_mfma_f32_16x16x32_bf16 v[52:55], a[144:147], v[188:191], v[52:55]
    s_waitcnt lgkmcnt(3)
    ds_read_b64_tr_b16 a[156:157], v229 offset:32768
    ds_read_b64_tr_b16 a[158:159], v229 offset:33792
    v_accvgpr_write_b32 a8, v92
    v_accvgpr_write_b32 a9, v93
    v_mfma_f32_16x16x32_bf16 v[24:27], a[148:151], v[184:187], v[24:27]
    ds_read_b128 a[16:19], v252 offset:24576
    v_accvgpr_write_b32 a10, v94
    v_accvgpr_write_b32 a11, v95
    v_exp_f32 v166, v166
    v_mfma_f32_16x16x32_bf16 v[56:59], a[148:151], v[188:191], v[56:59]
    s_waitcnt lgkmcnt(5)
    buffer_load_dwordx4 v244, s[12:15], s43 offen offset:3072 nt lds
    ds_read_b128 a[20:23], v253 offset:24576
    v_permlane16_swap_b32 v124, v126
    v_mfma_f32_16x16x32_bf16 a[252:255], a[240:243], a[224:227], a[252:255]
    s_waitcnt lgkmcnt(4)
    ds_read_b128 a[24:27], v254 offset:24576
    v_permlane16_swap_b32 v125, v127
    v_accvgpr_write_b32 a72, v124
    v_accvgpr_write_b32 a73, v125
    v_mfma_f32_16x16x32_bf16 v[28:31], a[152:155], v[184:187], v[28:31]
    s_add_u32 m0, s39, 65536
    ds_read_b128 a[28:31], v255 offset:24576
    v_exp_f32 v167, v167
    v_accvgpr_write_b32 a74, v126
    v_mfma_f32_16x16x32_bf16 v[60:63], a[152:155], v[188:191], v[60:63]
    v_exp_f32 v172, v172
    v_accvgpr_write_b32 a75, v127
    v_permlane16_swap_b32 v100, v102
    v_mfma_f32_16x16x32_bf16 v[68:71], a[152:155], a[224:227], v[68:71]
    s_waitcnt lgkmcnt(4)
    ds_read_b128 a[160:163], v218 offset:16384
    v_permlane16_swap_b32 v101, v103
    v_accvgpr_write_b32 a12, v100
    v_accvgpr_write_b32 a13, v101
    v_mfma_f32_16x16x32_bf16 v[32:35], a[156:159], v[184:187], v[32:35]
    ds_read_b128 a[164:167], v219 offset:16384
    v_accvgpr_write_b32 a14, v102
    v_accvgpr_write_b32 a15, v103
    v_exp_f32 v173, v173
    v_mfma_f32_16x16x32_bf16 v[64:67], a[156:159], v[188:191], v[64:67]
    ds_read_b128 a[168:171], v220 offset:16384
    ds_read_b128 a[172:175], v221 offset:16384
    v_permlane16_swap_b32 v132, v134
    v_permlane16_swap_b32 v133, v135
    v_mfma_f32_16x16x32_bf16 v[72:75], a[156:159], a[224:227], v[72:75]
    s_waitcnt lgkmcnt(3)
    v_accvgpr_write_b32 a76, v132
    v_accvgpr_write_b32 a77, v133
    v_accvgpr_write_b32 a78, v134
    v_accvgpr_write_b32 a79, v135
    s_cmp_eq_u32 s77, -1
    s_cbranch_scc1 L_max1
L_maxret1:
    v_exp_f32 v174, v174
    ds_read_b128 a[128:131], v214 offset:16384
    v_mfma_f32_16x16x32_bf16 v[180:183], a[160:163], a[16:19], v[210:213]
    s_waitcnt lgkmcnt(3)
    ds_read_b128 a[132:135], v215 offset:16384
    v_cvt_pk_bf16_f32 v192, v164, v165
    v_exp_f32 v175, v175
    v_mfma_f32_16x16x32_bf16 v[180:183], a[164:167], a[20:23], v[180:183]
    s_waitcnt lgkmcnt(3)
    buffer_load_dwordx4 v245, s[16:19], s43 offen offset:0 nt lds
    ds_read_b128 a[136:139], v216 offset:16384
    v_mfma_f32_16x16x32_bf16 v[180:183], a[168:171], a[24:27], v[180:183]
    s_waitcnt lgkmcnt(3)
    ds_read_b128 a[140:143], v217 offset:16384
    v_cvt_pk_bf16_f32 v193, v166, v167
    v_exp_f32 v168, v168
    v_mfma_f32_16x16x32_bf16 v[180:183], a[172:175], a[28:31], v[180:183]
    s_waitcnt lgkmcnt(3)
    v_exp_f32 v169, v169
    v_mfma_f32_16x16x32_bf16 v[148:151], a[128:131], a[0:3], v[202:205]
    s_waitcnt lgkmcnt(2)
    ds_read_b128 a[144:147], v214 offset:17408
    v_cvt_pk_bf16_f32 v194, v172, v173
    v_mfma_f32_16x16x32_bf16 v[148:151], a[132:135], a[4:7], v[148:151]
    s_waitcnt lgkmcnt(2)
    v_exp_f32 v170, v170
    v_mfma_f32_16x16x32_bf16 v[148:151], a[136:139], a[8:11], v[148:151]
    s_waitcnt lgkmcnt(1)
    ds_read_b128 a[148:151], v215 offset:17408
    v_cvt_pk_bf16_f32 v195, v174, v175
    v_mfma_f32_16x16x32_bf16 v[148:151], a[140:143], a[12:15], v[148:151]
    v_exp_f32 v171, v171
    v_mfma_f32_16x16x32_bf16 v[152:155], a[140:143], a[76:79], v[206:209]
    ds_read_b128 a[152:155], v216 offset:17408
    v_cvt_pk_bf16_f32 v196, v168, v169
    v_mfma_f32_16x16x32_bf16 v[152:155], a[136:139], a[72:75], v[152:155]
    ds_read_b128 a[156:159], v217 offset:17408
    v_cvt_pk_bf16_f32 v197, v170, v171
    v_mfma_f32_16x16x32_bf16 v[152:155], a[132:135], a[68:71], v[152:155]
    v_exp_f32 v176, v176
    v_mfma_f32_16x16x32_bf16 v[152:155], a[128:131], a[64:67], v[152:155]
    s_waitcnt lgkmcnt(3)
    v_exp_f32 v177, v177
    v_mfma_f32_16x16x32_bf16 v[156:159], a[144:147], a[0:3], v[202:205]
    s_waitcnt lgkmcnt(2)
    ds_read_b64_tr_b16 a[160:161], v222 offset:34816
    v_cvt_pk_bf16_f32 v198, v176, v177
    v_mfma_f32_16x16x32_bf16 v[156:159], a[148:151], a[4:7], v[156:159]
    s_waitcnt lgkmcnt(2)
    v_exp_f32 v178, v178
    v_mfma_f32_16x16x32_bf16 v[156:159], a[152:155], a[8:11], v[156:159]
    s_waitcnt lgkmcnt(1)
    buffer_load_dwordx4 v245, s[16:19], s43 offen offset:1024 nt lds
    ds_read_b64_tr_b16 a[162:163], v222 offset:35840
    v_mfma_f32_16x16x32_bf16 v[156:159], a[156:159], a[12:15], v[156:159]
    ds_read_b64_tr_b16 a[164:165], v223 offset:34816
    ds_read_b64_tr_b16 a[166:167], v223 offset:35840
    v_mfma_f32_16x16x32_bf16 v[160:163], a[156:159], a[76:79], v[206:209]
    v_exp_f32 v179, v179
    v_mfma_f32_16x16x32_bf16 v[160:163], a[152:155], a[72:75], v[160:163]
    v_exp_f32 v180, v180
    v_mfma_f32_16x16x32_bf16 v[160:163], a[148:151], a[68:71], v[160:163]
    ds_read_b64_tr_b16 a[168:169], v224 offset:34816
    ds_read_b64_tr_b16 a[170:171], v224 offset:35840
    v_mfma_f32_16x16x32_bf16 v[160:163], a[144:147], a[64:67], v[160:163]
    s_waitcnt lgkmcnt(4)
    v_exp_f32 v181, v181
    v_mfma_f32_16x16x32_bf16 v[4:7], a[160:163], v[192:195], v[4:7]
    ds_read_b64_tr_b16 a[172:173], v225 offset:34816
    v_cvt_pk_bf16_f32 v199, v178, v179
    s_nop 1
    v_mfma_f32_16x16x32_bf16 v[36:39], a[160:163], v[196:199], v[36:39]
    s_waitcnt lgkmcnt(3)
    ds_read_b64_tr_b16 a[174:175], v225 offset:35840
    v_cvt_pk_bf16_f32 v200, v180, v181
    v_mfma_f32_16x16x32_bf16 v[8:11], a[164:167], v[192:195], v[8:11]
    v_exp_f32 v182, v182
    v_mfma_f32_16x16x32_bf16 v[40:43], a[164:167], v[196:199], v[40:43]
    ds_read_b64_tr_b16 a[128:129], v226 offset:34816
    ds_read_b64_tr_b16 a[130:131], v226 offset:35840
    v_mfma_f32_16x16x32_bf16 a[244:247], a[240:243], v[192:195], a[244:247]
    s_waitcnt lgkmcnt(4)
    v_exp_f32 v183, v183
    v_mfma_f32_16x16x32_bf16 v[12:15], a[168:171], v[192:195], v[12:15]
    ds_read_b64_tr_b16 a[132:133], v227 offset:34816
    ds_read_b64_tr_b16 a[134:135], v227 offset:35840
    v_mfma_f32_16x16x32_bf16 v[44:47], a[168:171], v[196:199], v[44:47]
    s_waitcnt lgkmcnt(4)
    v_exp_f32 v148, v148
    v_mfma_f32_16x16x32_bf16 v[16:19], a[172:175], v[192:195], v[16:19]
    buffer_load_dwordx4 v245, s[16:19], s43 offen offset:2048 nt lds
    v_mfma_f32_16x16x32_bf16 v[48:51], a[172:175], v[196:199], v[48:51]
    ds_read_b128 a[228:231], v242 offset:19456
    ds_read_b64_tr_b16 a[136:137], v228 offset:34816
    v_exp_f32 v149, v149
    v_mfma_f32_16x16x32_bf16 a[248:251], a[240:243], v[196:199], a[248:251]
    s_waitcnt lgkmcnt(4)
    ds_read_b64_tr_b16 a[138:139], v228 offset:35840
    v_accvgpr_read_b32 v238, a244
    v_mfma_f32_16x16x32_bf16 v[20:23], a[128:131], v[192:195], v[20:23]
    v_exp_f32 v150, v150
    v_mfma_f32_16x16x32_bf16 v[52:55], a[128:131], v[196:199], v[52:55]
    s_waitcnt lgkmcnt(3)
    ds_read_b64_tr_b16 a[140:141], v229 offset:34816
    ds_read_b64_tr_b16 a[142:143], v229 offset:35840
    v_mfma_f32_16x16x32_bf16 v[24:27], a[132:135], v[192:195], v[24:27]
    v_exp_f32 v151, v151
    v_mfma_f32_16x16x32_bf16 v[56:59], a[132:135], v[196:199], v[56:59]
    s_waitcnt lgkmcnt(4)
    v_exp_f32 v156, v156
    v_mfma_f32_16x16x32_bf16 a[252:255], a[240:243], a[228:231], a[252:255]
    s_waitcnt lgkmcnt(2)
    ds_read_b128 a[144:147], v214 offset:18432
    v_subrev_u32 v248, s78, v238
    v_mfma_f32_16x16x32_bf16 v[28:31], a[136:139], v[192:195], v[28:31]
    v_exp_f32 v157, v157
    v_mfma_f32_16x16x32_bf16 v[60:63], a[136:139], v[196:199], v[60:63]
    ds_read_b128 a[148:151], v215 offset:18432
    v_accvgpr_read_b32 v239, a248
    v_mfma_f32_16x16x32_bf16 v[68:71], a[136:139], a[228:231], v[68:71]
    s_waitcnt lgkmcnt(2)
    ds_read_b128 a[152:155], v216 offset:18432
    v_subrev_u32 v249, s78, v239
    v_mfma_f32_16x16x32_bf16 v[32:35], a[140:143], v[192:195], v[32:35]
    ds_read_b128 a[156:159], v217 offset:18432
    v_exp_f32 v158, v158
    v_mfma_f32_16x16x32_bf16 v[64:67], a[140:143], v[196:199], v[64:67]
    v_exp_f32 v159, v159
    v_mfma_f32_16x16x32_bf16 v[72:75], a[140:143], a[228:231], v[72:75]
    s_waitcnt lgkmcnt(3)
    buffer_load_dwordx4 v245, s[16:19], s43 offen offset:3072 nt lds
    v_mfma_f32_16x16x32_bf16 v[164:167], a[144:147], a[0:3], v[202:205]
    s_waitcnt lgkmcnt(2)
    v_exp_f32 v152, v152
    v_mfma_f32_16x16x32_bf16 v[164:167], a[148:151], a[4:7], v[164:167]
    s_waitcnt lgkmcnt(1)
    ds_read_b128 a[160:163], v214 offset:19456
    v_accvgpr_read_b32 v240, a252
    v_mfma_f32_16x16x32_bf16 v[164:167], a[152:155], a[8:11], v[164:167]
    s_waitcnt lgkmcnt(1)
    ds_read_b128 a[164:167], v215 offset:19456
    v_subrev_u32 v250, s78, v240
    v_mfma_f32_16x16x32_bf16 v[164:167], a[156:159], a[12:15], v[164:167]
    s_add_u32 m0, s39, 49152
    v_exp_f32 v153, v153
    v_mfma_f32_16x16x32_bf16 v[168:171], a[156:159], a[76:79], v[206:209]
    s_add_u32 s43, s40, 163840
    ds_read_b128 a[168:171], v216 offset:19456
    ds_read_b128 a[172:175], v217 offset:19456
    v_cvt_pk_bf16_f32 v201, v182, v183
    v_mfma_f32_16x16x32_bf16 v[168:171], a[152:155], a[72:75], v[168:171]
    ds_write_b64 v243, v[200:201] offset:0
    v_max3_u32 v248, v248, v249, v250
    v_exp_f32 v154, v154
    v_mfma_f32_16x16x32_bf16 v[168:171], a[148:151], a[68:71], v[168:171]
    v_exp_f32 v155, v155
    v_mfma_f32_16x16x32_bf16 v[168:171], a[144:147], a[64:67], v[168:171]
    s_waitcnt vmcnt(4) lgkmcnt(0)
    s_barrier
    v_mfma_f32_16x16x32_bf16 v[172:175], a[160:163], a[0:3], v[202:205]
    v_exp_f32 v160, v160
    v_mfma_f32_16x16x32_bf16 v[172:175], a[164:167], a[4:7], v[172:175]
    ds_read_b64_tr_b16 a[128:129], v222 offset:16384
    ds_read_b64_tr_b16 a[130:131], v222 offset:17408
    v_mfma_f32_16x16x32_bf16 v[172:175], a[168:171], a[8:11], v[172:175]
    v_exp_f32 v161, v161
    v_mfma_f32_16x16x32_bf16 v[172:175], a[172:175], a[12:15], v[172:175]
    ds_read_b64_tr_b16 a[132:133], v223 offset:16384
    ds_read_b64_tr_b16 a[134:135], v223 offset:17408
    v_mfma_f32_16x16x32_bf16 v[176:179], a[172:175], a[76:79], v[206:209]
    buffer_load_dwordx4 v244, s[12:15], s43 offen offset:0 nt lds
    v_mfma_f32_16x16x32_bf16 v[176:179], a[168:171], a[72:75], v[176:179]
    v_exp_f32 v162, v162
    v_cvt_pk_bf16_f32 v184, v148, v149
    v_mfma_f32_16x16x32_bf16 v[176:179], a[164:167], a[68:71], v[176:179]
    ds_read_b64_tr_b16 a[136:137], v224 offset:16384
    v_cvt_pk_bf16_f32 v185, v150, v151
    v_cvt_pk_bf16_f32 v186, v156, v157
    v_mfma_f32_16x16x32_bf16 v[176:179], a[160:163], a[64:67], v[176:179]
    s_waitcnt lgkmcnt(3)
    ds_read_b64_tr_b16 a[138:139], v224 offset:17408
    v_cvt_pk_bf16_f32 v187, v158, v159
    v_cvt_pk_bf16_f32 v188, v152, v153
    s_nop 0
    v_mfma_f32_16x16x32_bf16 v[76:79], a[128:131], v[184:187], 0
    v_cvt_pk_bf16_f32 v189, v154, v155
    v_exp_f32 v163, v163
    v_cvt_pk_bf16_f32 v190, v160, v161
    v_cvt_pk_bf16_f32 v191, v162, v163
    s_nop 1
    v_mfma_f32_16x16x32_bf16 v[108:111], a[128:131], v[188:191], 0
    s_waitcnt lgkmcnt(2)
    ds_read_b64_tr_b16 a[140:141], v225 offset:16384
    ds_read_b64_tr_b16 a[142:143], v225 offset:17408
    v_mfma_f32_16x16x32_bf16 v[80:83], a[132:135], v[184:187], 0
    ds_write_b32 v241, v248
    v_add_u32 v252, s5, v247
    s_xor_b32 s5, s3, 65536
    v_mfma_f32_16x16x32_bf16 v[112:115], a[132:135], v[188:191], 0
    ds_read_b64_tr_b16 a[144:145], v226 offset:16384
    ds_read_b64_tr_b16 a[146:147], v226 offset:17408
    v_mfma_f32_16x16x32_bf16 a[244:247], a[240:243], v[184:187], 0
    s_waitcnt lgkmcnt(5)
    ds_read_b64_tr_b16 a[148:149], v227 offset:16384
    v_lshlrev_b32 v253, 21, v247
    v_mfma_f32_16x16x32_bf16 v[84:87], a[136:139], v[184:187], 0
    ds_read_b64_tr_b16 a[150:151], v227 offset:17408
    v_and_b32 v255, 48, v247
    v_mfma_f32_16x16x32_bf16 v[116:119], a[136:139], v[188:191], 0
    s_waitcnt lgkmcnt(5)
    v_exp_f32 v164, v164
    v_mfma_f32_16x16x32_bf16 v[88:91], a[140:143], v[184:187], 0
    ds_read_b128 a[224:227], v242 offset:16384
    v_max_u32 v255, 16, v255
    v_mfma_f32_16x16x32_bf16 v[120:123], a[140:143], v[188:191], 0
    buffer_load_dwordx4 v244, s[12:15], s43 offen offset:1024 nt lds
    v_mfma_f32_16x16x32_bf16 a[248:251], a[240:243], v[188:191], 0
    s_waitcnt lgkmcnt(3)
    ds_read_b64_tr_b16 a[152:153], v228 offset:16384
    ds_read_b64_tr_b16 a[154:155], v228 offset:17408
    v_exp_f32 v165, v165
    v_mfma_f32_16x16x32_bf16 v[92:95], a[144:147], v[184:187], 0
    v_exp_f32 v166, v166
    v_mfma_f32_16x16x32_bf16 v[124:127], a[144:147], v[188:191], 0
    s_waitcnt lgkmcnt(3)
    ds_read_b64_tr_b16 a[156:157], v229 offset:16384
    ds_read_b64_tr_b16 a[158:159], v229 offset:17408
    v_mfma_f32_16x16x32_bf16 v[96:99], a[148:151], v[184:187], 0
    v_exp_f32 v167, v167
    v_mfma_f32_16x16x32_bf16 v[128:131], a[148:151], v[188:191], 0
    s_waitcnt lgkmcnt(4)
    ds_read_b128 a[160:163], v218 offset:0
    v_lshlrev_b32 v255, 7, v255
    v_mfma_f32_16x16x32_bf16 a[252:255], a[240:243], a[224:227], 0
    s_waitcnt lgkmcnt(3)
    v_exp_f32 v172, v172
    v_mfma_f32_16x16x32_bf16 v[100:103], a[152:155], v[184:187], 0
    ds_read_b128 a[164:167], v219 offset:0
    v_xor_b32 v255, s47, v255
    v_mfma_f32_16x16x32_bf16 v[132:135], a[152:155], v[188:191], 0
    v_exp_f32 v173, v173
    v_mfma_f32_16x16x32_bf16 v[140:143], a[152:155], a[224:227], 0
    s_waitcnt lgkmcnt(2)
    buffer_load_dwordx4 v244, s[12:15], s43 offen offset:2048 nt lds
    ds_read_b128 a[168:171], v220 offset:0
    v_mfma_f32_16x16x32_bf16 v[104:107], a[156:159], v[184:187], 0
    ds_read_b128 a[172:175], v221 offset:0
    v_and_b32 v254, 0xf0, v245
    v_mfma_f32_16x16x32_bf16 v[136:139], a[156:159], v[188:191], 0
    buffer_load_dwordx4 v244, s[12:15], s43 offen offset:3072 nt lds
    v_exp_f32 v174, v174
    v_mfma_f32_16x16x32_bf16 v[144:147], a[156:159], a[224:227], 0
    s_waitcnt lgkmcnt(3)
    ds_read_b128 a[128:131], v214 offset:0
    ds_read_b128 a[132:135], v215 offset:0
    v_lshl_add_u32 v246, v246, 10, v254
    v_mfma_f32_16x16x32_bf16 v[180:183], a[160:163], a[16:19], v[210:213]
    s_waitcnt lgkmcnt(4)
    ds_read_b128 a[136:139], v216 offset:0
    v_exp_f32 v175, v175
    v_mfma_f32_16x16x32_bf16 v[180:183], a[164:167], a[20:23], v[180:183]
    s_waitcnt lgkmcnt(4)
    ds_read_b128 a[140:143], v217 offset:0
    v_cvt_pk_bf16_f32 v192, v164, v165
    v_mfma_f32_16x16x32_bf16 v[180:183], a[168:171], a[24:27], v[180:183]
    s_waitcnt lgkmcnt(4)
    v_exp_f32 v168, v168
    v_mfma_f32_16x16x32_bf16 v[180:183], a[172:175], a[28:31], v[180:183]
    s_waitcnt lgkmcnt(3)
    v_exp_f32 v169, v169
    v_mfma_f32_16x16x32_bf16 v[148:151], a[128:131], a[0:3], v[202:205]
    s_waitcnt lgkmcnt(2)
    ds_read_b128 a[144:147], v214 offset:1024
    v_cvt_pk_bf16_f32 v193, v166, v167
    v_mfma_f32_16x16x32_bf16 v[148:151], a[132:135], a[4:7], v[148:151]
    s_waitcnt lgkmcnt(2)
    v_exp_f32 v170, v170
    v_mfma_f32_16x16x32_bf16 v[148:151], a[136:139], a[8:11], v[148:151]
    s_waitcnt lgkmcnt(1)
    ds_read_b128 a[148:151], v215 offset:1024
    v_cvt_pk_bf16_f32 v194, v172, v173
    v_mfma_f32_16x16x32_bf16 v[148:151], a[140:143], a[12:15], v[148:151]
    s_add_u32 m0, s39, 114688
    v_exp_f32 v171, v171
    v_mfma_f32_16x16x32_bf16 v[152:155], a[140:143], a[76:79], v[206:209]
    ds_read_b128 a[152:155], v216 offset:1024
    v_cvt_pk_bf16_f32 v195, v174, v175
    v_mfma_f32_16x16x32_bf16 v[152:155], a[136:139], a[72:75], v[152:155]
    ds_read_b128 a[156:159], v217 offset:1024
    v_cvt_pk_bf16_f32 v196, v168, v169
    v_rcp_f32 v238, v238
    v_mfma_f32_16x16x32_bf16 v[152:155], a[132:135], a[68:71], v[152:155]
    buffer_load_dwordx4 v245, s[16:19], s43 offen offset:0 nt lds
    v_exp_f32 v176, v176
    v_mul_f32 v4, v238, v4
    v_mul_f32 v5, v238, v5
    v_mfma_f32_16x16x32_bf16 v[152:155], a[128:131], a[64:67], v[152:155]
    s_waitcnt lgkmcnt(3)
    v_exp_f32 v177, v177
    v_mul_f32 v6, v238, v6
    v_mul_f32 v7, v238, v7
    v_mfma_f32_16x16x32_bf16 v[156:159], a[144:147], a[0:3], v[202:205]
    s_waitcnt lgkmcnt(2)
    ds_read_b64_tr_b16 a[160:161], v222 offset:18432
    v_mul_f32 v8, v238, v8
    v_mul_f32 v9, v238, v9
    v_mul_f32 v10, v238, v10
    v_mfma_f32_16x16x32_bf16 v[156:159], a[148:151], a[4:7], v[156:159]
    s_waitcnt lgkmcnt(2)
    v_exp_f32 v178, v178
    v_mul_f32 v11, v238, v11
    v_cvt_pk_bf16_f32 v4, v4, v5
    v_mfma_f32_16x16x32_bf16 v[156:159], a[152:155], a[8:11], v[156:159]
    s_waitcnt lgkmcnt(1)
    ds_read_b64_tr_b16 a[162:163], v222 offset:19456
    v_cvt_pk_bf16_f32 v5, v6, v7
    v_cvt_pk_bf16_f32 v6, v8, v9
    v_cvt_pk_bf16_f32 v7, v10, v11
    v_mfma_f32_16x16x32_bf16 v[156:159], a[156:159], a[12:15], v[156:159]
    ds_read_b64_tr_b16 a[164:165], v223 offset:18432
    ds_read_b64_tr_b16 a[166:167], v223 offset:19456
    v_accvgpr_write_b32 a32, v4
    v_accvgpr_write_b32 a33, v5
    v_mfma_f32_16x16x32_bf16 v[160:163], a[156:159], a[76:79], v[206:209]
    v_exp_f32 v179, v179
    v_accvgpr_write_b32 a34, v6
    v_accvgpr_write_b32 a35, v7
    v_mfma_f32_16x16x32_bf16 v[160:163], a[152:155], a[72:75], v[160:163]
    v_exp_f32 v180, v180
    v_mfma_f32_16x16x32_bf16 v[160:163], a[148:151], a[68:71], v[160:163]
    ds_read_b64_tr_b16 a[168:169], v224 offset:18432
    v_cvt_pk_bf16_f32 v197, v170, v171
    v_mfma_f32_16x16x32_bf16 v[160:163], a[144:147], a[64:67], v[160:163]
    s_waitcnt lgkmcnt(3)
    ds_read_b64_tr_b16 a[170:171], v224 offset:19456
    v_cvt_pk_bf16_f32 v198, v176, v177
    v_mfma_f32_16x16x32_bf16 v[76:79], a[160:163], v[192:195], v[76:79]
    ds_read_b64_tr_b16 a[172:173], v225 offset:18432
    v_cvt_pk_bf16_f32 v199, v178, v179
    v_exp_f32 v181, v181
    s_nop 0
    v_mfma_f32_16x16x32_bf16 v[108:111], a[160:163], v[196:199], v[108:111]
    s_waitcnt lgkmcnt(3)
    buffer_load_dwordx4 v245, s[16:19], s43 offen offset:1024 nt lds
    ds_read_b64_tr_b16 a[174:175], v225 offset:19456
    v_mfma_f32_16x16x32_bf16 v[80:83], a[164:167], v[192:195], v[80:83]
    v_exp_f32 v182, v182
    v_mfma_f32_16x16x32_bf16 v[112:115], a[164:167], v[196:199], v[112:115]
    ds_read_b64_tr_b16 a[128:129], v226 offset:18432
    ds_read_b64_tr_b16 a[130:131], v226 offset:19456
    v_mfma_f32_16x16x32_bf16 a[244:247], a[240:243], v[192:195], a[244:247]
    s_waitcnt lgkmcnt(4)
    v_exp_f32 v183, v183
    v_mfma_f32_16x16x32_bf16 v[84:87], a[168:171], v[192:195], v[84:87]
    ds_read_b64_tr_b16 a[132:133], v227 offset:18432
    ds_read_b64_tr_b16 a[134:135], v227 offset:19456
    v_mfma_f32_16x16x32_bf16 v[116:119], a[168:171], v[196:199], v[116:119]
    s_waitcnt lgkmcnt(4)
    v_exp_f32 v148, v148
    v_mfma_f32_16x16x32_bf16 v[88:91], a[172:175], v[192:195], v[88:91]
    ds_read_b128 a[228:231], v242 offset:17408
    v_cvt_pk_bf16_f32 v200, v180, v181
    v_mfma_f32_16x16x32_bf16 v[120:123], a[172:175], v[196:199], v[120:123]
    v_exp_f32 v149, v149
    v_mfma_f32_16x16x32_bf16 a[248:251], a[240:243], v[196:199], a[248:251]
    s_waitcnt lgkmcnt(3)
    ds_read_b64_tr_b16 a[136:137], v228 offset:18432
    ds_read_b64_tr_b16 a[138:139], v228 offset:19456
    v_mfma_f32_16x16x32_bf16 v[92:95], a[128:131], v[192:195], v[92:95]
    v_exp_f32 v150, v150
    v_mfma_f32_16x16x32_bf16 v[124:127], a[128:131], v[196:199], v[124:127]
    s_waitcnt lgkmcnt(3)
    ds_read_b64_tr_b16 a[140:141], v229 offset:18432
    ds_read_b64_tr_b16 a[142:143], v229 offset:19456
    v_mfma_f32_16x16x32_bf16 v[96:99], a[132:135], v[192:195], v[96:99]
L_pad7:
    s_cbranch_execz L_back1
    buffer_load_dwordx4 v245, s[16:19], s43 offen offset:2048 nt lds
    v_exp_f32 v151, v151
    v_mfma_f32_16x16x32_bf16 v[128:131], a[132:135], v[196:199], v[128:131]
    s_waitcnt lgkmcnt(4)
    v_exp_f32 v156, v156
    v_mfma_f32_16x16x32_bf16 a[252:255], a[240:243], a[228:231], a[252:255]
    s_waitcnt lgkmcnt(2)
    ds_read_b128 a[144:147], v214 offset:2048
    v_cvt_pk_bf16_f32 v201, v182, v183
    v_mfma_f32_16x16x32_bf16 v[100:103], a[136:139], v[192:195], v[100:103]
    v_exp_f32 v157, v157
    v_mfma_f32_16x16x32_bf16 v[132:135], a[136:139], v[196:199], v[132:135]
    ds_read_b128 a[148:151], v215 offset:2048
    v_cvt_pk_bf16_f32 v184, v148, v149
    v_mfma_f32_16x16x32_bf16 v[140:143], a[136:139], a[228:231], v[140:143]
    s_waitcnt lgkmcnt(2)
    ds_read_b128 a[152:155], v216 offset:2048
    v_cvt_pk_bf16_f32 v185, v150, v151
    v_mfma_f32_16x16x32_bf16 v[104:107], a[140:143], v[192:195], v[104:107]
    ds_read_b128 a[156:159], v217 offset:2048
    v_exp_f32 v158, v158
    v_mfma_f32_16x16x32_bf16 v[136:139], a[140:143], v[196:199], v[136:139]
    v_exp_f32 v159, v159
    v_mfma_f32_16x16x32_bf16 v[144:147], a[140:143], a[228:231], v[144:147]
    s_waitcnt lgkmcnt(3)
    ds_read_b128 a[160:163], v214 offset:3072
    v_cvt_pk_bf16_f32 v186, v156, v157
    v_mfma_f32_16x16x32_bf16 v[164:167], a[144:147], a[0:3], v[202:205]
    s_waitcnt lgkmcnt(3)
    v_exp_f32 v152, v152
    v_mfma_f32_16x16x32_bf16 v[164:167], a[148:151], a[4:7], v[164:167]
    s_waitcnt lgkmcnt(2)
    ds_read_b128 a[164:167], v215 offset:3072
    v_cvt_pk_bf16_f32 v187, v158, v159
    v_mfma_f32_16x16x32_bf16 v[164:167], a[152:155], a[8:11], v[164:167]
    s_waitcnt lgkmcnt(2)
    v_exp_f32 v153, v153
    v_mfma_f32_16x16x32_bf16 v[164:167], a[156:159], a[12:15], v[164:167]
    buffer_load_dwordx4 v245, s[16:19], s43 offen offset:3072 nt lds
    v_mfma_f32_16x16x32_bf16 v[168:171], a[156:159], a[76:79], v[206:209]
    s_add_u32 m0, s39, 32768
    ds_read_b128 a[168:171], v216 offset:3072
    ds_write_b64 v243, v[200:201] offset:2048
    ds_read_b128 a[172:175], v217 offset:3072
    v_rcp_f32 v239, v239
    v_mfma_f32_16x16x32_bf16 v[168:171], a[152:155], a[72:75], v[168:171]
    s_add_u32 s43, s40, 180224
    v_exp_f32 v154, v154
    v_mul_f32 v36, v239, v36
    v_mul_f32 v37, v239, v37
    v_mfma_f32_16x16x32_bf16 v[168:171], a[148:151], a[68:71], v[168:171]
    v_exp_f32 v155, v155
    v_mul_f32 v38, v239, v38
    v_mul_f32 v39, v239, v39
    v_mfma_f32_16x16x32_bf16 v[168:171], a[144:147], a[64:67], v[168:171]
    s_mov_b64 exec, 0
    s_cmp_eq_u32 s36, 0
    s_cbranch_scc1 L_pad8
    s_cmp_eq_u32 s36, 1
    s_cbranch_scc1 L_pad9
    s_cmp_eq_u32 s36, 2
    s_cbranch_scc1 L_pad10
    s_branch L_pad11
L_back2:
    s_mov_b64 exec, -1
    s_waitcnt vmcnt(4) lgkmcnt(0)
    s_barrier
    v_mul_f32 v40, v239, v40
    v_mul_f32 v41, v239, v41
    v_mfma_f32_16x16x32_bf16 v[172:175], a[160:163], a[0:3], v[202:205]
    v_exp_f32 v160, v160
    v_mul_f32 v42, v239, v42
    v_mul_f32 v43, v239, v43
    v_mfma_f32_16x16x32_bf16 v[172:175], a[164:167], a[4:7], v[172:175]
    ds_read_b64_tr_b16 a[128:129], v222 offset:0
    ds_read_b64_tr_b16 a[130:131], v222 offset:1024
    v_cvt_pk_bf16_f32 v36, v36, v37
    v_cvt_pk_bf16_f32 v37, v38, v39
    v_mfma_f32_16x16x32_bf16 v[172:175], a[168:171], a[8:11], v[172:175]
    v_exp_f32 v161, v161
    v_cvt_pk_bf16_f32 v38, v40, v41
    v_cvt_pk_bf16_f32 v39, v42, v43
    v_mfma_f32_16x16x32_bf16 v[172:175], a[172:175], a[12:15], v[172:175]
    ds_read_b64_tr_b16 a[132:133], v223 offset:0
    ds_read_b64_tr_b16 a[134:135], v223 offset:1024
    v_accvgpr_write_b32 a48, v36
    v_accvgpr_write_b32 a49, v37
    v_mfma_f32_16x16x32_bf16 v[176:179], a[172:175], a[76:79], v[206:209]
    buffer_load_dwordx4 v244, s[12:15], s43 offen offset:0 nt lds
    v_accvgpr_write_b32 a50, v38
    v_accvgpr_write_b32 a51, v39
    v_mfma_f32_16x16x32_bf16 v[176:179], a[168:171], a[72:75], v[176:179]
    ds_read_b128 v[248:251], v242 offset:28672
    v_exp_f32 v162, v162
    v_mfma_f32_16x16x32_bf16 v[176:179], a[164:167], a[68:71], v[176:179]
    ds_read_b64_tr_b16 a[136:137], v224 offset:0
    v_cvt_pk_bf16_f32 v188, v152, v153
    v_mfma_f32_16x16x32_bf16 v[176:179], a[160:163], a[64:67], v[176:179]
    s_waitcnt lgkmcnt(4)
    v_exp_f32 v163, v163
    v_cvt_pk_bf16_f32 v189, v154, v155
    v_mfma_f32_16x16x32_bf16 v[76:79], a[128:131], v[184:187], v[76:79]
    ds_read_b64_tr_b16 a[138:139], v224 offset:1024
    v_cvt_pk_bf16_f32 v190, v160, v161
    v_cvt_pk_bf16_f32 v191, v162, v163
    s_nop 1
    v_mfma_f32_16x16x32_bf16 v[108:111], a[128:131], v[188:191], v[108:111]
    s_waitcnt lgkmcnt(3)
    ds_read_b64_tr_b16 a[140:141], v225 offset:0
    ds_read_b64_tr_b16 a[142:143], v225 offset:1024
    v_mfma_f32_16x16x32_bf16 v[80:83], a[132:135], v[184:187], v[80:83]
    ds_read_b64_tr_b16 a[144:145], v226 offset:0
    v_mul_f32 v12, v238, v12
    v_mfma_f32_16x16x32_bf16 v[112:115], a[132:135], v[188:191], v[112:115]
    ds_read_b64_tr_b16 a[146:147], v226 offset:1024
    v_mul_f32 v13, v238, v13
    v_mfma_f32_16x16x32_bf16 a[244:247], a[240:243], v[184:187], a[244:247]
    s_waitcnt lgkmcnt(4)
    ds_read_b64_tr_b16 a[148:149], v227 offset:0
    v_max3_u32 v248, v248, v249, v250
    v_max_u32 v248, v248, v251
    v_and_b32 v251, 16, v247
    v_mfma_f32_16x16x32_bf16 v[84:87], a[136:139], v[184:187], v[84:87]
    ds_read_b64_tr_b16 a[150:151], v227 offset:1024
    v_lshl_add_u32 v1, v251, 3, v1
    v_cmp_lt_u32 vcc, s76, v248
    s_cbranch_vccnz L_fail0
    v_mfma_f32_16x16x32_bf16 v[116:119], a[136:139], v[188:191], v[116:119]
    s_waitcnt lgkmcnt(4)
    buffer_load_dwordx4 v244, s[12:15], s43 offen offset:1024 nt lds
    v_mfma_f32_16x16x32_bf16 v[88:91], a[140:143], v[184:187], v[88:91]
    v_exp_f32 v164, v164
    v_mfma_f32_16x16x32_bf16 v[120:123], a[140:143], v[188:191], v[120:123]
    ds_read_b128 a[224:227], v242 offset:18432
    ds_read_b64_tr_b16 a[152:153], v228 offset:0
    v_mfma_f32_16x16x32_bf16 a[248:251], a[240:243], v[188:191], a[248:251]
    s_waitcnt lgkmcnt(4)
    ds_read_b64_tr_b16 a[154:155], v228 offset:1024
    v_exp_f32 v165, v165
    v_mfma_f32_16x16x32_bf16 v[92:95], a[144:147], v[184:187], v[92:95]
    v_exp_f32 v166, v166
    v_mfma_f32_16x16x32_bf16 v[124:127], a[144:147], v[188:191], v[124:127]
    s_waitcnt lgkmcnt(3)
    ds_read_b64_tr_b16 a[156:157], v229 offset:0
    ds_read_b64_tr_b16 a[158:159], v229 offset:1024
    v_mfma_f32_16x16x32_bf16 v[96:99], a[148:151], v[184:187], v[96:99]
    v_exp_f32 v167, v167
    v_mfma_f32_16x16x32_bf16 v[128:131], a[148:151], v[188:191], v[128:131]
    s_waitcnt lgkmcnt(4)
    ds_read_b128 a[160:163], v218 offset:49152
    v_mul_f32 v14, v238, v14
    v_mfma_f32_16x16x32_bf16 a[252:255], a[240:243], a[224:227], a[252:255]
    s_waitcnt lgkmcnt(3)
    v_exp_f32 v172, v172
    v_mfma_f32_16x16x32_bf16 v[100:103], a[152:155], v[184:187], v[100:103]
    ds_read_b128 a[164:167], v219 offset:49152
    v_mul_f32 v15, v238, v15
    v_mfma_f32_16x16x32_bf16 v[132:135], a[152:155], v[188:191], v[132:135]
    buffer_load_dwordx4 v244, s[12:15], s43 offen offset:2048 nt lds
    v_mfma_f32_16x16x32_bf16 v[140:143], a[152:155], a[224:227], v[140:143]
    s_waitcnt lgkmcnt(2)
    ds_read_b128 a[168:171], v220 offset:49152
    v_exp_f32 v173, v173
    v_mfma_f32_16x16x32_bf16 v[104:107], a[156:159], v[184:187], v[104:107]
    buffer_load_dwordx4 v244, s[12:15], s43 offen offset:3072 nt lds
    ds_read_b128 a[172:175], v221 offset:49152
    v_mfma_f32_16x16x32_bf16 v[136:139], a[156:159], v[188:191], v[136:139]
    s_add_u32 m0, s39, 98304
    ds_read_b128 a[128:131], v214 offset:49152
    v_exp_f32 v174, v174
    v_mfma_f32_16x16x32_bf16 v[144:147], a[156:159], a[224:227], v[144:147]
    s_waitcnt lgkmcnt(4)
    ds_read_b128 a[132:135], v215 offset:49152
    v_mul_f32 v16, v238, v16
    v_mul_f32 v17, v238, v17
    v_mfma_f32_16x16x32_bf16 v[180:183], a[160:163], a[16:19], v[210:213]
    s_waitcnt lgkmcnt(4)
    ds_read_b128 a[136:139], v216 offset:49152
    v_exp_f32 v175, v175
    v_mul_f32 v18, v238, v18
    v_mfma_f32_16x16x32_bf16 v[180:183], a[164:167], a[20:23], v[180:183]
    s_waitcnt lgkmcnt(4)
    ds_read_b128 a[140:143], v217 offset:49152
    v_mul_f32 v19, v238, v19
    v_cvt_pk_bf16_f32 v12, v12, v13
    v_mfma_f32_16x16x32_bf16 v[180:183], a[168:171], a[24:27], v[180:183]
    s_waitcnt lgkmcnt(4)
    v_exp_f32 v168, v168
    v_cvt_pk_bf16_f32 v13, v14, v15
    v_mfma_f32_16x16x32_bf16 v[180:183], a[172:175], a[28:31], v[180:183]
    s_waitcnt lgkmcnt(3)
    v_exp_f32 v169, v169
    v_cvt_pk_bf16_f32 v14, v16, v17
    v_mfma_f32_16x16x32_bf16 v[148:151], a[128:131], a[0:3], v[202:205]
    s_waitcnt lgkmcnt(2)
    ds_read_b128 a[144:147], v214 offset:50176
    v_cvt_pk_bf16_f32 v15, v18, v19
    v_accvgpr_write_b32 a36, v12
    v_mfma_f32_16x16x32_bf16 v[148:151], a[132:135], a[4:7], v[148:151]
    s_waitcnt lgkmcnt(2)
    v_exp_f32 v170, v170
    v_accvgpr_write_b32 a37, v13
    v_mfma_f32_16x16x32_bf16 v[148:151], a[136:139], a[8:11], v[148:151]
    s_waitcnt lgkmcnt(1)
    ds_read_b128 a[148:151], v215 offset:50176
    v_accvgpr_write_b32 a38, v14
    v_accvgpr_write_b32 a39, v15
    v_mfma_f32_16x16x32_bf16 v[148:151], a[140:143], a[12:15], v[148:151]
    buffer_load_dwordx4 v245, s[16:19], s43 offen offset:0 nt lds
    v_mfma_f32_16x16x32_bf16 v[152:155], a[140:143], a[76:79], v[206:209]
    ds_read_b128 a[152:155], v216 offset:50176
    v_exp_f32 v171, v171
    v_mfma_f32_16x16x32_bf16 v[152:155], a[136:139], a[72:75], v[152:155]
    ds_read_b128 a[156:159], v217 offset:50176
    v_cvt_pk_bf16_f32 v192, v164, v165
    v_mfma_f32_16x16x32_bf16 v[152:155], a[132:135], a[68:71], v[152:155]
    v_exp_f32 v176, v176
    v_mfma_f32_16x16x32_bf16 v[152:155], a[128:131], a[64:67], v[152:155]
    s_waitcnt lgkmcnt(3)
    v_exp_f32 v177, v177
    v_mfma_f32_16x16x32_bf16 v[156:159], a[144:147], a[0:3], v[202:205]
    s_waitcnt lgkmcnt(2)
    ds_read_b64_tr_b16 a[160:161], v222 offset:2048
    v_cvt_pk_bf16_f32 v193, v166, v167
    v_mfma_f32_16x16x32_bf16 v[156:159], a[148:151], a[4:7], v[156:159]
    s_waitcnt lgkmcnt(2)
    v_exp_f32 v178, v178
    v_mfma_f32_16x16x32_bf16 v[156:159], a[152:155], a[8:11], v[156:159]
    s_waitcnt lgkmcnt(1)
    ds_read_b64_tr_b16 a[162:163], v222 offset:3072
    v_cvt_pk_bf16_f32 v194, v172, v173
    v_mfma_f32_16x16x32_bf16 v[156:159], a[156:159], a[12:15], v[156:159]
    ds_read_b64_tr_b16 a[164:165], v223 offset:2048
    ds_read_b64_tr_b16 a[166:167], v223 offset:3072
    v_mfma_f32_16x16x32_bf16 v[160:163], a[156:159], a[76:79], v[206:209]
    v_exp_f32 v179, v179
    v_mfma_f32_16x16x32_bf16 v[160:163], a[152:155], a[72:75], v[160:163]
    v_exp_f32 v180, v180
    v_mfma_f32_16x16x32_bf16 v[160:163], a[148:151], a[68:71], v[160:163]
    ds_read_b64_tr_b16 a[168:169], v224 offset:2048
    v_cvt_pk_bf16_f32 v195, v174, v175
    v_mfma_f32_16x16x32_bf16 v[160:163], a[144:147], a[64:67], v[160:163]
    s_waitcnt lgkmcnt(3)
    buffer_load_dwordx4 v245, s[16:19], s43 offen offset:1024 nt lds
    v_cvt_pk_bf16_f32 v196, v168, v169
    v_mfma_f32_16x16x32_bf16 v[76:79], a[160:163], v[192:195], v[76:79]
    ds_read_b64_tr_b16 a[170:171], v224 offset:3072
    v_cvt_pk_bf16_f32 v197, v170, v171
    v_cvt_pk_bf16_f32 v198, v176, v177
    v_cvt_pk_bf16_f32 v199, v178, v179
    s_nop 1
    v_mfma_f32_16x16x32_bf16 v[108:111], a[160:163], v[196:199], v[108:111]
    s_waitcnt lgkmcnt(2)
    ds_read_b64_tr_b16 a[172:173], v225 offset:2048
    v_exp_f32 v181, v181
    v_mfma_f32_16x16x32_bf16 v[80:83], a[164:167], v[192:195], v[80:83]
    ds_read_b64_tr_b16 a[174:175], v225 offset:3072
    v_mul_f32 v44, v239, v44
    v_exp_f32 v182, v182
    v_mfma_f32_16x16x32_bf16 v[112:115], a[164:167], v[196:199], v[112:115]
    ds_read_b64_tr_b16 a[128:129], v226 offset:2048
    ds_read_b64_tr_b16 a[130:131], v226 offset:3072
    v_mfma_f32_16x16x32_bf16 a[244:247], a[240:243], v[192:195], a[244:247]
    s_waitcnt lgkmcnt(4)
    v_exp_f32 v183, v183
    v_mfma_f32_16x16x32_bf16 v[84:87], a[168:171], v[192:195], v[84:87]
    ds_read_b64_tr_b16 a[132:133], v227 offset:2048
    ds_read_b64_tr_b16 a[134:135], v227 offset:3072
    v_mfma_f32_16x16x32_bf16 v[116:119], a[168:171], v[196:199], v[116:119]
    s_waitcnt lgkmcnt(4)
    v_exp_f32 v148, v148
    v_mfma_f32_16x16x32_bf16 v[88:91], a[172:175], v[192:195], v[88:91]
    ds_read_b128 a[228:231], v242 offset:19456
    v_mul_f32 v45, v239, v45
    v_mfma_f32_16x16x32_bf16 v[120:123], a[172:175], v[196:199], v[120:123]
    v_exp_f32 v149, v149
    v_mfma_f32_16x16x32_bf16 a[248:251], a[240:243], v[196:199], a[248:251]
    s_waitcnt lgkmcnt(3)
    ds_read_b64_tr_b16 a[136:137], v228 offset:2048
    ds_read_b64_tr_b16 a[138:139], v228 offset:3072
    v_mfma_f32_16x16x32_bf16 v[92:95], a[128:131], v[192:195], v[92:95]
    buffer_load_dwordx4 v245, s[16:19], s43 offen offset:2048 nt lds
    v_exp_f32 v150, v150
    v_mfma_f32_16x16x32_bf16 v[124:127], a[128:131], v[196:199], v[124:127]
    s_waitcnt lgkmcnt(3)
    ds_read_b64_tr_b16 a[140:141], v229 offset:2048
    ds_read_b64_tr_b16 a[142:143], v229 offset:3072
    v_mfma_f32_16x16x32_bf16 v[96:99], a[132:135], v[192:195], v[96:99]
    v_exp_f32 v151, v151
    v_mfma_f32_16x16x32_bf16 v[128:131], a[132:135], v[196:199], v[128:131]
    s_waitcnt lgkmcnt(4)
    v_exp_f32 v156, v156
    v_mfma_f32_16x16x32_bf16 a[252:255], a[240:243], a[228:231], a[252:255]
    s_waitcnt lgkmcnt(2)
    ds_read_b128 a[144:147], v214 offset:51200
    v_mul_f32 v46, v239, v46
    v_mul_f32 v47, v239, v47
    v_mfma_f32_16x16x32_bf16 v[100:103], a[136:139], v[192:195], v[100:103]
    v_exp_f32 v157, v157
    v_mul_f32 v48, v239, v48
    v_mfma_f32_16x16x32_bf16 v[132:135], a[136:139], v[196:199], v[132:135]
    ds_read_b128 a[148:151], v215 offset:51200
    v_mul_f32 v49, v239, v49
    v_mul_f32 v50, v239, v50
    v_mfma_f32_16x16x32_bf16 v[140:143], a[136:139], a[228:231], v[140:143]
    s_waitcnt lgkmcnt(2)
    ds_read_b128 a[152:155], v216 offset:51200
    v_mul_f32 v51, v239, v51
    v_cvt_pk_bf16_f32 v44, v44, v45
    v_mfma_f32_16x16x32_bf16 v[104:107], a[140:143], v[192:195], v[104:107]
    ds_read_b128 a[156:159], v217 offset:51200
    v_exp_f32 v158, v158
    v_cvt_pk_bf16_f32 v45, v46, v47
    v_mfma_f32_16x16x32_bf16 v[136:139], a[140:143], v[196:199], v[136:139]
    v_exp_f32 v159, v159
    v_cvt_pk_bf16_f32 v46, v48, v49
    v_mfma_f32_16x16x32_bf16 v[144:147], a[140:143], a[228:231], v[144:147]
    s_waitcnt lgkmcnt(3)
    ds_read_b128 a[160:163], v214 offset:52224
    v_cvt_pk_bf16_f32 v47, v50, v51
    v_accvgpr_write_b32 a52, v44
    v_mfma_f32_16x16x32_bf16 v[164:167], a[144:147], a[0:3], v[202:205]
    s_waitcnt lgkmcnt(3)
    buffer_load_dwordx4 v245, s[16:19], s43 offen offset:3072 nt lds
    v_accvgpr_write_b32 a53, v45
    v_mfma_f32_16x16x32_bf16 v[164:167], a[148:151], a[4:7], v[164:167]
    s_waitcnt lgkmcnt(2)
    v_exp_f32 v152, v152
    v_accvgpr_write_b32 a54, v46
    v_accvgpr_write_b32 a55, v47
    v_mfma_f32_16x16x32_bf16 v[164:167], a[152:155], a[8:11], v[164:167]
    s_waitcnt lgkmcnt(1)
    ds_read_b128 a[164:167], v215 offset:52224
    v_cvt_pk_bf16_f32 v200, v180, v181
    v_mfma_f32_16x16x32_bf16 v[164:167], a[156:159], a[12:15], v[164:167]
    s_add_u32 m0, s39, 16384
    v_exp_f32 v153, v153
    v_mfma_f32_16x16x32_bf16 v[168:171], a[156:159], a[76:79], v[206:209]
    s_add_u32 s43, s40, 196608
    ds_read_b128 a[168:171], v216 offset:52224
    ds_read_b128 a[172:175], v217 offset:52224
    v_cvt_pk_bf16_f32 v201, v182, v183
    v_mfma_f32_16x16x32_bf16 v[168:171], a[152:155], a[72:75], v[168:171]
    ds_write_b64 v243, v[200:201] offset:0
    v_cvt_pk_bf16_f32 v184, v148, v149
    v_exp_f32 v154, v154
    v_mfma_f32_16x16x32_bf16 v[168:171], a[148:151], a[68:71], v[168:171]
    v_exp_f32 v155, v155
    v_mfma_f32_16x16x32_bf16 v[168:171], a[144:147], a[64:67], v[168:171]
    s_mov_b64 exec, 0
    s_cmp_eq_u32 s36, 0
    s_cbranch_scc1 L_pad12
    s_cmp_eq_u32 s36, 1
    s_cbranch_scc1 L_pad13
    s_cmp_eq_u32 s36, 2
    s_cbranch_scc1 L_back3
    s_branch L_back3
L_back3:
    s_mov_b64 exec, -1
    s_waitcnt vmcnt(4) lgkmcnt(0)
    s_barrier
    v_mfma_f32_16x16x32_bf16 v[172:175], a[160:163], a[0:3], v[202:205]
    v_exp_f32 v160, v160
    v_mfma_f32_16x16x32_bf16 v[172:175], a[164:167], a[4:7], v[172:175]
    ds_read_b64_tr_b16 a[128:129], v222 offset:49152
    ds_read_b64_tr_b16 a[130:131], v222 offset:50176
    v_mfma_f32_16x16x32_bf16 v[172:175], a[168:171], a[8:11], v[172:175]
    buffer_load_dwordx4 v244, s[12:15], s43 offen offset:0 nt lds
    v_mfma_f32_16x16x32_bf16 v[172:175], a[172:175], a[12:15], v[172:175]
    v_exp_f32 v161, v161
    v_mfma_f32_16x16x32_bf16 v[176:179], a[172:175], a[76:79], v[206:209]
    ds_read_b64_tr_b16 a[132:133], v223 offset:49152
    ds_read_b64_tr_b16 a[134:135], v223 offset:50176
    v_mfma_f32_16x16x32_bf16 v[176:179], a[168:171], a[72:75], v[176:179]
    v_exp_f32 v162, v162
    v_cvt_pk_bf16_f32 v185, v150, v151
    v_mfma_f32_16x16x32_bf16 v[176:179], a[164:167], a[68:71], v[176:179]
    ds_read_b64_tr_b16 a[136:137], v224 offset:49152
    v_cvt_pk_bf16_f32 v186, v156, v157
    v_cvt_pk_bf16_f32 v187, v158, v159
    v_mfma_f32_16x16x32_bf16 v[176:179], a[160:163], a[64:67], v[176:179]
    s_waitcnt lgkmcnt(3)
    v_exp_f32 v163, v163
    v_cvt_pk_bf16_f32 v188, v152, v153
    v_mfma_f32_16x16x32_bf16 v[76:79], a[128:131], v[184:187], v[76:79]
    ds_read_b64_tr_b16 a[138:139], v224 offset:50176
    v_cvt_pk_bf16_f32 v189, v154, v155
    v_cvt_pk_bf16_f32 v190, v160, v161
    v_cvt_pk_bf16_f32 v191, v162, v163
    s_nop 1
    v_mfma_f32_16x16x32_bf16 v[108:111], a[128:131], v[188:191], v[108:111]
    s_waitcnt lgkmcnt(2)
    ds_read_b64_tr_b16 a[140:141], v225 offset:49152
    ds_read_b64_tr_b16 a[142:143], v225 offset:50176
    v_mfma_f32_16x16x32_bf16 v[80:83], a[132:135], v[184:187], v[80:83]
    ds_read_b64_tr_b16 a[144:145], v226 offset:49152
    v_mul_f32 v20, v238, v20
    v_mfma_f32_16x16x32_bf16 v[112:115], a[132:135], v[188:191], v[112:115]
    ds_read_b64_tr_b16 a[146:147], v226 offset:50176
    v_mul_f32 v21, v238, v21
    v_mfma_f32_16x16x32_bf16 a[244:247], a[240:243], v[184:187], a[244:247]
    s_waitcnt lgkmcnt(4)
    ds_read_b64_tr_b16 a[148:149], v227 offset:49152
    v_mul_f32 v22, v238, v22
    v_mfma_f32_16x16x32_bf16 v[84:87], a[136:139], v[184:187], v[84:87]
    ds_read_b64_tr_b16 a[150:151], v227 offset:50176
    v_mul_f32 v23, v238, v23
    v_mfma_f32_16x16x32_bf16 v[116:119], a[136:139], v[188:191], v[116:119]
    s_waitcnt lgkmcnt(4)
    buffer_load_dwordx4 v244, s[12:15], s43 offen offset:1024 nt lds
    v_mfma_f32_16x16x32_bf16 v[88:91], a[140:143], v[184:187], v[88:91]
    v_exp_f32 v164, v164
    v_mfma_f32_16x16x32_bf16 v[120:123], a[140:143], v[188:191], v[120:123]
    ds_read_b128 a[224:227], v242 offset:16384
    ds_read_b64_tr_b16 a[152:153], v228 offset:49152
    v_mfma_f32_16x16x32_bf16 a[248:251], a[240:243], v[188:191], a[248:251]
    s_waitcnt lgkmcnt(4)
    ds_read_b64_tr_b16 a[154:155], v228 offset:50176
    v_exp_f32 v165, v165
    v_mfma_f32_16x16x32_bf16 v[92:95], a[144:147], v[184:187], v[92:95]
    v_exp_f32 v166, v166
    v_mfma_f32_16x16x32_bf16 v[124:127], a[144:147], v[188:191], v[124:127]
    s_waitcnt lgkmcnt(3)
    ds_read_b64_tr_b16 a[156:157], v229 offset:49152
    ds_read_b64_tr_b16 a[158:159], v229 offset:50176
    v_mfma_f32_16x16x32_bf16 v[96:99], a[148:151], v[184:187], v[96:99]
    v_exp_f32 v167, v167
    v_mfma_f32_16x16x32_bf16 v[128:131], a[148:151], v[188:191], v[128:131]
    s_waitcnt lgkmcnt(4)
    ds_read_b128 a[160:163], v218 offset:32768
    v_mul_f32 v24, v238, v24
    v_mfma_f32_16x16x32_bf16 a[252:255], a[240:243], a[224:227], a[252:255]
    s_waitcnt lgkmcnt(3)
    v_exp_f32 v172, v172
    v_mul_f32 v25, v238, v25
    v_mfma_f32_16x16x32_bf16 v[100:103], a[152:155], v[184:187], v[100:103]
    ds_read_b128 a[164:167], v219 offset:32768
    v_mul_f32 v26, v238, v26
    v_mul_f32 v27, v238, v27
    v_mfma_f32_16x16x32_bf16 v[132:135], a[152:155], v[188:191], v[132:135]
    buffer_load_dwordx4 v244, s[12:15], s43 offen offset:2048 nt lds
    v_cvt_pk_bf16_f32 v20, v20, v21
    v_mfma_f32_16x16x32_bf16 v[140:143], a[152:155], a[224:227], v[140:143]
    s_waitcnt lgkmcnt(2)
    ds_read_b128 a[168:171], v220 offset:32768
    v_exp_f32 v173, v173
    v_cvt_pk_bf16_f32 v21, v22, v23
    v_mfma_f32_16x16x32_bf16 v[104:107], a[156:159], v[184:187], v[104:107]
    buffer_load_dwordx4 v244, s[12:15], s43 offen offset:3072 nt lds
    ds_read_b128 a[172:175], v221 offset:32768
    v_cvt_pk_bf16_f32 v22, v24, v25
    v_mfma_f32_16x16x32_bf16 v[136:139], a[156:159], v[188:191], v[136:139]
    s_add_u32 m0, s39, 81920
    ds_read_b128 a[128:131], v214 offset:32768
    v_exp_f32 v174, v174
    v_cvt_pk_bf16_f32 v23, v26, v27
    v_mfma_f32_16x16x32_bf16 v[144:147], a[156:159], a[224:227], v[144:147]
    s_waitcnt lgkmcnt(4)
    ds_read_b128 a[132:135], v215 offset:32768
    v_accvgpr_write_b32 a40, v20
    v_accvgpr_write_b32 a41, v21
    v_mfma_f32_16x16x32_bf16 v[180:183], a[160:163], a[16:19], v[210:213]
    s_waitcnt lgkmcnt(4)
    ds_read_b128 a[136:139], v216 offset:32768
    v_exp_f32 v175, v175
    v_accvgpr_write_b32 a42, v22
    v_accvgpr_write_b32 a43, v23
    v_mfma_f32_16x16x32_bf16 v[180:183], a[164:167], a[20:23], v[180:183]
    s_waitcnt lgkmcnt(4)
    ds_read_b128 a[140:143], v217 offset:32768
    v_cvt_pk_bf16_f32 v192, v164, v165
    v_mfma_f32_16x16x32_bf16 v[180:183], a[168:171], a[24:27], v[180:183]
    s_waitcnt lgkmcnt(4)
    v_exp_f32 v168, v168
    v_mfma_f32_16x16x32_bf16 v[180:183], a[172:175], a[28:31], v[180:183]
    s_waitcnt lgkmcnt(3)
    v_exp_f32 v169, v169
    v_mfma_f32_16x16x32_bf16 v[148:151], a[128:131], a[0:3], v[202:205]
    s_waitcnt lgkmcnt(2)
    ds_read_b128 a[144:147], v214 offset:33792
    v_cvt_pk_bf16_f32 v193, v166, v167
    v_mfma_f32_16x16x32_bf16 v[148:151], a[132:135], a[4:7], v[148:151]
    s_waitcnt lgkmcnt(2)
    v_exp_f32 v170, v170
    v_mfma_f32_16x16x32_bf16 v[148:151], a[136:139], a[8:11], v[148:151]
    s_waitcnt lgkmcnt(1)
    ds_read_b128 a[148:151], v215 offset:33792
    v_cvt_pk_bf16_f32 v194, v172, v173
    v_mfma_f32_16x16x32_bf16 v[148:151], a[140:143], a[12:15], v[148:151]
    buffer_load_dwordx4 v245, s[16:19], s43 offen offset:0 nt lds
    v_mfma_f32_16x16x32_bf16 v[152:155], a[140:143], a[76:79], v[206:209]
    ds_read_b128 a[152:155], v216 offset:33792
    v_exp_f32 v171, v171
    v_mfma_f32_16x16x32_bf16 v[152:155], a[136:139], a[72:75], v[152:155]
    ds_read_b128 a[156:159], v217 offset:33792
    v_cvt_pk_bf16_f32 v195, v174, v175
    v_mfma_f32_16x16x32_bf16 v[152:155], a[132:135], a[68:71], v[152:155]
    v_exp_f32 v176, v176
    v_mfma_f32_16x16x32_bf16 v[152:155], a[128:131], a[64:67], v[152:155]
    s_waitcnt lgkmcnt(3)
    v_exp_f32 v177, v177
    v_mfma_f32_16x16x32_bf16 v[156:159], a[144:147], a[0:3], v[202:205]
    s_waitcnt lgkmcnt(2)
    ds_read_b64_tr_b16 a[160:161], v222 offset:51200
    v_cvt_pk_bf16_f32 v196, v168, v169
    v_mfma_f32_16x16x32_bf16 v[156:159], a[148:151], a[4:7], v[156:159]
    s_waitcnt lgkmcnt(2)
    v_exp_f32 v178, v178
    v_mfma_f32_16x16x32_bf16 v[156:159], a[152:155], a[8:11], v[156:159]
    s_waitcnt lgkmcnt(1)
    ds_read_b64_tr_b16 a[162:163], v222 offset:52224
    v_cvt_pk_bf16_f32 v197, v170, v171
    v_mfma_f32_16x16x32_bf16 v[156:159], a[156:159], a[12:15], v[156:159]
    ds_read_b64_tr_b16 a[164:165], v223 offset:51200
    ds_read_b64_tr_b16 a[166:167], v223 offset:52224
    v_mfma_f32_16x16x32_bf16 v[160:163], a[156:159], a[76:79], v[206:209]
    v_exp_f32 v179, v179
    v_mfma_f32_16x16x32_bf16 v[160:163], a[152:155], a[72:75], v[160:163]
    v_exp_f32 v180, v180
    v_mfma_f32_16x16x32_bf16 v[160:163], a[148:151], a[68:71], v[160:163]
    ds_read_b64_tr_b16 a[168:169], v224 offset:51200
    ds_read_b64_tr_b16 a[170:171], v224 offset:52224
    v_mfma_f32_16x16x32_bf16 v[160:163], a[144:147], a[64:67], v[160:163]
    s_waitcnt lgkmcnt(4)
    buffer_load_dwordx4 v245, s[16:19], s43 offen offset:1024 nt lds
    v_mfma_f32_16x16x32_bf16 v[76:79], a[160:163], v[192:195], v[76:79]
    v_cvt_pk_bf16_f32 v198, v176, v177
    v_cvt_pk_bf16_f32 v199, v178, v179
    v_exp_f32 v181, v181
    s_nop 0
    v_mfma_f32_16x16x32_bf16 v[108:111], a[160:163], v[196:199], v[108:111]
    s_waitcnt lgkmcnt(2)
    ds_read_b64_tr_b16 a[172:173], v225 offset:51200
    ds_read_b64_tr_b16 a[174:175], v225 offset:52224
    v_mfma_f32_16x16x32_bf16 v[80:83], a[164:167], v[192:195], v[80:83]
    v_exp_f32 v182, v182
    v_mfma_f32_16x16x32_bf16 v[112:115], a[164:167], v[196:199], v[112:115]
    ds_read_b64_tr_b16 a[128:129], v226 offset:51200
    ds_read_b64_tr_b16 a[130:131], v226 offset:52224
    v_mfma_f32_16x16x32_bf16 a[244:247], a[240:243], v[192:195], a[244:247]
    s_waitcnt lgkmcnt(4)
    v_exp_f32 v183, v183
    v_mfma_f32_16x16x32_bf16 v[84:87], a[168:171], v[192:195], v[84:87]
    ds_read_b64_tr_b16 a[132:133], v227 offset:51200
    ds_read_b64_tr_b16 a[134:135], v227 offset:52224
    v_mfma_f32_16x16x32_bf16 v[116:119], a[168:171], v[196:199], v[116:119]
    s_waitcnt lgkmcnt(4)
    v_exp_f32 v148, v148
    v_mfma_f32_16x16x32_bf16 v[88:91], a[172:175], v[192:195], v[88:91]
    ds_read_b128 a[228:231], v242 offset:17408
    v_mul_f32 v52, v239, v52
    v_mul_f32 v53, v239, v53
    v_mfma_f32_16x16x32_bf16 v[120:123], a[172:175], v[196:199], v[120:123]
    v_exp_f32 v149, v149
    v_mul_f32 v54, v239, v54
    v_mfma_f32_16x16x32_bf16 a[248:251], a[240:243], v[196:199], a[248:251]
    s_waitcnt lgkmcnt(3)
    ds_read_b64_tr_b16 a[136:137], v228 offset:51200
    ds_read_b64_tr_b16 a[138:139], v228 offset:52224
    v_mul_f32 v55, v239, v55
    v_mfma_f32_16x16x32_bf16 v[92:95], a[128:131], v[192:195], v[92:95]
    buffer_load_dwordx4 v245, s[16:19], s43 offen offset:2048 nt lds
    v_exp_f32 v150, v150
    v_mul_f32 v56, v239, v56
    v_mfma_f32_16x16x32_bf16 v[124:127], a[128:131], v[196:199], v[124:127]
    s_waitcnt lgkmcnt(3)
    ds_read_b64_tr_b16 a[140:141], v229 offset:51200
    ds_read_b64_tr_b16 a[142:143], v229 offset:52224
    v_mul_f32 v57, v239, v57
    v_mfma_f32_16x16x32_bf16 v[96:99], a[132:135], v[192:195], v[96:99]
    v_exp_f32 v151, v151
    v_mul_f32 v58, v239, v58
    v_mul_f32 v59, v239, v59
    v_mfma_f32_16x16x32_bf16 v[128:131], a[132:135], v[196:199], v[128:131]
    s_waitcnt lgkmcnt(4)
    v_exp_f32 v156, v156
    v_cvt_pk_bf16_f32 v52, v52, v53
    v_cvt_pk_bf16_f32 v53, v54, v55
    v_mfma_f32_16x16x32_bf16 a[252:255], a[240:243], a[228:231], a[252:255]
    s_waitcnt lgkmcnt(2)
    ds_read_b128 a[144:147], v214 offset:34816
    v_cvt_pk_bf16_f32 v54, v56, v57
    v_cvt_pk_bf16_f32 v55, v58, v59
    v_mfma_f32_16x16x32_bf16 v[100:103], a[136:139], v[192:195], v[100:103]
    v_exp_f32 v157, v157
    v_accvgpr_write_b32 a56, v52
    v_accvgpr_write_b32 a57, v53
    v_mfma_f32_16x16x32_bf16 v[132:135], a[136:139], v[196:199], v[132:135]
    ds_read_b128 a[148:151], v215 offset:34816
    v_accvgpr_write_b32 a58, v54
    v_accvgpr_write_b32 a59, v55
    v_mfma_f32_16x16x32_bf16 v[140:143], a[136:139], a[228:231], v[140:143]
    s_waitcnt lgkmcnt(2)
    ds_read_b128 a[152:155], v216 offset:34816
    v_cvt_pk_bf16_f32 v200, v180, v181
    v_mfma_f32_16x16x32_bf16 v[104:107], a[140:143], v[192:195], v[104:107]
    ds_read_b128 a[156:159], v217 offset:34816
    v_exp_f32 v158, v158
    v_mfma_f32_16x16x32_bf16 v[136:139], a[140:143], v[196:199], v[136:139]
    v_exp_f32 v159, v159
    v_mfma_f32_16x16x32_bf16 v[144:147], a[140:143], a[228:231], v[144:147]
    s_waitcnt lgkmcnt(3)
    buffer_load_dwordx4 v245, s[16:19], s43 offen offset:3072 nt lds
    v_mfma_f32_16x16x32_bf16 v[164:167], a[144:147], a[0:3], v[202:205]
    s_waitcnt lgkmcnt(2)
    v_exp_f32 v152, v152
    v_mfma_f32_16x16x32_bf16 v[164:167], a[148:151], a[4:7], v[164:167]
    s_waitcnt lgkmcnt(1)
    ds_read_b128 a[160:163], v214 offset:35840
    v_cvt_pk_bf16_f32 v201, v182, v183
    v_mfma_f32_16x16x32_bf16 v[164:167], a[152:155], a[8:11], v[164:167]
    s_waitcnt lgkmcnt(1)
    ds_read_b128 a[164:167], v215 offset:35840
    v_cvt_pk_bf16_f32 v184, v148, v149
    v_mfma_f32_16x16x32_bf16 v[164:167], a[156:159], a[12:15], v[164:167]
    s_add_u32 m0, s39, 0
    v_exp_f32 v153, v153
    v_mfma_f32_16x16x32_bf16 v[168:171], a[156:159], a[76:79], v[206:209]
    s_add_u32 s43, s40, 212992
    ds_read_b128 a[168:171], v216 offset:35840
    ds_write_b64 v243, v[200:201] offset:2048
    ds_read_b128 a[172:175], v217 offset:35840
    v_mfma_f32_16x16x32_bf16 v[168:171], a[152:155], a[72:75], v[168:171]
    v_exp_f32 v154, v154
    v_mfma_f32_16x16x32_bf16 v[168:171], a[148:151], a[68:71], v[168:171]
    v_exp_f32 v155, v155
    v_mfma_f32_16x16x32_bf16 v[168:171], a[144:147], a[64:67], v[168:171]
L_pad8:
    s_cbranch_execz L_back2
    s_waitcnt vmcnt(4) lgkmcnt(0)
    s_barrier
    v_mfma_f32_16x16x32_bf16 v[172:175], a[160:163], a[0:3], v[202:205]
    v_exp_f32 v160, v160
    v_mfma_f32_16x16x32_bf16 v[172:175], a[164:167], a[4:7], v[172:175]
    ds_read_b64_tr_b16 a[128:129], v222 offset:32768
    ds_read_b64_tr_b16 a[130:131], v222 offset:33792
    v_mfma_f32_16x16x32_bf16 v[172:175], a[168:171], a[8:11], v[172:175]
    buffer_load_dwordx4 v244, s[12:15], s43 offen offset:0 nt lds
    v_mfma_f32_16x16x32_bf16 v[172:175], a[172:175], a[12:15], v[172:175]
    v_exp_f32 v161, v161
    v_mfma_f32_16x16x32_bf16 v[176:179], a[172:175], a[76:79], v[206:209]
    ds_read_b64_tr_b16 a[132:133], v223 offset:32768
    ds_read_b64_tr_b16 a[134:135], v223 offset:33792
    v_mfma_f32_16x16x32_bf16 v[176:179], a[168:171], a[72:75], v[176:179]
    v_exp_f32 v162, v162
    v_cvt_pk_bf16_f32 v185, v150, v151
    v_mfma_f32_16x16x32_bf16 v[176:179], a[164:167], a[68:71], v[176:179]
    ds_read_b64_tr_b16 a[136:137], v224 offset:32768
    v_cvt_pk_bf16_f32 v186, v156, v157
    v_cvt_pk_bf16_f32 v187, v158, v159
    v_mfma_f32_16x16x32_bf16 v[176:179], a[160:163], a[64:67], v[176:179]
    s_waitcnt lgkmcnt(3)
    v_exp_f32 v163, v163
    v_cvt_pk_bf16_f32 v188, v152, v153
    v_mfma_f32_16x16x32_bf16 v[76:79], a[128:131], v[184:187], v[76:79]
    ds_read_b64_tr_b16 a[138:139], v224 offset:33792
    v_cvt_pk_bf16_f32 v189, v154, v155
    v_cvt_pk_bf16_f32 v190, v160, v161
    v_cvt_pk_bf16_f32 v191, v162, v163
    s_nop 1
    v_mfma_f32_16x16x32_bf16 v[108:111], a[128:131], v[188:191], v[108:111]
    s_waitcnt lgkmcnt(2)
    ds_read_b64_tr_b16 a[140:141], v225 offset:32768
    ds_read_b64_tr_b16 a[142:143], v225 offset:33792
    v_mfma_f32_16x16x32_bf16 v[80:83], a[132:135], v[184:187], v[80:83]
    ds_read_b64_tr_b16 a[144:145], v226 offset:32768
    v_mul_f32 v28, v238, v28
    v_mfma_f32_16x16x32_bf16 v[112:115], a[132:135], v[188:191], v[112:115]
    ds_read_b64_tr_b16 a[146:147], v226 offset:33792
    v_mul_f32 v29, v238, v29
    v_mfma_f32_16x16x32_bf16 a[244:247], a[240:243], v[184:187], a[244:247]
    s_waitcnt lgkmcnt(4)
    ds_read_b64_tr_b16 a[148:149], v227 offset:32768
    v_mul_f32 v30, v238, v30
    v_mfma_f32_16x16x32_bf16 v[84:87], a[136:139], v[184:187], v[84:87]
    ds_read_b64_tr_b16 a[150:151], v227 offset:33792
    v_mul_f32 v31, v238, v31
    v_mfma_f32_16x16x32_bf16 v[116:119], a[136:139], v[188:191], v[116:119]
    s_waitcnt lgkmcnt(4)
    buffer_load_dwordx4 v244, s[12:15], s43 offen offset:1024 nt lds
    v_mfma_f32_16x16x32_bf16 v[88:91], a[140:143], v[184:187], v[88:91]
    v_exp_f32 v164, v164
    v_mfma_f32_16x16x32_bf16 v[120:123], a[140:143], v[188:191], v[120:123]
    ds_read_b128 a[224:227], v242 offset:18432
    ds_read_b64_tr_b16 a[152:153], v228 offset:32768
    v_mfma_f32_16x16x32_bf16 a[248:251], a[240:243], v[188:191], a[248:251]
    s_waitcnt lgkmcnt(4)
    ds_read_b64_tr_b16 a[154:155], v228 offset:33792
    v_exp_f32 v165, v165
    v_mfma_f32_16x16x32_bf16 v[92:95], a[144:147], v[184:187], v[92:95]
    v_exp_f32 v166, v166
    v_mfma_f32_16x16x32_bf16 v[124:127], a[144:147], v[188:191], v[124:127]
    s_waitcnt lgkmcnt(3)
    ds_read_b64_tr_b16 a[156:157], v229 offset:32768
    ds_read_b64_tr_b16 a[158:159], v229 offset:33792
    v_mfma_f32_16x16x32_bf16 v[96:99], a[148:151], v[184:187], v[96:99]
    v_exp_f32 v167, v167
    v_rcp_f32 v240, v240
    v_mfma_f32_16x16x32_bf16 v[128:131], a[148:151], v[188:191], v[128:131]
    s_waitcnt lgkmcnt(4)
    ds_read_b128 a[160:163], v218 offset:16384
    v_mul_f32 v68, v240, v68
    v_mul_f32 v69, v240, v69
    v_mul_f32 v70, v240, v70
    v_mfma_f32_16x16x32_bf16 a[252:255], a[240:243], a[224:227], a[252:255]
    s_waitcnt lgkmcnt(3)
    v_exp_f32 v172, v172
    v_mul_f32 v71, v240, v71
    v_mul_f32 v72, v240, v72
    v_mfma_f32_16x16x32_bf16 v[100:103], a[152:155], v[184:187], v[100:103]
    buffer_load_dwordx4 v244, s[12:15], s43 offen offset:2048 nt lds
    v_mul_f32 v73, v240, v73
    v_mul_f32 v74, v240, v74
    v_mfma_f32_16x16x32_bf16 v[132:135], a[152:155], v[188:191], v[132:135]
    ds_read_b128 a[164:167], v219 offset:16384
    v_mul_f32 v75, v240, v75
    v_cvt_pk_bf16_f32 v68, v68, v69
    v_cvt_pk_bf16_f32 v69, v70, v71
    v_mfma_f32_16x16x32_bf16 v[140:143], a[152:155], a[224:227], v[140:143]
    s_waitcnt lgkmcnt(2)
    buffer_load_dwordx4 v244, s[12:15], s43 offen offset:3072 nt lds
    v_exp_f32 v173, v173
    v_cvt_pk_bf16_f32 v70, v72, v73
    v_cvt_pk_bf16_f32 v71, v74, v75
    v_mfma_f32_16x16x32_bf16 v[104:107], a[156:159], v[184:187], v[104:107]
    s_add_u32 m0, s39, 65536
    ds_read_b128 a[168:171], v220 offset:16384
    ds_read_b128 a[172:175], v221 offset:16384
    v_add_u32 v72, s83, v242
    v_mfma_f32_16x16x32_bf16 v[136:139], a[156:159], v[188:191], v[136:139]
    ds_read_b128 a[128:131], v214 offset:16384
    v_exp_f32 v174, v174
    v_mfma_f32_16x16x32_bf16 v[144:147], a[156:159], a[224:227], v[144:147]
    s_waitcnt lgkmcnt(4)
    ds_read_b128 a[132:135], v215 offset:16384
    v_cvt_pk_bf16_f32 v192, v164, v165
    v_mfma_f32_16x16x32_bf16 v[180:183], a[160:163], a[16:19], v[210:213]
    s_waitcnt lgkmcnt(4)
    ds_read_b128 a[136:139], v216 offset:16384
    v_exp_f32 v175, v175
    v_mfma_f32_16x16x32_bf16 v[180:183], a[164:167], a[20:23], v[180:183]
    s_waitcnt lgkmcnt(4)
    ds_read_b128 a[140:143], v217 offset:16384
    v_cvt_pk_bf16_f32 v193, v166, v167
    v_mfma_f32_16x16x32_bf16 v[180:183], a[168:171], a[24:27], v[180:183]
    s_waitcnt lgkmcnt(4)
    v_exp_f32 v168, v168
    v_mfma_f32_16x16x32_bf16 v[180:183], a[172:175], a[28:31], v[180:183]
    s_waitcnt lgkmcnt(3)
    v_exp_f32 v169, v169
    v_mfma_f32_16x16x32_bf16 v[148:151], a[128:131], a[0:3], v[202:205]
    s_waitcnt lgkmcnt(2)
    ds_write_b128 v72, v[68:71] offset:0
    v_cvt_pk_bf16_f32 v194, v172, v173
    v_mfma_f32_16x16x32_bf16 v[148:151], a[132:135], a[4:7], v[148:151]
    s_waitcnt lgkmcnt(2)
    v_exp_f32 v170, v170
    v_mfma_f32_16x16x32_bf16 v[148:151], a[136:139], a[8:11], v[148:151]
    s_waitcnt lgkmcnt(1)
    ds_read_b128 a[144:147], v214 offset:17408
    v_cvt_pk_bf16_f32 v195, v174, v175
    v_mfma_f32_16x16x32_bf16 v[148:151], a[140:143], a[12:15], v[148:151]
    buffer_load_dwordx4 v245, s[16:19], s43 offen offset:0 nt lds
    ds_read_b128 a[148:151], v215 offset:17408
    v_mfma_f32_16x16x32_bf16 v[152:155], a[140:143], a[76:79], v[206:209]
    ds_read_b128 a[152:155], v216 offset:17408
    v_exp_f32 v171, v171
    v_mfma_f32_16x16x32_bf16 v[152:155], a[136:139], a[72:75], v[152:155]
    ds_read_b128 a[156:159], v217 offset:17408
    v_cvt_pk_bf16_f32 v196, v168, v169
    v_mfma_f32_16x16x32_bf16 v[152:155], a[132:135], a[68:71], v[152:155]
    v_exp_f32 v176, v176
    v_mfma_f32_16x16x32_bf16 v[152:155], a[128:131], a[64:67], v[152:155]
    s_waitcnt lgkmcnt(3)
    v_exp_f32 v177, v177
    v_mfma_f32_16x16x32_bf16 v[156:159], a[144:147], a[0:3], v[202:205]
    s_waitcnt lgkmcnt(2)
    ds_read_b64_tr_b16 a[160:161], v222 offset:34816
    v_cvt_pk_bf16_f32 v197, v170, v171
    v_mfma_f32_16x16x32_bf16 v[156:159], a[148:151], a[4:7], v[156:159]
    s_waitcnt lgkmcnt(2)
    v_exp_f32 v178, v178
    v_mfma_f32_16x16x32_bf16 v[156:159], a[152:155], a[8:11], v[156:159]
    s_waitcnt lgkmcnt(1)
    ds_read_b64_tr_b16 a[162:163], v222 offset:35840
    v_cvt_pk_bf16_f32 v198, v176, v177
    v_mfma_f32_16x16x32_bf16 v[156:159], a[156:159], a[12:15], v[156:159]
    ds_read_b64_tr_b16 a[164:165], v223 offset:34816
    ds_read_b64_tr_b16 a[166:167], v223 offset:35840
    v_mfma_f32_16x16x32_bf16 v[160:163], a[156:159], a[76:79], v[206:209]
    v_exp_f32 v179, v179
    v_mfma_f32_16x16x32_bf16 v[160:163], a[152:155], a[72:75], v[160:163]
    v_exp_f32 v180, v180
    v_mfma_f32_16x16x32_bf16 v[160:163], a[148:151], a[68:71], v[160:163]
    buffer_load_dwordx4 v245, s[16:19], s43 offen offset:1024 nt lds
    v_mfma_f32_16x16x32_bf16 v[160:163], a[144:147], a[64:67], v[160:163]
    s_waitcnt lgkmcnt(2)
    ds_read_b64_tr_b16 a[168:169], v224 offset:34816
    ds_read_b64_tr_b16 a[170:171], v224 offset:35840
    v_mfma_f32_16x16x32_bf16 v[76:79], a[160:163], v[192:195], v[76:79]
    ds_read_b64_tr_b16 a[172:173], v225 offset:34816
    v_cvt_pk_bf16_f32 v199, v178, v179
    v_exp_f32 v181, v181
    s_nop 0
    v_mfma_f32_16x16x32_bf16 v[108:111], a[160:163], v[196:199], v[108:111]
    s_waitcnt lgkmcnt(3)
    ds_read_b64_tr_b16 a[174:175], v225 offset:35840
    v_mul_f32 v32, v238, v32
    v_mfma_f32_16x16x32_bf16 v[80:83], a[164:167], v[192:195], v[80:83]
    v_exp_f32 v182, v182
    v_mfma_f32_16x16x32_bf16 v[112:115], a[164:167], v[196:199], v[112:115]
    ds_read_b64_tr_b16 a[128:129], v226 offset:34816
    ds_read_b64_tr_b16 a[130:131], v226 offset:35840
    v_mul_f32 v33, v238, v33
    v_mfma_f32_16x16x32_bf16 a[244:247], a[240:243], v[192:195], a[244:247]
    s_waitcnt lgkmcnt(4)
    v_exp_f32 v183, v183
    v_mul_f32 v34, v238, v34
    v_mfma_f32_16x16x32_bf16 v[84:87], a[168:171], v[192:195], v[84:87]
    ds_read_b64_tr_b16 a[132:133], v227 offset:34816
    ds_read_b64_tr_b16 a[134:135], v227 offset:35840
    v_mul_f32 v35, v238, v35
    v_mfma_f32_16x16x32_bf16 v[116:119], a[168:171], v[196:199], v[116:119]
    s_waitcnt lgkmcnt(4)
    v_exp_f32 v148, v148
    v_cvt_pk_bf16_f32 v28, v28, v29
    v_mfma_f32_16x16x32_bf16 v[88:91], a[172:175], v[192:195], v[88:91]
    ds_read_b128 a[228:231], v242 offset:19456
    v_cvt_pk_bf16_f32 v29, v30, v31
    v_cvt_pk_bf16_f32 v30, v32, v33
    v_mfma_f32_16x16x32_bf16 v[120:123], a[172:175], v[196:199], v[120:123]
    v_exp_f32 v149, v149
    v_cvt_pk_bf16_f32 v31, v34, v35
    v_mfma_f32_16x16x32_bf16 a[248:251], a[240:243], v[196:199], a[248:251]
    s_waitcnt lgkmcnt(3)
    buffer_load_dwordx4 v245, s[16:19], s43 offen offset:2048 nt lds
    ds_read_b64_tr_b16 a[136:137], v228 offset:34816
    v_accvgpr_write_b32 a44, v28
    v_accvgpr_write_b32 a45, v29
    v_mfma_f32_16x16x32_bf16 v[92:95], a[128:131], v[192:195], v[92:95]
    ds_read_b64_tr_b16 a[138:139], v228 offset:35840
    v_accvgpr_write_b32 a46, v30
    v_exp_f32 v150, v150
    v_accvgpr_write_b32 a47, v31
    v_mfma_f32_16x16x32_bf16 v[124:127], a[128:131], v[196:199], v[124:127]
    s_waitcnt lgkmcnt(3)
    ds_read_b64_tr_b16 a[140:141], v229 offset:34816
    ds_read_b64_tr_b16 a[142:143], v229 offset:35840
    v_mfma_f32_16x16x32_bf16 v[96:99], a[132:135], v[192:195], v[96:99]
    v_exp_f32 v151, v151
    v_mfma_f32_16x16x32_bf16 v[128:131], a[132:135], v[196:199], v[128:131]
    s_waitcnt lgkmcnt(4)
    v_exp_f32 v156, v156
    v_mfma_f32_16x16x32_bf16 a[252:255], a[240:243], a[228:231], a[252:255]
    s_waitcnt lgkmcnt(2)
    ds_read_b128 a[144:147], v214 offset:18432
    v_cvt_pk_bf16_f32 v200, v180, v181
    v_mfma_f32_16x16x32_bf16 v[100:103], a[136:139], v[192:195], v[100:103]
    v_exp_f32 v157, v157
    v_mfma_f32_16x16x32_bf16 v[132:135], a[136:139], v[196:199], v[132:135]
    ds_read_b128 a[148:151], v215 offset:18432
    v_cvt_pk_bf16_f32 v201, v182, v183
    v_mfma_f32_16x16x32_bf16 v[140:143], a[136:139], a[228:231], v[140:143]
    s_waitcnt lgkmcnt(2)
    ds_read_b128 a[152:155], v216 offset:18432
    v_cvt_pk_bf16_f32 v184, v148, v149
    v_mfma_f32_16x16x32_bf16 v[104:107], a[140:143], v[192:195], v[104:107]
    ds_read_b128 a[156:159], v217 offset:18432
    v_exp_f32 v158, v158
    v_mfma_f32_16x16x32_bf16 v[136:139], a[140:143], v[196:199], v[136:139]
    v_exp_f32 v159, v159
    v_mfma_f32_16x16x32_bf16 v[144:147], a[140:143], a[228:231], v[144:147]
    s_waitcnt lgkmcnt(3)
    buffer_load_dwordx4 v245, s[16:19], s43 offen offset:3072 nt lds
    v_mfma_f32_16x16x32_bf16 v[164:167], a[144:147], a[0:3], v[202:205]
    s_waitcnt lgkmcnt(2)
    v_exp_f32 v152, v152
    v_mfma_f32_16x16x32_bf16 v[164:167], a[148:151], a[4:7], v[164:167]
    s_waitcnt lgkmcnt(1)
    ds_read_b128 a[160:163], v214 offset:19456
    v_cvt_pk_bf16_f32 v185, v150, v151
    v_mfma_f32_16x16x32_bf16 v[164:167], a[152:155], a[8:11], v[164:167]
    s_waitcnt lgkmcnt(1)
    ds_read_b128 a[164:167], v215 offset:19456
    v_cvt_pk_bf16_f32 v186, v156, v157
    v_mfma_f32_16x16x32_bf16 v[164:167], a[156:159], a[12:15], v[164:167]
    s_add_u32 m0, s39, 16384
    v_exp_f32 v153, v153
    v_mfma_f32_16x16x32_bf16 v[168:171], a[156:159], a[76:79], v[206:209]
    s_add_u32 s43, s60, 0
    ds_read_b128 a[168:171], v216 offset:19456
    ds_write_b64 v243, v[200:201] offset:0
    ds_read_b128 a[172:175], v217 offset:19456
    v_mfma_f32_16x16x32_bf16 v[168:171], a[152:155], a[72:75], v[168:171]
    v_exp_f32 v154, v154
    v_mfma_f32_16x16x32_bf16 v[168:171], a[148:151], a[68:71], v[168:171]
    v_exp_f32 v155, v155
    v_mfma_f32_16x16x32_bf16 v[168:171], a[144:147], a[64:67], v[168:171]
    s_waitcnt vmcnt(4) lgkmcnt(0)
    s_barrier
    v_mfma_f32_16x16x32_bf16 v[172:175], a[160:163], a[0:3], v[202:205]
    v_exp_f32 v160, v160
    v_mfma_f32_16x16x32_bf16 v[172:175], a[164:167], a[4:7], v[172:175]
    ds_read_b64_tr_b16 a[128:129], v222 offset:16384
    ds_read_b64_tr_b16 a[130:131], v222 offset:17408
    v_mfma_f32_16x16x32_bf16 v[172:175], a[168:171], a[8:11], v[172:175]
    buffer_load_dwordx4 v246, s[24:27], s43 offen offset:0  lds
    v_mfma_f32_16x16x32_bf16 v[172:175], a[172:175], a[12:15], v[172:175]
    s_add_u32 s43, s60, 15360
    v_exp_f32 v161, v161
    v_mfma_f32_16x16x32_bf16 v[176:179], a[172:175], a[76:79], v[206:209]
    ds_read_b64_tr_b16 a[132:133], v223 offset:16384
    ds_read_b64_tr_b16 a[134:135], v223 offset:17408
    v_mfma_f32_16x16x32_bf16 v[176:179], a[168:171], a[72:75], v[176:179]
    v_exp_f32 v162, v162
    v_mfma_f32_16x16x32_bf16 v[176:179], a[164:167], a[68:71], v[176:179]
    buffer_load_dwordx4 v246, s[24:27], s43 offen offset:1024  lds
    v_cvt_pk_bf16_f32 v187, v158, v159
    v_mfma_f32_16x16x32_bf16 v[176:179], a[160:163], a[64:67], v[176:179]
    s_waitcnt lgkmcnt(2)
    ds_read_b64_tr_b16 a[136:137], v224 offset:16384
    v_cvt_pk_bf16_f32 v188, v152, v153
    v_cvt_pk_bf16_f32 v189, v154, v155
    v_mfma_f32_16x16x32_bf16 v[76:79], a[128:131], v[184:187], v[76:79]
    v_exp_f32 v163, v163
    v_cvt_pk_bf16_f32 v190, v160, v161
    v_cvt_pk_bf16_f32 v191, v162, v163
    s_add_u32 m0, s39, 49152
    ds_read_b64_tr_b16 a[138:139], v224 offset:17408
    v_mul_f32 v60, v239, v60
    v_mfma_f32_16x16x32_bf16 v[108:111], a[128:131], v[188:191], v[108:111]
    s_waitcnt lgkmcnt(2)
    s_add_u32 s43, s40, 229376
    ds_read_b64_tr_b16 a[140:141], v225 offset:16384
    v_exp_f32 v164, v164
    v_mul_f32 v61, v239, v61
    v_mfma_f32_16x16x32_bf16 v[80:83], a[132:135], v[184:187], v[80:83]
    buffer_load_dwordx4 v244, s[12:15], s43 offen offset:0 nt lds
    ds_read_b64_tr_b16 a[142:143], v225 offset:17408
    v_mul_f32 v62, v239, v62
    v_mfma_f32_16x16x32_bf16 v[112:115], a[132:135], v[188:191], v[112:115]
    s_add_u32 m0, s39, 18432
    v_exp_f32 v165, v165
    v_mul_f32 v63, v239, v63
    v_mfma_f32_16x16x32_bf16 a[244:247], a[240:243], v[184:187], a[244:247]
    s_waitcnt lgkmcnt(2)
    ds_read_b64_tr_b16 a[144:145], v226 offset:16384
    ds_read_b64_tr_b16 a[146:147], v226 offset:17408
    v_mul_f32 v64, v239, v64
    v_mul_f32 v65, v239, v65
    v_mfma_f32_16x16x32_bf16 v[84:87], a[136:139], v[184:187], v[84:87]
    s_add_u32 s43, s60, 32768
    v_exp_f32 v166, v166
    v_mul_f32 v66, v239, v66
    v_mul_f32 v67, v239, v67
    v_mfma_f32_16x16x32_bf16 v[116:119], a[136:139], v[188:191], v[116:119]
    s_waitcnt lgkmcnt(2)
    ds_read_b64_tr_b16 a[148:149], v227 offset:16384
    ds_read_b64_tr_b16 a[150:151], v227 offset:17408
    v_cvt_pk_bf16_f32 v60, v60, v61
    v_cvt_pk_bf16_f32 v61, v62, v63
    v_mfma_f32_16x16x32_bf16 v[88:91], a[140:143], v[184:187], v[88:91]
    buffer_load_dwordx4 v246, s[24:27], s43 offen offset:0  lds
    v_exp_f32 v167, v167
    v_cvt_pk_bf16_f32 v62, v64, v65
    v_cvt_pk_bf16_f32 v63, v66, v67
    v_mfma_f32_16x16x32_bf16 v[120:123], a[140:143], v[188:191], v[120:123]
    s_add_u32 s43, s60, 48128
    ds_read_b128 a[224:227], v242 offset:16384
    ds_read_b64_tr_b16 a[152:153], v228 offset:16384
    v_accvgpr_write_b32 a60, v60
    v_accvgpr_write_b32 a61, v61
    v_mfma_f32_16x16x32_bf16 a[248:251], a[240:243], v[188:191], a[248:251]
    s_waitcnt lgkmcnt(4)
    buffer_load_dwordx4 v246, s[24:27], s43 offen offset:1024  lds
    v_exp_f32 v172, v172
    v_accvgpr_write_b32 a62, v62
    v_accvgpr_write_b32 a63, v63
    v_mfma_f32_16x16x32_bf16 v[92:95], a[144:147], v[184:187], v[92:95]
    s_add_u32 m0, s39, 50176
    ds_read_b64_tr_b16 a[154:155], v228 offset:17408
    v_cvt_pk_bf16_f32 v192, v164, v165
    v_mfma_f32_16x16x32_bf16 v[124:127], a[144:147], v[188:191], v[124:127]
    s_waitcnt lgkmcnt(3)
    v_exp_f32 v173, v173
    v_mfma_f32_16x16x32_bf16 v[96:99], a[148:151], v[184:187], v[96:99]
    s_add_u32 s43, s40, 230400
    ds_read_b64_tr_b16 a[156:157], v229 offset:16384
    ds_read_b64_tr_b16 a[158:159], v229 offset:17408
    v_mfma_f32_16x16x32_bf16 v[128:131], a[148:151], v[188:191], v[128:131]
    s_waitcnt lgkmcnt(4)
    v_exp_f32 v174, v174
    v_mfma_f32_16x16x32_bf16 a[252:255], a[240:243], a[224:227], a[252:255]
    s_waitcnt lgkmcnt(2)
    buffer_load_dwordx4 v244, s[12:15], s43 offen offset:0 nt lds
    v_mfma_f32_16x16x32_bf16 v[100:103], a[152:155], v[184:187], v[100:103]
    ds_read_b128 a[160:163], v218 offset:0
    v_exp_f32 v175, v175
    v_mfma_f32_16x16x32_bf16 v[132:135], a[152:155], v[188:191], v[132:135]
    buffer_load_dwordx4 v244, s[12:15], s43 offen offset:1024 nt lds
    ds_read_b128 a[164:167], v219 offset:0
    v_mfma_f32_16x16x32_bf16 v[140:143], a[152:155], a[224:227], v[140:143]
    s_waitcnt lgkmcnt(2)
    ds_read_b128 a[168:171], v220 offset:0
    v_exp_f32 v168, v168
    v_mfma_f32_16x16x32_bf16 v[104:107], a[156:159], v[184:187], v[104:107]
    buffer_load_dwordx4 v244, s[12:15], s43 offen offset:2048 nt lds
    ds_read_b128 a[172:175], v221 offset:0
    v_mfma_f32_16x16x32_bf16 v[136:139], a[156:159], v[188:191], v[136:139]
    s_add_u32 m0, s39, 114688
    ds_read_b128 a[128:131], v214 offset:0
    v_exp_f32 v169, v169
    v_mfma_f32_16x16x32_bf16 v[144:147], a[156:159], a[224:227], v[144:147]
    s_waitcnt lgkmcnt(4)
    ds_read_b128 a[132:135], v215 offset:0
    v_cvt_pk_bf16_f32 v193, v166, v167
    v_mfma_f32_16x16x32_bf16 v[180:183], a[160:163], a[16:19], v[210:213]
    s_waitcnt lgkmcnt(4)
    ds_read_b128 a[136:139], v216 offset:0
    v_exp_f32 v170, v170
    v_mfma_f32_16x16x32_bf16 v[180:183], a[164:167], a[20:23], v[180:183]
    s_waitcnt lgkmcnt(4)
    ds_read_b128 a[140:143], v217 offset:0
    v_cvt_pk_bf16_f32 v194, v172, v173
    v_mfma_f32_16x16x32_bf16 v[180:183], a[168:171], a[24:27], v[180:183]
    s_waitcnt lgkmcnt(4)
    v_exp_f32 v171, v171
    v_mfma_f32_16x16x32_bf16 v[180:183], a[172:175], a[28:31], v[180:183]
    s_waitcnt lgkmcnt(3)
    v_exp_f32 v176, v176
    v_mfma_f32_16x16x32_bf16 v[148:151], a[128:131], a[0:3], v[202:205]
    s_waitcnt lgkmcnt(2)
    ds_read_b128 a[144:147], v214 offset:1024
    v_cvt_pk_bf16_f32 v195, v174, v175
    v_mfma_f32_16x16x32_bf16 v[148:151], a[132:135], a[4:7], v[148:151]
    s_waitcnt lgkmcnt(2)
    s_add_u32 s43, s40, 229376
    ds_read_b128 a[148:151], v215 offset:1024
    v_mfma_f32_16x16x32_bf16 v[148:151], a[136:139], a[8:11], v[148:151]
    s_waitcnt lgkmcnt(2)
    buffer_load_dwordx4 v245, s[16:19], s43 offen offset:0 nt lds
    v_exp_f32 v177, v177
    v_mfma_f32_16x16x32_bf16 v[148:151], a[140:143], a[12:15], v[148:151]
    v_exp_f32 v178, v178
    v_mfma_f32_16x16x32_bf16 v[152:155], a[140:143], a[76:79], v[206:209]
    ds_read_b128 a[152:155], v216 offset:1024
    v_cvt_pk_bf16_f32 v196, v168, v169
    v_mfma_f32_16x16x32_bf16 v[152:155], a[136:139], a[72:75], v[152:155]
    ds_read_b128 a[156:159], v217 offset:1024
    v_cvt_pk_bf16_f32 v197, v170, v171
    v_mfma_f32_16x16x32_bf16 v[152:155], a[132:135], a[68:71], v[152:155]
    v_exp_f32 v179, v179
    v_mfma_f32_16x16x32_bf16 v[152:155], a[128:131], a[64:67], v[152:155]
    s_waitcnt lgkmcnt(3)
    v_exp_f32 v180, v180
    v_mfma_f32_16x16x32_bf16 v[156:159], a[144:147], a[0:3], v[202:205]
    s_waitcnt lgkmcnt(2)
    ds_read_b64_tr_b16 a[160:161], v222 offset:18432
    v_cvt_pk_bf16_f32 v198, v176, v177
    v_mfma_f32_16x16x32_bf16 v[156:159], a[148:151], a[4:7], v[156:159]
    s_waitcnt lgkmcnt(2)
    v_exp_f32 v181, v181
    v_mfma_f32_16x16x32_bf16 v[156:159], a[152:155], a[8:11], v[156:159]
    s_waitcnt lgkmcnt(1)
    ds_read_b64_tr_b16 a[162:163], v222 offset:19456
    v_cvt_pk_bf16_f32 v199, v178, v179
    v_mfma_f32_16x16x32_bf16 v[156:159], a[156:159], a[12:15], v[156:159]
    ds_read_b64_tr_b16 a[164:165], v223 offset:18432
    ds_read_b64_tr_b16 a[166:167], v223 offset:19456
    v_mfma_f32_16x16x32_bf16 v[160:163], a[156:159], a[76:79], v[206:209]
    v_exp_f32 v182, v182
    v_mfma_f32_16x16x32_bf16 v[160:163], a[152:155], a[72:75], v[160:163]
    v_exp_f32 v183, v183
    v_mfma_f32_16x16x32_bf16 v[160:163], a[148:151], a[68:71], v[160:163]
    buffer_load_dwordx4 v245, s[16:19], s43 offen offset:1024 nt lds
    v_mfma_f32_16x16x32_bf16 v[160:163], a[144:147], a[64:67], v[160:163]
    s_waitcnt lgkmcnt(2)
    ds_read_b64_tr_b16 a[168:169], v224 offset:18432
    ds_read_b64_tr_b16 a[170:171], v224 offset:19456
    v_mfma_f32_16x16x32_bf16 v[76:79], a[160:163], v[192:195], v[76:79]
    v_exp_f32 v148, v148
    v_mfma_f32_16x16x32_bf16 v[108:111], a[160:163], v[196:199], v[108:111]
    s_waitcnt lgkmcnt(2)
    ds_read_b64_tr_b16 a[172:173], v225 offset:18432
    ds_read_b64_tr_b16 a[174:175], v225 offset:19456
    v_mfma_f32_16x16x32_bf16 v[80:83], a[164:167], v[192:195], v[80:83]
    v_exp_f32 v149, v149
    v_mfma_f32_16x16x32_bf16 v[112:115], a[164:167], v[196:199], v[112:115]
    ds_read_b64_tr_b16 a[128:129], v226 offset:18432
    ds_read_b64_tr_b16 a[130:131], v226 offset:19456
    v_mfma_f32_16x16x32_bf16 a[244:247], a[240:243], v[192:195], a[244:247]
    s_waitcnt lgkmcnt(4)
    v_exp_f32 v150, v150
    v_mfma_f32_16x16x32_bf16 v[84:87], a[168:171], v[192:195], v[84:87]
    ds_read_b64_tr_b16 a[132:133], v227 offset:18432
    ds_read_b64_tr_b16 a[134:135], v227 offset:19456
    v_mfma_f32_16x16x32_bf16 v[116:119], a[168:171], v[196:199], v[116:119]
    s_waitcnt lgkmcnt(4)
    v_exp_f32 v151, v151
    v_mfma_f32_16x16x32_bf16 v[88:91], a[172:175], v[192:195], v[88:91]
    ds_read_b128 a[228:231], v242 offset:17408
    v_cvt_pk_bf16_f32 v200, v180, v181
    v_mfma_f32_16x16x32_bf16 v[120:123], a[172:175], v[196:199], v[120:123]
    v_exp_f32 v156, v156
    v_mfma_f32_16x16x32_bf16 a[248:251], a[240:243], v[196:199], a[248:251]
    s_waitcnt lgkmcnt(3)
    ds_read_b64_tr_b16 a[136:137], v228 offset:18432
    ds_read_b64_tr_b16 a[138:139], v228 offset:19456
    v_mfma_f32_16x16x32_bf16 v[92:95], a[128:131], v[192:195], v[92:95]
    buffer_load_dwordx4 v245, s[16:19], s43 offen offset:2048 nt lds
    v_exp_f32 v157, v157
    v_mfma_f32_16x16x32_bf16 v[124:127], a[128:131], v[196:199], v[124:127]
    s_waitcnt lgkmcnt(3)
    ds_read_b64_tr_b16 a[140:141], v229 offset:18432
    ds_read_b64_tr_b16 a[142:143], v229 offset:19456
    v_mfma_f32_16x16x32_bf16 v[96:99], a[132:135], v[192:195], v[96:99]
    v_exp_f32 v158, v158
    v_mfma_f32_16x16x32_bf16 v[128:131], a[132:135], v[196:199], v[128:131]
    s_waitcnt lgkmcnt(4)
    buffer_load_dwordx4 v245, s[16:19], s43 offen offset:3072 nt lds
    v_mfma_f32_16x16x32_bf16 a[252:255], a[240:243], a[228:231], a[252:255]
    s_waitcnt lgkmcnt(2)
    v_exp_f32 v159, v159
    v_mfma_f32_16x16x32_bf16 v[100:103], a[136:139], v[192:195], v[100:103]
    s_add_u32 m0, s39, 32768
    ds_read_b128 a[144:147], v214 offset:2048
    v_cvt_pk_bf16_f32 v201, v182, v183
    v_mfma_f32_16x16x32_bf16 v[132:135], a[136:139], v[196:199], v[132:135]
    s_add_u32 s43, s40, 245760
    ds_read_b128 a[148:151], v215 offset:2048
    v_exp_f32 v152, v152
    v_mfma_f32_16x16x32_bf16 v[140:143], a[136:139], a[228:231], v[140:143]
    s_waitcnt lgkmcnt(2)
    buffer_load_dwordx4 v244, s[12:15], s43 offen offset:0 nt lds
    ds_read_b128 a[152:155], v216 offset:2048
    v_mfma_f32_16x16x32_bf16 v[104:107], a[140:143], v[192:195], v[104:107]
    s_add_u32 s44, s48, 0
    ds_read_b128 a[156:159], v217 offset:2048
    v_exp_f32 v153, v153
    v_mfma_f32_16x16x32_bf16 v[136:139], a[140:143], v[196:199], v[136:139]
    v_exp_f32 v154, v154
    v_mfma_f32_16x16x32_bf16 v[144:147], a[140:143], a[228:231], v[144:147]
    s_waitcnt lgkmcnt(3)
    ds_read_b128 a[160:163], v214 offset:3072
    v_cvt_pk_bf16_f32 v184, v148, v149
    v_mfma_f32_16x16x32_bf16 v[164:167], a[144:147], a[0:3], v[202:205]
    s_waitcnt lgkmcnt(3)
    buffer_store_dwordx4 v[4:7], v247, s[28:31], s44 offen offset:0 sc1
    v_mfma_f32_16x16x32_bf16 v[164:167], a[148:151], a[4:7], v[164:167]
    s_waitcnt lgkmcnt(2)
    v_exp_f32 v155, v155
    v_mfma_f32_16x16x32_bf16 v[164:167], a[152:155], a[8:11], v[164:167]
    s_waitcnt lgkmcnt(1)
    ds_read_b128 a[164:167], v215 offset:3072
    v_cvt_pk_bf16_f32 v185, v150, v151
    v_mfma_f32_16x16x32_bf16 v[164:167], a[156:159], a[12:15], v[164:167]
    s_add_u32 s44, s48, 4096
    buffer_store_dwordx4 v[36:39], v247, s[28:31], s44 offen offset:0 sc1
    v_exp_f32 v160, v160
    v_mfma_f32_16x16x32_bf16 v[168:171], a[156:159], a[76:79], v[206:209]
    s_add_u32 s44, s49, 0
    ds_read_b128 a[168:171], v216 offset:3072
    ds_write_b64 v243, v[200:201] offset:2048
    ds_read_b128 a[172:175], v217 offset:3072
    v_mfma_f32_16x16x32_bf16 v[168:171], a[152:155], a[72:75], v[168:171]
    v_exp_f32 v161, v161
    v_mfma_f32_16x16x32_bf16 v[168:171], a[148:151], a[68:71], v[168:171]
    buffer_store_dwordx4 v[12:15], v247, s[28:31], s44 offen offset:0 sc1
    v_mfma_f32_16x16x32_bf16 v[168:171], a[144:147], a[64:67], v[168:171]
    s_waitcnt vmcnt(8) lgkmcnt(0)
    s_barrier
    v_exp_f32 v162, v162
    v_mfma_f32_16x16x32_bf16 v[172:175], a[160:163], a[0:3], v[202:205]
    v_exp_f32 v163, v163
    v_mfma_f32_16x16x32_bf16 v[172:175], a[164:167], a[4:7], v[172:175]
    s_add_u32 s44, s49, 4096
    ds_read_b64_tr_b16 a[128:129], v222 offset:0
    v_mfma_f32_16x16x32_bf16 v[172:175], a[168:171], a[8:11], v[172:175]
    buffer_store_dwordx4 v[44:47], v247, s[28:31], s44 offen offset:0 sc1
    ds_read_b64_tr_b16 a[130:131], v222 offset:1024
    v_mfma_f32_16x16x32_bf16 v[172:175], a[172:175], a[12:15], v[172:175]
    s_add_u32 s44, s50, 0
    v_exp_f32 v164, v164
    v_mfma_f32_16x16x32_bf16 v[176:179], a[172:175], a[76:79], v[206:209]
    buffer_store_dwordx4 v[20:23], v247, s[28:31], s44 offen offset:0 sc1
    ds_read_b64_tr_b16 a[132:133], v223 offset:0
    v_mfma_f32_16x16x32_bf16 v[176:179], a[168:171], a[72:75], v[176:179]
    s_add_u32 s44, s50, 4096
    ds_read_b64_tr_b16 a[134:135], v223 offset:1024
    v_cvt_pk_bf16_f32 v186, v156, v157
    v_exp_f32 v165, v165
    v_mfma_f32_16x16x32_bf16 v[176:179], a[164:167], a[68:71], v[176:179]
    buffer_store_dwordx4 v[52:55], v247, s[28:31], s44 offen offset:0 sc1
    v_cvt_pk_bf16_f32 v187, v158, v159
    v_mfma_f32_16x16x32_bf16 v[176:179], a[160:163], a[64:67], v[176:179]
    s_waitcnt lgkmcnt(2)
    ds_read_b64_tr_b16 a[136:137], v224 offset:0
    v_cvt_pk_bf16_f32 v188, v152, v153
    v_cvt_pk_bf16_f32 v189, v154, v155
    v_mfma_f32_16x16x32_bf16 v[76:79], a[128:131], v[184:187], v[76:79]
    v_cvt_pk_bf16_f32 v190, v160, v161
    v_cvt_pk_bf16_f32 v191, v162, v163
    s_add_u32 s44, s64, 0
    v_exp_f32 v166, v166
    ds_read_b64_tr_b16 a[138:139], v224 offset:1024
    v_mfma_f32_16x16x32_bf16 v[108:111], a[128:131], v[188:191], v[108:111]
    s_waitcnt lgkmcnt(2)
    buffer_store_dwordx4 v[68:71], v252, s[28:31], s44 offen offset:0 sc1
    ds_read_b64_tr_b16 a[140:141], v225 offset:0
    v_mfma_f32_16x16x32_bf16 v[80:83], a[132:135], v[184:187], v[80:83]
    s_add_u32 s44, s51, 0
    ds_read_b64_tr_b16 a[142:143], v225 offset:1024
    v_exp_f32 v167, v167
    v_mfma_f32_16x16x32_bf16 v[112:115], a[132:135], v[188:191], v[112:115]
    v_exp_f32 v172, v172
    v_mfma_f32_16x16x32_bf16 a[244:247], a[240:243], v[184:187], a[244:247]
    s_waitcnt lgkmcnt(2)
    ds_read_b64_tr_b16 a[144:145], v226 offset:0
    ds_read_b64_tr_b16 a[146:147], v226 offset:1024
    v_mfma_f32_16x16x32_bf16 v[84:87], a[136:139], v[184:187], v[84:87]
    buffer_store_dwordx4 v[28:31], v247, s[28:31], s44 offen offset:0 sc1
    v_exp_f32 v173, v173
    v_mfma_f32_16x16x32_bf16 v[116:119], a[136:139], v[188:191], v[116:119]
    s_waitcnt lgkmcnt(2)
    ds_read_b64_tr_b16 a[148:149], v227 offset:0
    ds_read_b64_tr_b16 a[150:151], v227 offset:1024
    v_mfma_f32_16x16x32_bf16 v[88:91], a[140:143], v[184:187], v[88:91]
    v_exp_f32 v174, v174
    v_mfma_f32_16x16x32_bf16 v[120:123], a[140:143], v[188:191], v[120:123]
    ds_read_b128 a[224:227], v242 offset:18432
    ds_read_b64_tr_b16 a[152:153], v228 offset:0
    v_mfma_f32_16x16x32_bf16 a[248:251], a[240:243], v[188:191], a[248:251]
    s_waitcnt lgkmcnt(4)
    ds_read_b64_tr_b16 a[154:155], v228 offset:1024
    v_exp_f32 v175, v175
    v_mfma_f32_16x16x32_bf16 v[92:95], a[144:147], v[184:187], v[92:95]
    v_exp_f32 v168, v168
    v_mfma_f32_16x16x32_bf16 v[124:127], a[144:147], v[188:191], v[124:127]
    s_waitcnt lgkmcnt(3)
    ds_read_b64_tr_b16 a[156:157], v229 offset:0
    ds_read_b64_tr_b16 a[158:159], v229 offset:1024
    v_mfma_f32_16x16x32_bf16 v[96:99], a[148:151], v[184:187], v[96:99]
L_pad9:
    s_cbranch_execz L_back2
    v_exp_f32 v169, v169
    v_mfma_f32_16x16x32_bf16 v[128:131], a[148:151], v[188:191], v[128:131]
    s_waitcnt lgkmcnt(4)
    ds_read_b128 a[160:163], v218 offset:49152
    v_cvt_pk_bf16_f32 v192, v164, v165
    v_mfma_f32_16x16x32_bf16 a[252:255], a[240:243], a[224:227], a[252:255]
    s_waitcnt lgkmcnt(3)
    buffer_load_dwordx4 v244, s[12:15], s43 offen offset:1024 nt lds
    v_mfma_f32_16x16x32_bf16 v[100:103], a[152:155], v[184:187], v[100:103]
    v_exp_f32 v170, v170
    v_mfma_f32_16x16x32_bf16 v[132:135], a[152:155], v[188:191], v[132:135]
    buffer_load_dwordx4 v244, s[12:15], s43 offen offset:2048 nt lds
    ds_read_b128 a[164:167], v219 offset:49152
    v_mfma_f32_16x16x32_bf16 v[140:143], a[152:155], a[224:227], v[140:143]
    s_waitcnt lgkmcnt(2)
    ds_read_b128 a[168:171], v220 offset:49152
    v_exp_f32 v171, v171
    v_mfma_f32_16x16x32_bf16 v[104:107], a[156:159], v[184:187], v[104:107]
    buffer_load_dwordx4 v244, s[12:15], s43 offen offset:3072 nt lds
    ds_read_b128 a[172:175], v221 offset:49152
    v_mfma_f32_16x16x32_bf16 v[136:139], a[156:159], v[188:191], v[136:139]
    s_add_u32 m0, s39, 81920
    ds_read_b128 a[128:131], v214 offset:49152
    v_exp_f32 v176, v176
    v_mfma_f32_16x16x32_bf16 v[144:147], a[156:159], a[224:227], v[144:147]
    s_waitcnt lgkmcnt(4)
    ds_read_b128 a[132:135], v215 offset:49152
    v_cvt_pk_bf16_f32 v193, v166, v167
    v_mfma_f32_16x16x32_bf16 v[180:183], a[160:163], a[16:19], v[210:213]
    s_waitcnt lgkmcnt(4)
    ds_read_b128 a[136:139], v216 offset:49152
    v_exp_f32 v177, v177
    v_mfma_f32_16x16x32_bf16 v[180:183], a[164:167], a[20:23], v[180:183]
    s_waitcnt lgkmcnt(4)
    ds_read_b128 a[140:143], v217 offset:49152
    v_cvt_pk_bf16_f32 v194, v172, v173
    v_mfma_f32_16x16x32_bf16 v[180:183], a[168:171], a[24:27], v[180:183]
    s_waitcnt lgkmcnt(4)
    s_add_u32 s43, s60, 65536
    ds_read_b128 a[144:147], v214 offset:50176
    v_exp_f32 v178, v178
    v_mfma_f32_16x16x32_bf16 v[180:183], a[172:175], a[28:31], v[180:183]
    s_waitcnt lgkmcnt(4)
    buffer_load_dwordx4 v246, s[24:27], s43 offen offset:0  lds
    v_mfma_f32_16x16x32_bf16 v[148:151], a[128:131], a[0:3], v[202:205]
    s_waitcnt lgkmcnt(3)
    v_exp_f32 v179, v179
    v_mfma_f32_16x16x32_bf16 v[148:151], a[132:135], a[4:7], v[148:151]
    s_waitcnt lgkmcnt(2)
    ds_read_b128 a[148:151], v215 offset:50176
    v_cvt_pk_bf16_f32 v195, v174, v175
    v_mfma_f32_16x16x32_bf16 v[148:151], a[136:139], a[8:11], v[148:151]
    s_waitcnt lgkmcnt(2)
    ds_read_b128 a[152:155], v216 offset:50176
    v_cvt_pk_bf16_f32 v196, v168, v169
    v_mfma_f32_16x16x32_bf16 v[148:151], a[140:143], a[12:15], v[148:151]
    s_add_u32 s43, s60, 80896
    v_exp_f32 v180, v180
    v_mfma_f32_16x16x32_bf16 v[152:155], a[140:143], a[76:79], v[206:209]
    v_exp_f32 v181, v181
    v_mfma_f32_16x16x32_bf16 v[152:155], a[136:139], a[72:75], v[152:155]
    ds_read_b128 a[156:159], v217 offset:50176
    v_cvt_pk_bf16_f32 v197, v170, v171
    v_mfma_f32_16x16x32_bf16 v[152:155], a[132:135], a[68:71], v[152:155]
    v_exp_f32 v182, v182
    v_mfma_f32_16x16x32_bf16 v[152:155], a[128:131], a[64:67], v[152:155]
    s_waitcnt lgkmcnt(3)
    v_exp_f32 v183, v183
    v_mfma_f32_16x16x32_bf16 v[156:159], a[144:147], a[0:3], v[202:205]
    s_waitcnt lgkmcnt(2)
    ds_read_b64_tr_b16 a[160:161], v222 offset:2048
    v_cvt_pk_bf16_f32 v198, v176, v177
    v_mfma_f32_16x16x32_bf16 v[156:159], a[148:151], a[4:7], v[156:159]
    s_waitcnt lgkmcnt(2)
    v_exp_f32 v148, v148
    v_mfma_f32_16x16x32_bf16 v[156:159], a[152:155], a[8:11], v[156:159]
    s_waitcnt lgkmcnt(1)
    ds_read_b64_tr_b16 a[162:163], v222 offset:3072
    v_cvt_pk_bf16_f32 v199, v178, v179
    v_mfma_f32_16x16x32_bf16 v[156:159], a[156:159], a[12:15], v[156:159]
    buffer_load_dwordx4 v246, s[24:27], s43 offen offset:1024  lds
    v_mfma_f32_16x16x32_bf16 v[160:163], a[156:159], a[76:79], v[206:209]
    s_add_u32 m0, s39, 98304
    ds_read_b64_tr_b16 a[164:165], v223 offset:2048
    ds_read_b64_tr_b16 a[166:167], v223 offset:3072
    v_exp_f32 v149, v149
    v_mfma_f32_16x16x32_bf16 v[160:163], a[152:155], a[72:75], v[160:163]
    s_add_u32 s43, s40, 245760
    v_exp_f32 v150, v150
    v_mfma_f32_16x16x32_bf16 v[160:163], a[148:151], a[68:71], v[160:163]
    ds_read_b64_tr_b16 a[168:169], v224 offset:2048
    ds_read_b64_tr_b16 a[170:171], v224 offset:3072
    v_mfma_f32_16x16x32_bf16 v[160:163], a[144:147], a[64:67], v[160:163]
    s_waitcnt lgkmcnt(4)
    v_exp_f32 v151, v151
    v_mfma_f32_16x16x32_bf16 v[76:79], a[160:163], v[192:195], v[76:79]
    ds_read_b64_tr_b16 a[172:173], v225 offset:2048
    ds_read_b64_tr_b16 a[174:175], v225 offset:3072
    v_mfma_f32_16x16x32_bf16 v[108:111], a[160:163], v[196:199], v[108:111]
    s_waitcnt lgkmcnt(4)
    v_exp_f32 v156, v156
    v_mfma_f32_16x16x32_bf16 v[80:83], a[164:167], v[192:195], v[80:83]
    s_add_u32 s44, s51, 4096
    ds_read_b64_tr_b16 a[128:129], v226 offset:2048
    v_cvt_pk_bf16_f32 v200, v180, v181
    v_mfma_f32_16x16x32_bf16 v[112:115], a[164:167], v[196:199], v[112:115]
    v_exp_f32 v157, v157
    v_mfma_f32_16x16x32_bf16 a[244:247], a[240:243], v[192:195], a[244:247]
    s_waitcnt lgkmcnt(3)
    ds_read_b64_tr_b16 a[130:131], v226 offset:3072
    v_cvt_pk_bf16_f32 v201, v182, v183
    v_mfma_f32_16x16x32_bf16 v[84:87], a[168:171], v[192:195], v[84:87]
    ds_read_b64_tr_b16 a[132:133], v227 offset:2048
    ds_read_b64_tr_b16 a[134:135], v227 offset:3072
    v_mfma_f32_16x16x32_bf16 v[116:119], a[168:171], v[196:199], v[116:119]
    s_waitcnt lgkmcnt(4)
    v_exp_f32 v158, v158
    v_mfma_f32_16x16x32_bf16 v[88:91], a[172:175], v[192:195], v[88:91]
    buffer_store_dwordx4 v[60:63], v247, s[28:31], s44 offen offset:0 sc1
    v_mfma_f32_16x16x32_bf16 v[120:123], a[172:175], v[196:199], v[120:123]
    ds_read_b128 a[228:231], v242 offset:19456
    ds_read_b64_tr_b16 a[136:137], v228 offset:2048
    v_exp_f32 v159, v159
    v_mfma_f32_16x16x32_bf16 a[248:251], a[240:243], v[196:199], a[248:251]
    s_waitcnt lgkmcnt(4)
    ds_read_b64_tr_b16 a[138:139], v228 offset:3072
    v_cvt_pk_bf16_f32 v184, v148, v149
    v_mfma_f32_16x16x32_bf16 v[92:95], a[128:131], v[192:195], v[92:95]
    buffer_load_dwordx4 v245, s[16:19], s43 offen offset:0 nt lds
    v_exp_f32 v152, v152
    v_mfma_f32_16x16x32_bf16 v[124:127], a[128:131], v[196:199], v[124:127]
    s_waitcnt lgkmcnt(3)
    ds_read_b64_tr_b16 a[140:141], v229 offset:2048
    ds_read_b64_tr_b16 a[142:143], v229 offset:3072
    v_mfma_f32_16x16x32_bf16 v[96:99], a[132:135], v[192:195], v[96:99]
    s_add_u32 m0, s39, 83968
    v_exp_f32 v153, v153
    v_mfma_f32_16x16x32_bf16 v[128:131], a[132:135], v[196:199], v[128:131]
    s_waitcnt lgkmcnt(4)
    v_exp_f32 v154, v154
    v_mfma_f32_16x16x32_bf16 a[252:255], a[240:243], a[228:231], a[252:255]
    s_waitcnt lgkmcnt(2)
    s_add_u32 s43, s60, 98304
    ds_read_b128 a[144:147], v214 offset:51200
    v_mfma_f32_16x16x32_bf16 v[100:103], a[136:139], v[192:195], v[100:103]
    buffer_load_dwordx4 v246, s[24:27], s43 offen offset:0  lds
    v_mfma_f32_16x16x32_bf16 v[132:135], a[136:139], v[196:199], v[132:135]
    s_add_u32 s43, s60, 113664
    ds_read_b128 a[148:151], v215 offset:51200
    v_exp_f32 v155, v155
    v_mfma_f32_16x16x32_bf16 v[140:143], a[136:139], a[228:231], v[140:143]
    s_waitcnt lgkmcnt(2)
    ds_read_b128 a[152:155], v216 offset:51200
    v_cvt_pk_bf16_f32 v185, v150, v151
    v_mfma_f32_16x16x32_bf16 v[104:107], a[140:143], v[192:195], v[104:107]
    ds_read_b128 a[156:159], v217 offset:51200
    v_exp_f32 v160, v160
    v_mfma_f32_16x16x32_bf16 v[136:139], a[140:143], v[196:199], v[136:139]
    v_exp_f32 v161, v161
    v_mfma_f32_16x16x32_bf16 v[144:147], a[140:143], a[228:231], v[144:147]
    s_waitcnt lgkmcnt(3)
    ds_read_b128 a[160:163], v214 offset:52224
    v_cvt_pk_bf16_f32 v186, v156, v157
    v_mfma_f32_16x16x32_bf16 v[164:167], a[144:147], a[0:3], v[202:205]
    s_waitcnt lgkmcnt(3)
    v_exp_f32 v162, v162
    v_mfma_f32_16x16x32_bf16 v[164:167], a[148:151], a[4:7], v[164:167]
    s_waitcnt lgkmcnt(2)
    buffer_load_dwordx4 v246, s[24:27], s43 offen offset:1024  lds
    v_mfma_f32_16x16x32_bf16 v[164:167], a[152:155], a[8:11], v[164:167]
    s_waitcnt lgkmcnt(1)
    ds_read_b128 a[164:167], v215 offset:52224
    v_cvt_pk_bf16_f32 v187, v158, v159
    v_mfma_f32_16x16x32_bf16 v[164:167], a[156:159], a[12:15], v[164:167]
    s_add_u32 m0, s39, 99328
    v_exp_f32 v163, v163
    v_mfma_f32_16x16x32_bf16 v[168:171], a[156:159], a[76:79], v[206:209]
    s_add_u32 s43, s40, 246784
    ds_read_b128 a[168:171], v216 offset:52224
    ds_write_b64 v243, v[200:201] offset:0
    ds_read_b128 a[172:175], v217 offset:52224
    v_mfma_f32_16x16x32_bf16 v[168:171], a[152:155], a[72:75], v[168:171]
    v_cvt_pk_bf16_f32 v188, v152, v153
    v_cvt_pk_bf16_f32 v189, v154, v155
    v_mfma_f32_16x16x32_bf16 v[168:171], a[148:151], a[68:71], v[168:171]
    v_cvt_pk_bf16_f32 v190, v160, v161
    v_cvt_pk_bf16_f32 v191, v162, v163
    v_mfma_f32_16x16x32_bf16 v[168:171], a[144:147], a[64:67], v[168:171]
    s_waitcnt vmcnt(6) lgkmcnt(0)
    s_barrier
    v_exp_f32 v164, v164
    v_mfma_f32_16x16x32_bf16 v[172:175], a[160:163], a[0:3], v[202:205]
    v_exp_f32 v165, v165
    v_mfma_f32_16x16x32_bf16 v[172:175], a[164:167], a[4:7], v[172:175]
    buffer_load_dwordx4 v245, s[16:19], s43 offen offset:0 nt lds
    v_exp_f32 v166, v166
    v_mfma_f32_16x16x32_bf16 v[172:175], a[168:171], a[8:11], v[172:175]
    ds_read_b64_tr_b16 a[128:129], v222 offset:49152
    ds_read_b64_tr_b16 a[130:131], v222 offset:50176
    v_mfma_f32_16x16x32_bf16 v[172:175], a[172:175], a[12:15], v[172:175]
    s_add_u32 m0, s39, 0
    v_exp_f32 v167, v167
    v_mfma_f32_16x16x32_bf16 v[176:179], a[172:175], a[76:79], v[206:209]
    s_add_u32 s43, s60, 131072
    ds_read_b64_tr_b16 a[132:133], v223 offset:49152
    ds_read_b64_tr_b16 a[134:135], v223 offset:50176
    v_mfma_f32_16x16x32_bf16 v[176:179], a[168:171], a[72:75], v[176:179]
    buffer_load_dwordx4 v246, s[24:27], s43 offen offset:0  lds
    v_mfma_f32_16x16x32_bf16 v[176:179], a[164:167], a[68:71], v[176:179]
    s_add_u32 s43, s60, 146432
    ds_read_b64_tr_b16 a[136:137], v224 offset:49152
    ds_read_b64_tr_b16 a[138:139], v224 offset:50176
    v_mfma_f32_16x16x32_bf16 v[176:179], a[160:163], a[64:67], v[176:179]
    s_waitcnt lgkmcnt(4)
    v_exp_f32 v172, v172
    v_exp_f32 v173, v173
    v_mfma_f32_16x16x32_bf16 v[76:79], a[128:131], v[184:187], v[76:79]
    ds_read_b64_tr_b16 a[140:141], v225 offset:49152
    ds_read_b64_tr_b16 a[142:143], v225 offset:50176
    v_mfma_f32_16x16x32_bf16 v[108:111], a[128:131], v[188:191], v[108:111]
    s_waitcnt lgkmcnt(4)
    buffer_load_dwordx4 v246, s[24:27], s43 offen offset:1024  lds
    v_exp_f32 v174, v174
    v_mfma_f32_16x16x32_bf16 v[80:83], a[132:135], v[184:187], v[80:83]
    s_add_u32 m0, s39, 100352
    v_exp_f32 v175, v175
    v_mfma_f32_16x16x32_bf16 v[112:115], a[132:135], v[188:191], v[112:115]
    s_add_u32 s43, s40, 247808
    ds_read_b64_tr_b16 a[144:145], v226 offset:49152
    ds_read_b64_tr_b16 a[146:147], v226 offset:50176
    v_mfma_f32_16x16x32_bf16 a[244:247], a[240:243], v[184:187], a[244:247]
    s_waitcnt lgkmcnt(4)
    v_exp_f32 v168, v168
    v_mfma_f32_16x16x32_bf16 v[84:87], a[136:139], v[184:187], v[84:87]
    ds_read_b64_tr_b16 a[148:149], v227 offset:49152
    ds_read_b64_tr_b16 a[150:151], v227 offset:50176
    v_mfma_f32_16x16x32_bf16 v[116:119], a[136:139], v[188:191], v[116:119]
    s_waitcnt lgkmcnt(4)
    v_exp_f32 v169, v169
    v_mfma_f32_16x16x32_bf16 v[88:91], a[140:143], v[184:187], v[88:91]
    buffer_load_dwordx4 v245, s[16:19], s43 offen offset:0 nt lds
    v_mfma_f32_16x16x32_bf16 v[120:123], a[140:143], v[188:191], v[120:123]
    s_add_u32 m0, s39, 2048
    ds_read_b128 a[224:227], v242 offset:16384
    ds_read_b64_tr_b16 a[152:153], v228 offset:49152
    v_mfma_f32_16x16x32_bf16 a[248:251], a[240:243], v[188:191], a[248:251]
    s_waitcnt lgkmcnt(4)
    ds_read_b64_tr_b16 a[154:155], v228 offset:50176
    v_exp_f32 v170, v170
    v_mfma_f32_16x16x32_bf16 v[92:95], a[144:147], v[184:187], v[92:95]
    s_add_u32 s43, s60, 163840
    v_exp_f32 v171, v171
    v_mfma_f32_16x16x32_bf16 v[124:127], a[144:147], v[188:191], v[124:127]
    s_waitcnt lgkmcnt(3)
    buffer_load_dwordx4 v246, s[24:27], s43 offen offset:0  lds
    v_mfma_f32_16x16x32_bf16 v[96:99], a[148:151], v[184:187], v[96:99]
    s_add_u32 s43, s60, 179200
    ds_read_b64_tr_b16 a[156:157], v229 offset:49152
    ds_read_b64_tr_b16 a[158:159], v229 offset:50176
    v_mfma_f32_16x16x32_bf16 v[128:131], a[148:151], v[188:191], v[128:131]
    s_waitcnt lgkmcnt(4)
    v_exp_f32 v176, v176
    v_mfma_f32_16x16x32_bf16 a[252:255], a[240:243], a[224:227], a[252:255]
    s_waitcnt lgkmcnt(2)
    v_exp_f32 v177, v177
    v_mfma_f32_16x16x32_bf16 v[100:103], a[152:155], v[184:187], v[100:103]
    buffer_load_dwordx4 v246, s[24:27], s43 offen offset:1024  lds
    ds_read_b128 a[160:163], v218 offset:32768
    v_mfma_f32_16x16x32_bf16 v[132:135], a[152:155], v[188:191], v[132:135]
    s_add_u32 m0, s39, 101376
    ds_read_b128 a[164:167], v219 offset:32768
    v_cvt_pk_bf16_f32 v192, v164, v165
    v_mfma_f32_16x16x32_bf16 v[140:143], a[152:155], a[224:227], v[140:143]
    s_waitcnt lgkmcnt(2)
    ds_read_b128 a[168:171], v220 offset:32768
    v_exp_f32 v178, v178
    v_mfma_f32_16x16x32_bf16 v[104:107], a[156:159], v[184:187], v[104:107]
    s_add_u32 s43, s40, 248832
    ds_read_b128 a[172:175], v221 offset:32768
    v_cvt_pk_bf16_f32 v193, v166, v167
    v_mfma_f32_16x16x32_bf16 v[136:139], a[156:159], v[188:191], v[136:139]
    buffer_load_dwordx4 v245, s[16:19], s43 offen offset:0 nt lds
    v_exp_f32 v179, v179
    v_mfma_f32_16x16x32_bf16 v[144:147], a[156:159], a[224:227], v[144:147]
    s_waitcnt lgkmcnt(3)
    ds_read_b128 a[128:131], v214 offset:32768
    ds_read_b128 a[132:135], v215 offset:32768
    v_cvt_pk_bf16_f32 v194, v172, v173
    v_mfma_f32_16x16x32_bf16 v[180:183], a[160:163], a[16:19], v[210:213]
    s_waitcnt vmcnt(10) lgkmcnt(4)
    buffer_store_dword v0, v253, s[28:31], s47 offen offset:0 sc1
    ds_read_b128 a[136:139], v216 offset:32768
    v_mfma_f32_16x16x32_bf16 v[180:183], a[164:167], a[20:23], v[180:183]
    s_waitcnt lgkmcnt(4)
    ds_read_b128 a[140:143], v217 offset:32768
    v_cvt_pk_bf16_f32 v195, v174, v175
    v_mfma_f32_16x16x32_bf16 v[180:183], a[168:171], a[24:27], v[180:183]
    s_waitcnt lgkmcnt(4)
    s_add_u32 m0, s39, 65536
    s_add_u32 s43, s60, 196608
    v_mfma_f32_16x16x32_bf16 v[180:183], a[172:175], a[28:31], v[180:183]
    s_waitcnt lgkmcnt(3)
    buffer_load_dwordx4 v246, s[24:27], s43 offen offset:0  lds
    v_mfma_f32_16x16x32_bf16 v[148:151], a[128:131], a[0:3], v[202:205]
    s_waitcnt lgkmcnt(2)
    ds_read_b128 a[144:147], v214 offset:33792
    v_cvt_pk_bf16_f32 v196, v168, v169
    v_mfma_f32_16x16x32_bf16 v[148:151], a[132:135], a[4:7], v[148:151]
    s_waitcnt lgkmcnt(2)
    ds_read_b128 a[148:151], v215 offset:33792
    v_cvt_pk_bf16_f32 v197, v170, v171
    v_mfma_f32_16x16x32_bf16 v[148:151], a[136:139], a[8:11], v[148:151]
    s_waitcnt lgkmcnt(2)
    ds_read_b128 a[152:155], v216 offset:33792
    v_cvt_pk_bf16_f32 v198, v176, v177
    v_mfma_f32_16x16x32_bf16 v[148:151], a[140:143], a[12:15], v[148:151]
    s_add_u32 s43, s60, 211968
    v_exp_f32 v180, v180
    v_exp_f32 v181, v181
    v_exp_f32 v182, v182
    v_mfma_f32_16x16x32_bf16 v[152:155], a[140:143], a[76:79], v[206:209]
    v_exp_f32 v183, v183
    v_mfma_f32_16x16x32_bf16 v[152:155], a[136:139], a[72:75], v[152:155]
    buffer_load_dword a245, v1, s[24:27], s96 offen
    ds_read_b128 a[156:159], v217 offset:33792
    v_mfma_f32_16x16x32_bf16 v[152:155], a[132:135], a[68:71], v[152:155]
    s_add_u32 s96, s96, 4096
    ds_read_b64_tr_b16 a[160:161], v222 offset:51200
    v_cvt_pk_bf16_f32 v199, v178, v179
    v_mfma_f32_16x16x32_bf16 v[152:155], a[128:131], a[64:67], v[152:155]
    s_waitcnt lgkmcnt(4)
    v_exp_f32 v148, v148
    v_exp_f32 v149, v149
    v_mfma_f32_16x16x32_bf16 v[156:159], a[144:147], a[0:3], v[202:205]
    s_waitcnt lgkmcnt(3)
    buffer_load_dwordx4 v246, s[24:27], s43 offen offset:1024  lds
    v_exp_f32 v150, v150
    v_mfma_f32_16x16x32_bf16 v[156:159], a[148:151], a[4:7], v[156:159]
    s_waitcnt lgkmcnt(2)
    v_exp_f32 v151, v151
    v_mfma_f32_16x16x32_bf16 v[156:159], a[152:155], a[8:11], v[156:159]
    s_waitcnt lgkmcnt(1)
    ds_read_b64_tr_b16 a[162:163], v222 offset:52224
    v_cvt_pk_bf16_f32 v200, v180, v181
    v_mfma_f32_16x16x32_bf16 v[156:159], a[156:159], a[12:15], v[156:159]
    s_add_u32 s43, s60, 227328
    ds_read_b64_tr_b16 a[164:165], v223 offset:51200
    ds_read_b64_tr_b16 a[166:167], v223 offset:52224
    v_mfma_f32_16x16x32_bf16 v[160:163], a[156:159], a[76:79], v[206:209]
    buffer_load_dwordx4 v246, s[24:27], s43 offen offset:2048  lds
    v_mfma_f32_16x16x32_bf16 v[160:163], a[152:155], a[72:75], v[160:163]
    s_add_u32 s43, s60, 242688
    ds_read_b64_tr_b16 a[168:169], v224 offset:51200
    v_cvt_pk_bf16_f32 v201, v182, v183
    v_mfma_f32_16x16x32_bf16 v[160:163], a[148:151], a[68:71], v[160:163]
    ds_read_b64_tr_b16 a[170:171], v224 offset:52224
    v_cvt_pk_bf16_f32 v184, v148, v149
    v_mfma_f32_16x16x32_bf16 v[160:163], a[144:147], a[64:67], v[160:163]
    s_waitcnt lgkmcnt(4)
    v_exp_f32 v156, v156
    v_exp_f32 v157, v157
    v_mfma_f32_16x16x32_bf16 v[76:79], a[160:163], v[192:195], v[76:79]
    v_exp_f32 v158, v158
    v_mfma_f32_16x16x32_bf16 v[108:111], a[160:163], v[196:199], v[108:111]
    s_waitcnt lgkmcnt(2)
    ds_read_b64_tr_b16 a[172:173], v225 offset:51200
    ds_read_b64_tr_b16 a[174:175], v225 offset:52224
    v_mfma_f32_16x16x32_bf16 v[80:83], a[164:167], v[192:195], v[80:83]
    buffer_load_dword a245, v1, s[24:27], s96 offen
    v_exp_f32 v159, v159
    v_mfma_f32_16x16x32_bf16 v[112:115], a[164:167], v[196:199], v[112:115]
    s_add_u32 s96, s96, 4096
    ds_read_b64_tr_b16 a[128:129], v226 offset:51200
    ds_read_b64_tr_b16 a[130:131], v226 offset:52224
    v_mfma_f32_16x16x32_bf16 a[244:247], a[240:243], v[192:195], a[244:247]
    s_waitcnt lgkmcnt(4)
    v_exp_f32 v152, v152
    v_mfma_f32_16x16x32_bf16 v[84:87], a[168:171], v[192:195], v[84:87]
    buffer_load_dwordx4 v246, s[24:27], s43 offen offset:3072  lds
    v_mfma_f32_16x16x32_bf16 v[116:119], a[168:171], v[196:199], v[116:119]
    s_waitcnt lgkmcnt(2)
    ds_read_b64_tr_b16 a[132:133], v227 offset:51200
    ds_read_b64_tr_b16 a[134:135], v227 offset:52224
    v_exp_f32 v153, v153
    v_mfma_f32_16x16x32_bf16 v[88:91], a[172:175], v[192:195], v[88:91]
    s_add_u32 m0, s39, 49152
    ds_read_b128 a[228:231], v242 offset:17408
    v_cvt_pk_bf16_f32 v185, v150, v151
    v_mfma_f32_16x16x32_bf16 v[120:123], a[172:175], v[196:199], v[120:123]
    s_add_u32 s43, s61, 0
    v_exp_f32 v154, v154
    v_mfma_f32_16x16x32_bf16 a[248:251], a[240:243], v[196:199], a[248:251]
    s_waitcnt lgkmcnt(3)
    ds_read_b64_tr_b16 a[136:137], v228 offset:51200
    ds_read_b64_tr_b16 a[138:139], v228 offset:52224
    v_mfma_f32_16x16x32_bf16 v[92:95], a[128:131], v[192:195], v[92:95]
    buffer_load_dword a245, v1, s[24:27], s96 offen
    v_exp_f32 v155, v155
    v_mfma_f32_16x16x32_bf16 v[124:127], a[128:131], v[196:199], v[124:127]
    s_waitcnt lgkmcnt(3)
    ds_read_b64_tr_b16 a[140:141], v229 offset:51200
    ds_read_b64_tr_b16 a[142:143], v229 offset:52224
    v_mfma_f32_16x16x32_bf16 v[96:99], a[132:135], v[192:195], v[96:99]
    s_add_u32 s96, s96, 4096
    v_exp_f32 v160, v160
    v_mfma_f32_16x16x32_bf16 v[128:131], a[132:135], v[196:199], v[128:131]
    s_waitcnt lgkmcnt(4)
    v_exp_f32 v161, v161
    v_mfma_f32_16x16x32_bf16 a[252:255], a[240:243], a[228:231], a[252:255]
    s_waitcnt lgkmcnt(2)
    ds_read_b128 a[144:147], v214 offset:34816
    v_cvt_pk_bf16_f32 v186, v156, v157
    v_mfma_f32_16x16x32_bf16 v[100:103], a[136:139], v[192:195], v[100:103]
    v_exp_f32 v162, v162
    v_mfma_f32_16x16x32_bf16 v[132:135], a[136:139], v[196:199], v[132:135]
    ds_read_b128 a[148:151], v215 offset:34816
    v_cvt_pk_bf16_f32 v187, v158, v159
    v_mfma_f32_16x16x32_bf16 v[140:143], a[136:139], a[228:231], v[140:143]
    s_waitcnt lgkmcnt(2)
    buffer_load_dword a245, v1, s[24:27], s96 offen
    ds_read_b128 a[152:155], v216 offset:34816
    v_mfma_f32_16x16x32_bf16 v[104:107], a[140:143], v[192:195], v[104:107]
    s_add_u32 s96, s96, 4096
    ds_read_b128 a[156:159], v217 offset:34816
    v_exp_f32 v163, v163
    v_mfma_f32_16x16x32_bf16 v[136:139], a[140:143], v[196:199], v[136:139]
    ds_read_b128 a[160:163], v214 offset:35840
    v_cvt_pk_bf16_f32 v188, v152, v153
    v_mfma_f32_16x16x32_bf16 v[144:147], a[140:143], a[228:231], v[144:147]
    s_waitcnt lgkmcnt(4)
    ds_read_b128 a[164:167], v215 offset:35840
    v_cvt_pk_bf16_f32 v189, v154, v155
    v_mfma_f32_16x16x32_bf16 v[164:167], a[144:147], a[0:3], v[202:205]
    s_waitcnt lgkmcnt(4)
    buffer_load_dword a245, v1, s[24:27], s96 offen
    v_mfma_f32_16x16x32_bf16 v[164:167], a[148:151], a[4:7], v[164:167]
    s_waitcnt lgkmcnt(3)
    ds_read_b128 a[168:171], v216 offset:35840
    v_cvt_pk_bf16_f32 v190, v160, v161
    v_mfma_f32_16x16x32_bf16 v[164:167], a[152:155], a[8:11], v[164:167]
    s_waitcnt lgkmcnt(3)
    ds_write_b64 v243, v[200:201] offset:2048
    v_cvt_pk_bf16_f32 v191, v162, v163
    v_mfma_f32_16x16x32_bf16 v[164:167], a[156:159], a[12:15], v[164:167]
    s_add_u32 s96, s96, 4096
    ds_read_b128 a[172:175], v217 offset:35840
    v_xor_b32 v148, s3, v230
    v_mfma_f32_16x16x32_bf16 v[168:171], a[156:159], a[76:79], v[206:209]
    v_xor_b32 v156, s4, v230
    v_add_u32 v214, s80, v242
    v_mfma_f32_16x16x32_bf16 v[168:171], a[152:155], a[72:75], v[168:171]
    v_add_u32 v215, s81, v242
    v_add_u32 v216, s82, v242
    v_mfma_f32_16x16x32_bf16 v[168:171], a[148:151], a[68:71], v[168:171]
    v_add_u32 v217, s83, v242
    v_xor_b32 v149, s3, v231
    v_mfma_f32_16x16x32_bf16 v[168:171], a[144:147], a[64:67], v[168:171]
    s_waitcnt vmcnt(10) lgkmcnt(0)
    s_barrier
    v_exp_f32 v164, v164
    v_exp_f32 v165, v165
    v_mfma_f32_16x16x32_bf16 v[172:175], a[160:163], a[0:3], v[202:205]
    v_exp_f32 v166, v166
    v_exp_f32 v167, v167
    v_mfma_f32_16x16x32_bf16 v[172:175], a[164:167], a[4:7], v[172:175]
    ds_read_b64_tr_b16 a[128:129], v222 offset:32768
    ds_read_b64_tr_b16 a[130:131], v222 offset:33792
    v_mfma_f32_16x16x32_bf16 v[172:175], a[168:171], a[8:11], v[172:175]
    buffer_load_dword a245, v1, s[24:27], s96 offen
    v_mfma_f32_16x16x32_bf16 v[172:175], a[172:175], a[12:15], v[172:175]
    s_add_u32 s96, s96, 4096
    ds_read_b64_tr_b16 a[132:133], v223 offset:32768
    v_cvt_pk_bf16_f32 v192, v164, v165
    v_mfma_f32_16x16x32_bf16 v[176:179], a[172:175], a[76:79], v[206:209]
    ds_read_b64_tr_b16 a[134:135], v223 offset:33792
    v_cvt_pk_bf16_f32 v193, v166, v167
    v_mfma_f32_16x16x32_bf16 v[176:179], a[168:171], a[72:75], v[176:179]
    ds_read_b64_tr_b16 a[136:137], v224 offset:32768
    v_xor_b32 v164, s5, v230
    v_mfma_f32_16x16x32_bf16 v[176:179], a[164:167], a[68:71], v[176:179]
    v_exp_f32 v168, v168
    v_mfma_f32_16x16x32_bf16 v[176:179], a[160:163], a[64:67], v[176:179]
    s_waitcnt lgkmcnt(3)
    v_exp_f32 v172, v172
    v_exp_f32 v173, v173
    v_exp_f32 v174, v174
    v_mfma_f32_16x16x32_bf16 v[76:79], a[128:131], v[184:187], v[76:79]
    ds_read_b64_tr_b16 a[138:139], v224 offset:33792
    v_exp_f32 v175, v175
    v_mfma_f32_16x16x32_bf16 v[108:111], a[128:131], v[188:191], v[108:111]
    v_exp_f32 v169, v169
    v_mfma_f32_16x16x32_bf16 a[244:247], a[240:243], v[184:187], a[244:247]
    s_waitcnt lgkmcnt(2)
    ds_read_b128 a[224:227], v242 offset:18432
    ds_read_b64_tr_b16 a[140:141], v225 offset:32768
    v_mfma_f32_16x16x32_bf16 v[80:83], a[132:135], v[184:187], v[80:83]
    ds_read_b64_tr_b16 a[142:143], v225 offset:33792
    v_exp_f32 v170, v170
    v_mfma_f32_16x16x32_bf16 v[112:115], a[132:135], v[188:191], v[112:115]
    ds_read_b64_tr_b16 a[144:145], v226 offset:32768
    ds_read_b64_tr_b16 a[146:147], v226 offset:33792
    v_mfma_f32_16x16x32_bf16 a[248:251], a[240:243], v[188:191], a[248:251]
    s_waitcnt lgkmcnt(5)
    v_exp_f32 v171, v171
    v_mfma_f32_16x16x32_bf16 v[84:87], a[136:139], v[184:187], v[84:87]
    buffer_load_dword a245, v1, s[24:27], s96 offen
    v_mfma_f32_16x16x32_bf16 v[116:119], a[136:139], v[188:191], v[116:119]
    s_waitcnt lgkmcnt(4)
    ds_read_b128 a[228:231], v242 offset:19456
    v_exp_f32 v176, v176
    v_mfma_f32_16x16x32_bf16 a[252:255], a[240:243], a[224:227], a[252:255]
    s_waitcnt lgkmcnt(3)
    v_exp_f32 v177, v177
    v_mfma_f32_16x16x32_bf16 v[88:91], a[140:143], v[184:187], v[88:91]
    s_add_u32 s96, s96, 4096
    ds_read_b64_tr_b16 a[148:149], v222 offset:34816
    ds_read_b64_tr_b16 a[150:151], v222 offset:35840
    v_mfma_f32_16x16x32_bf16 v[120:123], a[140:143], v[188:191], v[120:123]
    s_waitcnt lgkmcnt(3)
    v_exp_f32 v178, v178
    v_mfma_f32_16x16x32_bf16 v[92:95], a[144:147], v[184:187], v[92:95]
    ds_read_b64_tr_b16 a[152:153], v223 offset:34816
    v_cvt_pk_bf16_f32 v194, v172, v173
    v_mfma_f32_16x16x32_bf16 v[124:127], a[144:147], v[188:191], v[124:127]
    s_waitcnt lgkmcnt(3)
    ds_read_b64_tr_b16 a[154:155], v223 offset:35840
    v_cvt_pk_bf16_f32 v195, v174, v175
    v_mfma_f32_16x16x32_bf16 a[252:255], a[240:243], a[228:231], a[252:255]
    v_exp_f32 v179, v179
    v_cvt_pk_bf16_f32 v196, v168, v169
    v_mfma_f32_16x16x32_bf16 a[244:247], a[240:243], v[192:195], a[244:247]
    ds_read_b64_tr_b16 a[156:157], v224 offset:34816
    v_cvt_pk_bf16_f32 v197, v170, v171
    v_cvt_pk_bf16_f32 v198, v176, v177
    v_cvt_pk_bf16_f32 v199, v178, v179
    s_nop 1
    v_mfma_f32_16x16x32_bf16 a[248:251], a[240:243], v[196:199], a[248:251]
    s_waitcnt lgkmcnt(3)
    ds_read_b64_tr_b16 a[158:159], v224 offset:35840
    ds_read_b64_tr_b16 a[160:161], v225 offset:34816
    v_mfma_f32_16x16x32_bf16 v[76:79], a[148:151], v[192:195], v[76:79]
    ds_read_b64_tr_b16 a[162:163], v225 offset:35840
    v_xor_b32 v172, s6, v230
    v_mfma_f32_16x16x32_bf16 v[108:111], a[148:151], v[196:199], v[108:111]
    s_waitcnt lgkmcnt(4)
    ds_read_b64_tr_b16 a[164:165], v226 offset:34816
    ds_read_b64_tr_b16 a[166:167], v226 offset:35840
    v_mfma_f32_16x16x32_bf16 v[80:83], a[152:155], v[192:195], v[80:83]
    buffer_load_dword a245, v1, s[24:27], s96 offen
    v_mfma_f32_16x16x32_bf16 v[112:115], a[152:155], v[196:199], v[112:115]
    s_waitcnt lgkmcnt(4)
    ds_read_b64_tr_b16 a[168:169], v227 offset:32768
    ds_read_b64_tr_b16 a[170:171], v227 offset:33792
    v_mfma_f32_16x16x32_bf16 v[84:87], a[156:159], v[192:195], v[84:87]
    s_add_u32 s96, s96, 4096
    ds_read_b64_tr_b16 a[172:173], v227 offset:34816
    ds_read_b64_tr_b16 a[174:175], v227 offset:35840
    v_mfma_f32_16x16x32_bf16 v[116:119], a[156:159], v[196:199], v[116:119]
    s_waitcnt lgkmcnt(6)
    ds_read_b64_tr_b16 a[128:129], v228 offset:32768
    v_accvgpr_read_b32 v238, a244
    v_mfma_f32_16x16x32_bf16 v[88:91], a[160:163], v[192:195], v[88:91]
    ds_read_b64_tr_b16 a[130:131], v228 offset:33792
    v_subrev_u32 v248, s78, v238
    v_mfma_f32_16x16x32_bf16 v[120:123], a[160:163], v[196:199], v[120:123]
    s_waitcnt lgkmcnt(6)
    ds_read_b64_tr_b16 a[132:133], v228 offset:34816
    v_accvgpr_read_b32 v239, a248
    v_mfma_f32_16x16x32_bf16 v[92:95], a[164:167], v[192:195], v[92:95]
    buffer_load_dword v254, v255, s[28:31], 0 offen offset:0 sc1
    v_mfma_f32_16x16x32_bf16 v[124:127], a[164:167], v[196:199], v[124:127]
    s_waitcnt lgkmcnt(5)
    ds_read_b64_tr_b16 a[134:135], v228 offset:35840
    v_subrev_u32 v249, s78, v239
    v_mfma_f32_16x16x32_bf16 v[96:99], a[168:171], v[184:187], v[96:99]
    s_waitcnt lgkmcnt(4)
    ds_read_b64_tr_b16 a[136:137], v229 offset:32768
    v_accvgpr_read_b32 v240, a252
    v_mfma_f32_16x16x32_bf16 v[96:99], a[172:175], v[192:195], v[96:99]
    ds_read_b64_tr_b16 a[138:139], v229 offset:33792
    v_subrev_u32 v250, s78, v240
    v_mfma_f32_16x16x32_bf16 v[128:131], a[172:175], v[196:199], v[128:131]
    ds_read_b64_tr_b16 a[140:141], v229 offset:34816
    v_max3_u32 v248, v248, v249, v250
    v_mfma_f32_16x16x32_bf16 v[128:131], a[168:171], v[188:191], v[128:131]
    s_waitcnt lgkmcnt(5)
    ds_read_b64_tr_b16 a[142:143], v229 offset:35840
    v_xor_b32 v157, s4, v231
    v_mfma_f32_16x16x32_bf16 v[100:103], a[128:131], v[184:187], v[100:103]
    s_waitcnt lgkmcnt(4)
    ds_write_b32 v241, v248
    v_xor_b32 v165, s5, v231
    v_mfma_f32_16x16x32_bf16 v[100:103], a[132:135], v[192:195], v[100:103]
    v_xor_b32 v173, s6, v231
    v_xor_b32 v150, s3, v232
    v_mfma_f32_16x16x32_bf16 v[132:135], a[132:135], v[196:199], v[132:135]
    v_xor_b32 v158, s4, v232
    v_xor_b32 v166, s5, v232
    v_mfma_f32_16x16x32_bf16 v[132:135], a[128:131], v[188:191], v[132:135]
    s_waitcnt lgkmcnt(1)
    s_barrier
    ds_read_b64_tr_b16 a[144:145], v148 offset:16384
    v_mfma_f32_16x16x32_bf16 v[140:143], a[128:131], a[224:227], v[140:143]
L_pad10:
    s_cbranch_execz L_back2
    ds_read_b64_tr_b16 a[146:147], v148 offset:17408
    v_xor_b32 v174, s6, v232
    v_mfma_f32_16x16x32_bf16 v[140:143], a[132:135], a[228:231], v[140:143]
    ds_read_b64_tr_b16 a[148:149], v156 offset:16384
    ds_read_b64_tr_b16 a[150:151], v156 offset:17408
    v_mfma_f32_16x16x32_bf16 v[104:107], a[136:139], v[184:187], v[104:107]
    ds_read_b64_tr_b16 a[152:153], v164 offset:16384
    v_xor_b32 v151, s3, v233
    v_mfma_f32_16x16x32_bf16 v[104:107], a[140:143], v[192:195], v[104:107]
    ds_read_b64_tr_b16 a[154:155], v164 offset:17408
    v_xor_b32 v159, s4, v233
    v_mfma_f32_16x16x32_bf16 v[136:139], a[140:143], v[196:199], v[136:139]
    ds_read_b64_tr_b16 a[156:157], v172 offset:16384
    ds_read_b64_tr_b16 a[158:159], v172 offset:17408
    v_mfma_f32_16x16x32_bf16 v[136:139], a[136:139], v[188:191], v[136:139]
    v_rcp_f32 v238, v238
    v_mfma_f32_16x16x32_bf16 v[144:147], a[136:139], a[224:227], v[144:147]
    ds_read_b128 a[224:227], v214 offset:0
    v_mul_f32 v76, v238, v76
    v_mul_f32 v77, v238, v77
    v_mul_f32 v78, v238, v78
    v_mfma_f32_16x16x32_bf16 v[144:147], a[140:143], a[228:231], v[144:147]
    s_waitcnt lgkmcnt(7)
    ds_read_b128 a[228:231], v215 offset:0
    v_mul_f32 v79, v238, v79
    v_mul_f32 v80, v238, v80
    v_mul_f32 v81, v238, v81
    v_mfma_f32_16x16x32_bf16 v[4:7], a[144:147], a[32:35], 0
    s_waitcnt lgkmcnt(6)
    ds_read_b128 a[232:235], v216 offset:0
    v_mul_f32 v82, v238, v82
    v_mul_f32 v83, v238, v83
    v_cvt_pk_bf16_f32 v76, v76, v77
    v_mfma_f32_16x16x32_bf16 v[4:7], a[148:151], a[36:39], v[4:7]
    s_waitcnt lgkmcnt(5)
    ds_read_b128 a[236:239], v217 offset:0
    v_cvt_pk_bf16_f32 v77, v78, v79
    v_cvt_pk_bf16_f32 v78, v80, v81
    v_cvt_pk_bf16_f32 v79, v82, v83
    v_mfma_f32_16x16x32_bf16 v[4:7], a[152:155], a[40:43], v[4:7]
    s_waitcnt lgkmcnt(4)
    ds_read_b64_tr_b16 a[160:161], v149 offset:16384
    v_mul_f32 v84, v238, v84
    v_mfma_f32_16x16x32_bf16 v[4:7], a[156:159], a[44:47], v[4:7]
    v_rcp_f32 v239, v239
    v_mfma_f32_16x16x32_bf16 v[36:39], a[156:159], a[60:63], 0
    ds_read_b64_tr_b16 a[162:163], v149 offset:17408
    v_mul_f32 v108, v239, v108
    v_mul_f32 v109, v239, v109
    v_mul_f32 v110, v239, v110
    v_mfma_f32_16x16x32_bf16 v[36:39], a[152:155], a[56:59], v[36:39]
    ds_read_b64_tr_b16 a[164:165], v157 offset:16384
    ds_read_b64_tr_b16 a[166:167], v157 offset:17408
    v_mul_f32 v111, v239, v111
    v_mul_f32 v112, v239, v112
    v_mfma_f32_16x16x32_bf16 v[36:39], a[148:151], a[52:55], v[36:39]
    ds_read_b64_tr_b16 a[168:169], v165 offset:16384
    v_mul_f32 v113, v239, v113
    v_mul_f32 v114, v239, v114
    v_mul_f32 v115, v239, v115
    v_mfma_f32_16x16x32_bf16 v[36:39], a[144:147], a[48:51], v[36:39]
    s_waitcnt lgkmcnt(8)
    ds_read_b64_tr_b16 a[170:171], v165 offset:17408
    v_cvt_pk_bf16_f32 v108, v108, v109
    v_cvt_pk_bf16_f32 v109, v110, v111
    v_cvt_pk_bf16_f32 v110, v112, v113
    v_mfma_f32_16x16x32_bf16 v[68:71], a[144:147], a[224:227], 0
    s_waitcnt lgkmcnt(8)
    ds_read_b64_tr_b16 a[172:173], v173 offset:16384
    ds_read_b64_tr_b16 a[174:175], v173 offset:17408
    v_cvt_pk_bf16_f32 v111, v114, v115
    v_mfma_f32_16x16x32_bf16 v[68:71], a[148:151], a[228:231], v[68:71]
    s_waitcnt lgkmcnt(9)
    v_mul_f32 v85, v238, v85
    v_mul_f32 v86, v238, v86
    v_mul_f32 v87, v238, v87
    v_mfma_f32_16x16x32_bf16 v[68:71], a[152:155], a[232:235], v[68:71]
    s_waitcnt lgkmcnt(8)
    ds_read_b64_tr_b16 a[128:129], v150 offset:16384
    v_mul_f32 v88, v238, v88
    v_mul_f32 v89, v238, v89
    v_mfma_f32_16x16x32_bf16 v[68:71], a[156:159], a[236:239], v[68:71]
    s_waitcnt lgkmcnt(7)
    ds_read_b64_tr_b16 a[130:131], v150 offset:17408
    v_mul_f32 v90, v238, v90
    v_mul_f32 v91, v238, v91
    v_mfma_f32_16x16x32_bf16 v[8:11], a[160:163], a[32:35], 0
    s_waitcnt lgkmcnt(6)
    ds_read_b64_tr_b16 a[132:133], v158 offset:16384
    v_cvt_pk_bf16_f32 v84, v84, v85
    v_cvt_pk_bf16_f32 v85, v86, v87
    v_mfma_f32_16x16x32_bf16 v[8:11], a[164:167], a[36:39], v[8:11]
    s_waitcnt lgkmcnt(5)
    ds_read_b64_tr_b16 a[134:135], v158 offset:17408
    v_cvt_pk_bf16_f32 v86, v88, v89
    v_cvt_pk_bf16_f32 v87, v90, v91
    v_mfma_f32_16x16x32_bf16 v[8:11], a[168:171], a[40:43], v[8:11]
    s_waitcnt lgkmcnt(4)
    ds_read_b64_tr_b16 a[136:137], v166 offset:16384
    v_mul_f32 v116, v239, v116
    v_mul_f32 v117, v239, v117
    v_mfma_f32_16x16x32_bf16 v[8:11], a[172:175], a[44:47], v[8:11]
    ds_read_b64_tr_b16 a[138:139], v166 offset:17408
    v_mul_f32 v118, v239, v118
    v_mul_f32 v119, v239, v119
    v_mfma_f32_16x16x32_bf16 v[40:43], a[172:175], a[60:63], 0
    buffer_load_dwordx4 v246, s[24:27], s43 offen offset:0  lds
    v_mul_f32 v120, v239, v120
    v_mfma_f32_16x16x32_bf16 v[40:43], a[168:171], a[56:59], v[40:43]
    s_add_u32 s43, s61, 15360
    ds_read_b64_tr_b16 a[140:141], v174 offset:16384
    v_mul_f32 v121, v239, v121
    v_mul_f32 v122, v239, v122
    v_mfma_f32_16x16x32_bf16 v[40:43], a[164:167], a[52:55], v[40:43]
    ds_read_b64_tr_b16 a[142:143], v174 offset:17408
    v_mul_f32 v123, v239, v123
    v_cvt_pk_bf16_f32 v116, v116, v117
    v_mfma_f32_16x16x32_bf16 v[40:43], a[160:163], a[48:51], v[40:43]
    ds_read_b64_tr_b16 a[144:145], v151 offset:16384
    v_cvt_pk_bf16_f32 v117, v118, v119
    v_cvt_pk_bf16_f32 v118, v120, v121
    v_mfma_f32_16x16x32_bf16 v[72:75], a[160:163], a[224:227], 0
    buffer_load_dwordx4 v246, s[24:27], s43 offen offset:1024  lds
    v_cvt_pk_bf16_f32 v119, v122, v123
    v_mfma_f32_16x16x32_bf16 v[72:75], a[164:167], a[228:231], v[72:75]
    s_add_u32 s43, s61, 30720
    ds_read_b64_tr_b16 a[146:147], v151 offset:17408
    v_mul_f32 v92, v238, v92
    v_mul_f32 v93, v238, v93
    v_mfma_f32_16x16x32_bf16 v[72:75], a[168:171], a[232:235], v[72:75]
    ds_read_b64_tr_b16 a[148:149], v159 offset:16384
    v_mul_f32 v94, v238, v94
    v_mul_f32 v95, v238, v95
    v_mfma_f32_16x16x32_bf16 v[72:75], a[172:175], a[236:239], v[72:75]
    s_waitcnt lgkmcnt(9)
    ds_read_b64_tr_b16 a[150:151], v159 offset:17408
    v_mul_f32 v96, v238, v96
    v_mul_f32 v97, v238, v97
    v_mfma_f32_16x16x32_bf16 v[12:15], a[128:131], a[32:35], 0
    s_waitcnt lgkmcnt(8)
    buffer_load_dwordx4 v246, s[24:27], s43 offen offset:2048  lds
    v_mul_f32 v98, v238, v98
    v_mfma_f32_16x16x32_bf16 v[12:15], a[132:135], a[36:39], v[12:15]
    s_waitcnt lgkmcnt(6)
    v_mul_f32 v99, v238, v99
    v_cvt_pk_bf16_f32 v92, v92, v93
    v_cvt_pk_bf16_f32 v93, v94, v95
    v_mfma_f32_16x16x32_bf16 v[12:15], a[136:139], a[40:43], v[12:15]
    s_waitcnt lgkmcnt(4)
    v_cvt_pk_bf16_f32 v94, v96, v97
    v_cvt_pk_bf16_f32 v95, v98, v99
    v_mfma_f32_16x16x32_bf16 v[12:15], a[140:143], a[44:47], v[12:15]
    s_add_u32 s43, s61, 46080
    v_xor_b32 v167, s5, v233
    v_mul_f32 v124, v239, v124
    v_mfma_f32_16x16x32_bf16 v[44:47], a[140:143], a[60:63], 0
    buffer_load_dwordx4 v246, s[24:27], s43 offen offset:3072  lds
    ds_read_b64_tr_b16 a[152:153], v167 offset:16384
    v_mul_f32 v125, v239, v125
    v_mfma_f32_16x16x32_bf16 v[44:47], a[136:139], a[56:59], v[44:47]
    s_add_u32 m0, s39, 114688
    ds_read_b64_tr_b16 a[154:155], v167 offset:17408
    v_xor_b32 v175, s6, v233
    v_mul_f32 v126, v239, v126
    v_mfma_f32_16x16x32_bf16 v[44:47], a[132:135], a[52:55], v[44:47]
    s_add_u32 s43, s61, 65536
    ds_read_b64_tr_b16 a[156:157], v175 offset:16384
    ds_read_b64_tr_b16 a[158:159], v175 offset:17408
    v_mul_f32 v127, v239, v127
    v_mfma_f32_16x16x32_bf16 v[44:47], a[128:131], a[48:51], v[44:47]
    s_waitcnt lgkmcnt(6)
    v_mul_f32 v128, v239, v128
    v_mul_f32 v129, v239, v129
    v_mul_f32 v130, v239, v130
    v_mfma_f32_16x16x32_bf16 v[16:19], a[144:147], a[32:35], 0
    s_waitcnt lgkmcnt(4)
    buffer_load_dwordx4 v246, s[24:27], s43 offen offset:0  lds
    v_mul_f32 v131, v239, v131
    v_mfma_f32_16x16x32_bf16 v[16:19], a[148:151], a[36:39], v[16:19]
    s_waitcnt lgkmcnt(2)
    v_xor_b32 v152, s3, v234
    v_cvt_pk_bf16_f32 v124, v124, v125
    v_cvt_pk_bf16_f32 v125, v126, v127
    v_mfma_f32_16x16x32_bf16 v[16:19], a[152:155], a[40:43], v[16:19]
    s_waitcnt lgkmcnt(0)
    ds_read_b64_tr_b16 a[160:161], v152 offset:16384
    ds_read_b64_tr_b16 a[162:163], v152 offset:17408
    v_cvt_pk_bf16_f32 v126, v128, v129
    v_mfma_f32_16x16x32_bf16 v[16:19], a[156:159], a[44:47], v[16:19]
    s_add_u32 s43, s61, 80896
    v_xor_b32 v160, s4, v234
    v_xor_b32 v168, s5, v234
    v_cvt_pk_bf16_f32 v127, v130, v131
    v_mfma_f32_16x16x32_bf16 v[48:51], a[156:159], a[60:63], 0
    buffer_load_dwordx4 v246, s[24:27], s43 offen offset:1024  lds
    ds_read_b64_tr_b16 a[164:165], v160 offset:16384
    ds_read_b64_tr_b16 a[166:167], v160 offset:17408
    v_mfma_f32_16x16x32_bf16 v[48:51], a[152:155], a[56:59], v[48:51]
    s_add_u32 s43, s61, 96256
    ds_read_b64_tr_b16 a[168:169], v168 offset:16384
    ds_read_b64_tr_b16 a[170:171], v168 offset:17408
    v_xor_b32 v176, s6, v234
    v_mfma_f32_16x16x32_bf16 v[48:51], a[148:151], a[52:55], v[48:51]
    ds_read_b64_tr_b16 a[172:173], v176 offset:16384
    ds_read_b64_tr_b16 a[174:175], v176 offset:17408
    v_mfma_f32_16x16x32_bf16 v[48:51], a[144:147], a[48:51], v[48:51]
    s_waitcnt lgkmcnt(6)
    v_rcp_f32 v240, v240
    v_mfma_f32_16x16x32_bf16 v[20:23], a[160:163], a[32:35], 0
    s_waitcnt lgkmcnt(4)
    buffer_load_dwordx4 v246, s[24:27], s43 offen offset:2048  lds
    v_mul_f32 v140, v240, v140
    v_mul_f32 v141, v240, v141
    v_mfma_f32_16x16x32_bf16 v[20:23], a[164:167], a[36:39], v[20:23]
    s_waitcnt lgkmcnt(2)
    v_xor_b32 v153, s3, v235
    v_mul_f32 v142, v240, v142
    v_mul_f32 v143, v240, v143
    v_mul_f32 v144, v240, v144
    v_mfma_f32_16x16x32_bf16 v[20:23], a[168:171], a[40:43], v[20:23]
    s_waitcnt lgkmcnt(0)
    ds_read_b64_tr_b16 a[128:129], v153 offset:16384
    ds_read_b64_tr_b16 a[130:131], v153 offset:17408
    v_mul_f32 v145, v240, v145
    v_mul_f32 v146, v240, v146
    v_mfma_f32_16x16x32_bf16 v[20:23], a[172:175], a[44:47], v[20:23]
    s_add_u32 s43, s61, 111616
    v_xor_b32 v161, s4, v235
    v_xor_b32 v169, s5, v235
    v_mul_f32 v147, v240, v147
    v_cvt_pk_bf16_f32 v140, v140, v141
    v_mfma_f32_16x16x32_bf16 v[52:55], a[172:175], a[60:63], 0
    buffer_load_dwordx4 v246, s[24:27], s43 offen offset:3072  lds
    ds_read_b64_tr_b16 a[132:133], v161 offset:16384
    ds_read_b64_tr_b16 a[134:135], v161 offset:17408
    v_cvt_pk_bf16_f32 v141, v142, v143
    v_cvt_pk_bf16_f32 v142, v144, v145
    v_mfma_f32_16x16x32_bf16 v[52:55], a[168:171], a[56:59], v[52:55]
    s_add_u32 m0, s39, 32768
    ds_read_b64_tr_b16 a[136:137], v169 offset:16384
    ds_read_b64_tr_b16 a[138:139], v169 offset:17408
    v_xor_b32 v177, s6, v235
    v_cvt_pk_bf16_f32 v143, v146, v147
    v_mul_f32 v100, v238, v100
    v_mfma_f32_16x16x32_bf16 v[52:55], a[164:167], a[52:55], v[52:55]
    s_add_u32 s43, s62, 0
    ds_read_b64_tr_b16 a[140:141], v177 offset:16384
    ds_read_b64_tr_b16 a[142:143], v177 offset:17408
    v_mul_f32 v101, v238, v101
    v_mul_f32 v102, v238, v102
    v_mfma_f32_16x16x32_bf16 v[52:55], a[160:163], a[48:51], v[52:55]
    s_waitcnt lgkmcnt(6)
    buffer_load_dwordx4 v246, s[24:27], s43 offen offset:0  lds
    v_mul_f32 v103, v238, v103
    v_mul_f32 v104, v238, v104
    v_mfma_f32_16x16x32_bf16 v[24:27], a[128:131], a[32:35], 0
    s_waitcnt lgkmcnt(4)
    v_add_u32 v144, s83, v242
    v_mul_f32 v105, v238, v105
    v_mul_f32 v106, v238, v106
    v_mul_f32 v107, v238, v107
    v_mfma_f32_16x16x32_bf16 v[24:27], a[132:135], a[36:39], v[24:27]
    s_waitcnt lgkmcnt(2)
    ds_write_b128 v144, v[140:143] offset:4096
    v_xor_b32 v154, s3, v236
    v_cvt_pk_bf16_f32 v100, v100, v101
    v_cvt_pk_bf16_f32 v101, v102, v103
    v_mfma_f32_16x16x32_bf16 v[24:27], a[136:139], a[40:43], v[24:27]
    s_waitcnt lgkmcnt(1)
    s_add_u32 s43, s62, 15360
    ds_read_b64_tr_b16 a[144:145], v154 offset:16384
    ds_read_b64_tr_b16 a[146:147], v154 offset:17408
    v_cvt_pk_bf16_f32 v102, v104, v105
    v_cvt_pk_bf16_f32 v103, v106, v107
    v_mfma_f32_16x16x32_bf16 v[24:27], a[140:143], a[44:47], v[24:27]
    buffer_load_dwordx4 v246, s[24:27], s43 offen offset:1024  lds
    v_xor_b32 v162, s4, v236
    v_mul_f32 v132, v239, v132
    v_mul_f32 v133, v239, v133
    v_mfma_f32_16x16x32_bf16 v[56:59], a[140:143], a[60:63], 0
    s_add_u32 s43, s62, 30720
    ds_read_b64_tr_b16 a[148:149], v162 offset:16384
    ds_read_b64_tr_b16 a[150:151], v162 offset:17408
    v_xor_b32 v170, s5, v236
    v_mul_f32 v134, v239, v134
    v_mul_f32 v135, v239, v135
    v_mfma_f32_16x16x32_bf16 v[56:59], a[136:139], a[56:59], v[56:59]
    buffer_load_dwordx4 v246, s[24:27], s43 offen offset:2048  lds
    ds_read_b64_tr_b16 a[152:153], v170 offset:16384
    ds_read_b64_tr_b16 a[154:155], v170 offset:17408
    v_mul_f32 v136, v239, v136
    v_mul_f32 v137, v239, v137
    v_mfma_f32_16x16x32_bf16 v[56:59], a[132:135], a[52:55], v[56:59]
    s_add_u32 s43, s62, 46080
    v_xor_b32 v178, s6, v236
    v_mul_f32 v138, v239, v138
    v_mul_f32 v139, v239, v139
    v_mfma_f32_16x16x32_bf16 v[56:59], a[128:131], a[48:51], v[56:59]
    s_waitcnt lgkmcnt(4)
    buffer_load_dwordx4 v246, s[24:27], s43 offen offset:3072  lds
    ds_read_b64_tr_b16 a[156:157], v178 offset:16384
    ds_read_b64_tr_b16 a[158:159], v178 offset:17408
    v_cvt_pk_bf16_f32 v132, v132, v133
    v_cvt_pk_bf16_f32 v133, v134, v135
    v_mfma_f32_16x16x32_bf16 v[28:31], a[144:147], a[32:35], 0
    s_waitcnt lgkmcnt(4)
    v_cvt_pk_bf16_f32 v134, v136, v137
    v_cvt_pk_bf16_f32 v135, v138, v139
    v_mfma_f32_16x16x32_bf16 v[28:31], a[148:151], a[36:39], v[28:31]
    s_waitcnt lgkmcnt(2)
    v_xor_b32 v155, s3, v237
    v_xor_b32 v163, s4, v237
    v_mfma_f32_16x16x32_bf16 v[28:31], a[152:155], a[40:43], v[28:31]
    s_waitcnt lgkmcnt(0)
    s_add_u32 m0, s39, 98304
    s_add_u32 s43, s62, 65536
    ds_read_b64_tr_b16 a[160:161], v155 offset:16384
    ds_read_b64_tr_b16 a[162:163], v155 offset:17408
    v_mfma_f32_16x16x32_bf16 v[28:31], a[156:159], a[44:47], v[28:31]
    buffer_load_dwordx4 v246, s[24:27], s43 offen offset:0  lds
    ds_read_b64_tr_b16 a[164:165], v163 offset:16384
    ds_read_b64_tr_b16 a[166:167], v163 offset:17408
    v_mfma_f32_16x16x32_bf16 v[60:63], a[156:159], a[60:63], 0
    s_add_u32 s43, s62, 80896
    v_xor_b32 v171, s5, v237
    v_xor_b32 v179, s6, v237
    v_mfma_f32_16x16x32_bf16 v[60:63], a[152:155], a[56:59], v[60:63]
    buffer_load_dwordx4 v246, s[24:27], s43 offen offset:1024  lds
    ds_read_b64_tr_b16 a[168:169], v171 offset:16384
    ds_read_b64_tr_b16 a[170:171], v171 offset:17408
    v_mfma_f32_16x16x32_bf16 v[60:63], a[148:151], a[52:55], v[60:63]
    s_add_u32 s43, s62, 96256
    ds_read_b64_tr_b16 a[172:173], v179 offset:16384
    ds_read_b64_tr_b16 a[174:175], v179 offset:17408
    v_mfma_f32_16x16x32_bf16 v[60:63], a[144:147], a[48:51], v[60:63]
    s_waitcnt vmcnt(21) lgkmcnt(0)
    s_barrier
    v_mfma_f32_16x16x32_bf16 v[32:35], a[160:163], a[32:35], 0
    buffer_load_dwordx4 v246, s[24:27], s43 offen offset:2048  lds
    ds_read_b64_tr_b16 a[128:129], v148 offset:0
    v_mfma_f32_16x16x32_bf16 v[32:35], a[164:167], a[36:39], v[32:35]
    ds_read_b64_tr_b16 a[130:131], v148 offset:1024
    ds_read_b64_tr_b16 a[132:133], v156 offset:0
    v_mfma_f32_16x16x32_bf16 v[32:35], a[168:171], a[40:43], v[32:35]
    ds_read_b64_tr_b16 a[134:135], v156 offset:1024
    ds_read_b64_tr_b16 a[136:137], v164 offset:0
    ds_read_b128 v[248:251], v242 offset:28672
    v_mfma_f32_16x16x32_bf16 v[32:35], a[172:175], a[44:47], v[32:35]
    s_add_u32 s43, s62, 111616
    ds_read_b64_tr_b16 a[138:139], v164 offset:1024
    ds_read_b64_tr_b16 a[140:141], v172 offset:0
    s_waitcnt vmcnt(15)
    v_cmp_ne_u32 vcc, 1, v254
    s_cbranch_vccnz L_spin_o0
L_ret_o0:
    v_mfma_f32_16x16x32_bf16 v[64:67], a[172:175], a[60:63], 0
    s_add_u32 s97, s65, 0
    buffer_load_dwordx4 v246, s[24:27], s43 offen offset:3072  lds
    v_mfma_f32_16x16x32_bf16 v[64:67], a[168:171], a[56:59], v[64:67]
    s_add_u32 m0, s83, 139264
    ds_read_b64_tr_b16 a[142:143], v172 offset:1024
    v_mfma_f32_16x16x32_bf16 v[64:67], a[164:167], a[52:55], v[64:67]
    s_add_u32 s43, s65, 0
    ds_read_b128 a[224:227], v214 offset:4096
    v_mfma_f32_16x16x32_bf16 v[64:67], a[160:163], a[48:51], v[64:67]
    s_waitcnt lgkmcnt(8)
    buffer_load_dwordx4 v252, s[28:31], s43 offen offset:0 sc1 lds
    v_mfma_f32_16x16x32_bf16 v[4:7], a[128:131], v[76:79], v[4:7]
    s_waitcnt lgkmcnt(6)
    ds_read_b128 a[228:231], v215 offset:4096
    v_mfma_f32_16x16x32_bf16 v[4:7], a[132:135], v[84:87], v[4:7]
    s_waitcnt lgkmcnt(4)
    buffer_load_dwordx4 a[80:83], v247, s[28:31], s97 offen offset:0 sc1
    v_mfma_f32_16x16x32_bf16 v[4:7], a[136:139], v[92:95], v[4:7]
    s_waitcnt lgkmcnt(2)
    ds_read_b128 a[232:235], v216 offset:4096
    v_max3_u32 v248, v248, v249, v250
    v_max_u32 v248, v248, v251
    v_mfma_f32_16x16x32_bf16 v[4:7], a[140:143], v[100:103], v[4:7]
    s_add_u32 m0, s83, 143360
    buffer_load_dwordx4 a[84:87], v247, s[28:31], s97 offen offset:1024 sc1
    ds_read_b128 a[236:239], v217 offset:4096
    v_mfma_f32_16x16x32_bf16 v[36:39], a[140:143], v[132:135], v[36:39]
    s_add_u32 s43, s66, 0
    ds_read_b64_tr_b16 a[144:145], v149 offset:0
    ds_read_b64_tr_b16 a[146:147], v149 offset:1024
    v_cmp_lt_u32 vcc, s77, v248
    s_cbranch_vccnz L_fail1
    v_mfma_f32_16x16x32_bf16 v[36:39], a[136:139], v[124:127], v[36:39]
    ds_read_b64_tr_b16 a[148:149], v157 offset:0
    ds_read_b64_tr_b16 a[150:151], v157 offset:1024
    v_mfma_f32_16x16x32_bf16 v[36:39], a[132:135], v[116:119], v[36:39]
    buffer_load_dwordx4 a[88:91], v247, s[28:31], s97 offen offset:2048 sc1
    v_mfma_f32_16x16x32_bf16 v[36:39], a[128:131], v[108:111], v[36:39]
    s_waitcnt lgkmcnt(7)
    ds_read_b64_tr_b16 a[152:153], v165 offset:0
    ds_read_b64_tr_b16 a[154:155], v165 offset:1024
    v_mfma_f32_16x16x32_bf16 v[68:71], a[128:131], a[224:227], v[68:71]
    s_waitcnt lgkmcnt(8)
    ds_read_b64_tr_b16 a[156:157], v173 offset:0
    ds_read_b64_tr_b16 a[158:159], v173 offset:1024
    v_mfma_f32_16x16x32_bf16 v[68:71], a[132:135], a[228:231], v[68:71]
    s_waitcnt lgkmcnt(9)
    buffer_load_dwordx4 a[92:95], v247, s[28:31], s97 offen offset:3072 sc1
    v_mfma_f32_16x16x32_bf16 v[68:71], a[136:139], a[232:235], v[68:71]
    s_waitcnt lgkmcnt(8)
    ds_read_b64_tr_b16 a[160:161], v150 offset:0
    v_mfma_f32_16x16x32_bf16 v[68:71], a[140:143], a[236:239], v[68:71]
    s_waitcnt lgkmcnt(7)
    ds_read_b64_tr_b16 a[162:163], v150 offset:1024
    v_mfma_f32_16x16x32_bf16 v[8:11], a[144:147], v[76:79], v[8:11]
    s_waitcnt lgkmcnt(6)
    s_add_u32 s97, s65, 4096
    ds_read_b64_tr_b16 a[164:165], v158 offset:0
    v_mfma_f32_16x16x32_bf16 v[8:11], a[148:151], v[84:87], v[8:11]
    s_waitcnt lgkmcnt(5)
    buffer_load_dwordx4 a[96:99], v247, s[28:31], s97 offen offset:0 sc1
    v_mfma_f32_16x16x32_bf16 v[8:11], a[152:155], v[92:95], v[8:11]
    s_waitcnt lgkmcnt(3)
    ds_read_b64_tr_b16 a[166:167], v158 offset:1024
    v_mfma_f32_16x16x32_bf16 v[8:11], a[156:159], v[100:103], v[8:11]
    buffer_load_dwordx4 a[100:103], v247, s[28:31], s97 offen offset:1024 sc1
    v_mfma_f32_16x16x32_bf16 v[40:43], a[156:159], v[132:135], v[40:43]
    ds_read_b64_tr_b16 a[168:169], v166 offset:0
    v_mfma_f32_16x16x32_bf16 v[40:43], a[152:155], v[124:127], v[40:43]
    ds_read_b64_tr_b16 a[170:171], v166 offset:1024
    v_mfma_f32_16x16x32_bf16 v[40:43], a[148:151], v[116:119], v[40:43]
    buffer_load_dwordx4 a[104:107], v247, s[28:31], s97 offen offset:2048 sc1
    v_mfma_f32_16x16x32_bf16 v[40:43], a[144:147], v[108:111], v[40:43]
    ds_read_b64_tr_b16 a[172:173], v174 offset:0
    ds_read_b64_tr_b16 a[174:175], v174 offset:1024
    v_mfma_f32_16x16x32_bf16 v[72:75], a[144:147], a[224:227], v[72:75]
    s_add_u32 s44, s48, 36864
    ds_read_b64_tr_b16 a[128:129], v151 offset:0
    v_mfma_f32_16x16x32_bf16 v[72:75], a[148:151], a[228:231], v[72:75]
    buffer_load_dwordx4 a[108:111], v247, s[28:31], s97 offen offset:3072 sc1
    v_mfma_f32_16x16x32_bf16 v[72:75], a[152:155], a[232:235], v[72:75]
    ds_read_b64_tr_b16 a[130:131], v151 offset:1024
    v_mfma_f32_16x16x32_bf16 v[72:75], a[156:159], a[236:239], v[72:75]
    s_waitcnt lgkmcnt(8)
    ds_read_b64_tr_b16 a[132:133], v159 offset:0
    ds_read_b64_tr_b16 a[134:135], v159 offset:1024
    v_mfma_f32_16x16x32_bf16 v[12:15], a[160:163], v[76:79], v[12:15]
    s_waitcnt lgkmcnt(8)
    ds_read_b64_tr_b16 a[136:137], v167 offset:0
    v_mfma_f32_16x16x32_bf16 v[12:15], a[164:167], v[84:87], v[12:15]
    s_waitcnt lgkmcnt(7)
    ds_read_b64_tr_b16 a[138:139], v167 offset:1024
    v_mfma_f32_16x16x32_bf16 v[12:15], a[168:171], v[92:95], v[12:15]
    s_waitcnt lgkmcnt(6)
    buffer_store_dwordx4 v[76:79], v247, s[28:31], s44 offen offset:0 sc1
    v_mfma_f32_16x16x32_bf16 v[12:15], a[172:175], v[100:103], v[12:15]
    s_nop 0
    s_add_u32 s44, s48, 40960
    ds_read_b64_tr_b16 a[140:141], v175 offset:0
    ds_read_b64_tr_b16 a[142:143], v175 offset:1024
    v_mfma_f32_16x16x32_bf16 v[44:47], a[172:175], v[132:135], v[44:47]
    ds_read_b64_tr_b16 a[144:145], v152 offset:0
    v_mfma_f32_16x16x32_bf16 v[44:47], a[168:171], v[124:127], v[44:47]
    buffer_store_dwordx4 v[108:111], v247, s[28:31], s44 offen offset:0 sc1
    v_mfma_f32_16x16x32_bf16 v[44:47], a[164:167], v[116:119], v[44:47]
    s_nop 0
    s_add_u32 s44, s49, 36864
    ds_read_b64_tr_b16 a[146:147], v152 offset:1024
    v_mfma_f32_16x16x32_bf16 v[44:47], a[160:163], v[108:111], v[44:47]
    s_waitcnt lgkmcnt(8)
    ds_read_b64_tr_b16 a[148:149], v160 offset:0
    ds_read_b64_tr_b16 a[150:151], v160 offset:1024
    v_mfma_f32_16x16x32_bf16 v[16:19], a[128:131], v[76:79], v[16:19]
    s_waitcnt lgkmcnt(8)
    buffer_store_dwordx4 v[84:87], v247, s[28:31], s44 offen offset:0 sc1
    v_mfma_f32_16x16x32_bf16 v[16:19], a[132:135], v[84:87], v[16:19]
    s_waitcnt lgkmcnt(6)
    ds_read_b64_tr_b16 a[152:153], v168 offset:0
    ds_read_b64_tr_b16 a[154:155], v168 offset:1024
    v_mfma_f32_16x16x32_bf16 v[16:19], a[136:139], v[92:95], v[16:19]
    s_waitcnt lgkmcnt(6)
    ds_read_b64_tr_b16 a[156:157], v176 offset:0
    ds_read_b64_tr_b16 a[158:159], v176 offset:1024
    v_mfma_f32_16x16x32_bf16 v[16:19], a[140:143], v[100:103], v[16:19]
    s_add_u32 s44, s49, 40960
    buffer_store_dwordx4 v[116:119], v247, s[28:31], s44 offen offset:0 sc1
    v_mfma_f32_16x16x32_bf16 v[48:51], a[140:143], v[132:135], v[48:51]
    s_nop 0
    s_add_u32 s44, s50, 36864
    ds_read_b64_tr_b16 a[160:161], v153 offset:0
    v_mfma_f32_16x16x32_bf16 v[48:51], a[136:139], v[124:127], v[48:51]
    ds_read_b64_tr_b16 a[162:163], v153 offset:1024
    v_mfma_f32_16x16x32_bf16 v[48:51], a[132:135], v[116:119], v[48:51]
    buffer_store_dwordx4 v[92:95], v247, s[28:31], s44 offen offset:0 sc1
    v_mfma_f32_16x16x32_bf16 v[48:51], a[128:131], v[108:111], v[48:51]
    s_waitcnt lgkmcnt(8)
    ds_read_b64_tr_b16 a[164:165], v161 offset:0
    ds_read_b64_tr_b16 a[166:167], v161 offset:1024
    v_mfma_f32_16x16x32_bf16 v[20:23], a[144:147], v[76:79], v[20:23]
    s_waitcnt lgkmcnt(8)
    ds_read_b64_tr_b16 a[168:169], v169 offset:0
    v_mfma_f32_16x16x32_bf16 v[20:23], a[148:151], v[84:87], v[20:23]
    s_waitcnt lgkmcnt(7)
    s_add_u32 s44, s50, 40960
    ds_read_b64_tr_b16 a[170:171], v169 offset:1024
    v_mfma_f32_16x16x32_bf16 v[20:23], a[152:155], v[92:95], v[20:23]
    s_waitcnt lgkmcnt(6)
    buffer_store_dwordx4 v[124:127], v247, s[28:31], s44 offen offset:0 sc1
    v_mfma_f32_16x16x32_bf16 v[20:23], a[156:159], v[100:103], v[20:23]
    s_nop 0
    s_add_u32 s44, s64, 36864
    ds_read_b64_tr_b16 a[172:173], v177 offset:0
    ds_read_b64_tr_b16 a[174:175], v177 offset:1024
    v_mfma_f32_16x16x32_bf16 v[52:55], a[156:159], v[132:135], v[52:55]
    buffer_store_dwordx4 v[140:143], v252, s[28:31], s44 offen offset:0 sc1
    v_mfma_f32_16x16x32_bf16 v[52:55], a[152:155], v[124:127], v[52:55]
    s_nop 0
    s_add_u32 s44, s51, 36864
    ds_read_b64_tr_b16 a[128:129], v154 offset:0
    v_mfma_f32_16x16x32_bf16 v[52:55], a[148:151], v[116:119], v[52:55]
    ds_read_b64_tr_b16 a[130:131], v154 offset:1024
    v_mfma_f32_16x16x32_bf16 v[52:55], a[144:147], v[108:111], v[52:55]
    s_waitcnt lgkmcnt(8)
    buffer_store_dwordx4 v[100:103], v247, s[28:31], s44 offen offset:0 sc1
    v_mfma_f32_16x16x32_bf16 v[24:27], a[160:163], v[76:79], v[24:27]
    s_waitcnt lgkmcnt(6)
    ds_read_b64_tr_b16 a[132:133], v162 offset:0
    ds_read_b64_tr_b16 a[134:135], v162 offset:1024
    v_mfma_f32_16x16x32_bf16 v[24:27], a[164:167], v[84:87], v[24:27]
    s_waitcnt lgkmcnt(6)
    ds_read_b64_tr_b16 a[136:137], v170 offset:0
    ds_read_b64_tr_b16 a[138:139], v170 offset:1024
    v_mfma_f32_16x16x32_bf16 v[24:27], a[168:171], v[92:95], v[24:27]
    s_waitcnt lgkmcnt(6)
    s_add_u32 s44, s51, 40960
    ds_read_b64_tr_b16 a[140:141], v178 offset:0
    v_mfma_f32_16x16x32_bf16 v[24:27], a[172:175], v[100:103], v[24:27]
    buffer_store_dwordx4 v[132:135], v247, s[28:31], s44 offen offset:0 sc1
    v_mfma_f32_16x16x32_bf16 v[56:59], a[172:175], v[132:135], v[56:59]
    ds_read_b64_tr_b16 a[142:143], v178 offset:1024
    ds_read_b64_tr_b16 a[144:145], v155 offset:0
    v_mfma_f32_16x16x32_bf16 v[56:59], a[168:171], v[124:127], v[56:59]
    ds_read_b64_tr_b16 a[146:147], v155 offset:1024
    v_mfma_f32_16x16x32_bf16 v[56:59], a[164:167], v[116:119], v[56:59]
    ds_read_b64_tr_b16 a[148:149], v163 offset:0
    ds_read_b64_tr_b16 a[150:151], v163 offset:1024
    v_mfma_f32_16x16x32_bf16 v[56:59], a[160:163], v[108:111], v[56:59]
    s_waitcnt lgkmcnt(10)
    ds_read_b64_tr_b16 a[152:153], v171 offset:0
    v_mfma_f32_16x16x32_bf16 v[28:31], a[128:131], v[76:79], v[28:31]
    s_waitcnt lgkmcnt(9)
    ds_read_b64_tr_b16 a[154:155], v171 offset:1024
    v_mfma_f32_16x16x32_bf16 v[28:31], a[132:135], v[84:87], v[28:31]
    s_waitcnt lgkmcnt(8)
    ds_read_b64_tr_b16 a[156:157], v179 offset:0
    ds_read_b64_tr_b16 a[158:159], v179 offset:1024
    v_mfma_f32_16x16x32_bf16 v[28:31], a[136:139], v[92:95], v[28:31]
    s_waitcnt lgkmcnt(8)
    v_mfma_f32_16x16x32_bf16 v[28:31], a[140:143], v[100:103], v[28:31]
    v_mfma_f32_16x16x32_bf16 v[60:63], a[140:143], v[132:135], v[60:63]
    v_mfma_f32_16x16x32_bf16 v[60:63], a[136:139], v[124:127], v[60:63]
    v_mfma_f32_16x16x32_bf16 v[60:63], a[132:135], v[116:119], v[60:63]
    v_mfma_f32_16x16x32_bf16 v[60:63], a[128:131], v[108:111], v[60:63]
    s_waitcnt vmcnt(17) lgkmcnt(0)
    s_barrier
    v_mfma_f32_16x16x32_bf16 v[32:35], a[144:147], v[76:79], v[32:35]
    ds_read_b64_tr_b16 a[160:161], v230 offset:49152
    ds_read_b64_tr_b16 a[162:163], v230 offset:50176
    v_mfma_f32_16x16x32_bf16 v[32:35], a[148:151], v[84:87], v[32:35]
    ds_read_b64_tr_b16 a[164:165], v230 offset:51200
    ds_read_b64_tr_b16 a[166:167], v230 offset:52224
    v_mfma_f32_16x16x32_bf16 v[32:35], a[152:155], v[92:95], v[32:35]
    ds_read_b64_tr_b16 a[168:169], v222 offset:49152
    ds_read_b64_tr_b16 a[170:171], v222 offset:50176
    v_mfma_f32_16x16x32_bf16 v[32:35], a[156:159], v[100:103], v[32:35]
    ds_read_b64_tr_b16 a[172:173], v222 offset:51200
    ds_read_b64_tr_b16 a[174:175], v222 offset:52224
    v_mfma_f32_16x16x32_bf16 v[64:67], a[156:159], v[132:135], v[64:67]
    ds_read_b128 a[224:227], v242 offset:8192
    v_mfma_f32_16x16x32_bf16 v[64:67], a[152:155], v[124:127], v[64:67]
    ds_read_b128 a[228:231], v242 offset:9216
    v_mfma_f32_16x16x32_bf16 v[64:67], a[148:151], v[116:119], v[64:67]
    ds_read_b128 a[232:235], v242 offset:10240
    v_mfma_f32_16x16x32_bf16 v[64:67], a[144:147], v[108:111], v[64:67]
    s_waitcnt vmcnt(16) lgkmcnt(9)
    ds_read_b128 a[236:239], v242 offset:11264
    v_mfma_f32_16x16x32_bf16 v[4:7], a[160:163], a[80:83], v[4:7]
    s_waitcnt vmcnt(15) lgkmcnt(8)
    ds_read_b64_tr_b16 a[128:129], v231 offset:49152
    v_mfma_f32_16x16x32_bf16 v[4:7], a[164:167], a[84:87], v[4:7]
    s_waitcnt vmcnt(14) lgkmcnt(7)
    ds_read_b64_tr_b16 a[130:131], v231 offset:50176
    v_mfma_f32_16x16x32_bf16 v[4:7], a[168:171], a[88:91], v[4:7]
    s_waitcnt vmcnt(13) lgkmcnt(6)
    ds_read_b64_tr_b16 a[132:133], v231 offset:51200
    v_mfma_f32_16x16x32_bf16 v[4:7], a[172:175], a[92:95], v[4:7]
    s_waitcnt vmcnt(9)
    ds_read_b64_tr_b16 a[134:135], v231 offset:52224
    v_mfma_f32_16x16x32_bf16 v[36:39], a[172:175], a[108:111], v[36:39]
    s_waitcnt vmcnt(0)
    buffer_store_dword v0, v253, s[28:31], s47 offen offset:4 sc1
    v_mfma_f32_16x16x32_bf16 v[36:39], a[168:171], a[104:107], v[36:39]
    ds_read_b64_tr_b16 a[136:137], v223 offset:49152
    ds_read_b64_tr_b16 a[138:139], v223 offset:50176
    v_mfma_f32_16x16x32_bf16 v[36:39], a[164:167], a[100:103], v[36:39]
    s_add_u32 s97, s66, 0
    ds_read_b64_tr_b16 a[140:141], v223 offset:51200
    v_mfma_f32_16x16x32_bf16 v[36:39], a[160:163], a[96:99], v[36:39]
    s_waitcnt lgkmcnt(10)
    buffer_load_dwordx4 v252, s[28:31], s43 offen offset:0 sc1 lds
    v_mfma_f32_16x16x32_bf16 v[68:71], a[160:163], a[224:227], v[68:71]
L_pad11:
    s_cbranch_execz L_back2
    s_waitcnt lgkmcnt(9)
    ds_read_b64_tr_b16 a[142:143], v223 offset:52224
    v_mfma_f32_16x16x32_bf16 v[68:71], a[164:167], a[228:231], v[68:71]
    s_waitcnt lgkmcnt(9)
    v_mfma_f32_16x16x32_bf16 v[68:71], a[168:171], a[232:235], v[68:71]
    s_waitcnt lgkmcnt(8)
    buffer_load_dwordx4 a[112:115], v247, s[28:31], s97 offen offset:0 sc1
    v_mfma_f32_16x16x32_bf16 v[68:71], a[172:175], a[236:239], v[68:71]
    s_waitcnt lgkmcnt(6)
    ds_read_b64_tr_b16 a[144:145], v232 offset:49152
    v_mfma_f32_16x16x32_bf16 v[8:11], a[128:131], a[80:83], v[8:11]
    s_waitcnt lgkmcnt(5)
    ds_read_b64_tr_b16 a[146:147], v232 offset:50176
    v_mfma_f32_16x16x32_bf16 v[8:11], a[132:135], a[84:87], v[8:11]
    s_waitcnt lgkmcnt(4)
    buffer_load_dwordx4 a[116:119], v247, s[28:31], s97 offen offset:1024 sc1
    v_mfma_f32_16x16x32_bf16 v[8:11], a[136:139], a[88:91], v[8:11]
    s_waitcnt lgkmcnt(2)
    ds_read_b64_tr_b16 a[148:149], v232 offset:51200
    v_mfma_f32_16x16x32_bf16 v[8:11], a[140:143], a[92:95], v[8:11]
    s_add_u32 m0, s83, 131072
    ds_read_b64_tr_b16 a[150:151], v232 offset:52224
    v_mfma_f32_16x16x32_bf16 v[40:43], a[140:143], a[108:111], v[40:43]
    s_add_u32 s43, s67, 0
    buffer_load_dwordx4 a[120:123], v247, s[28:31], s97 offen offset:2048 sc1
    v_mfma_f32_16x16x32_bf16 v[40:43], a[136:139], a[104:107], v[40:43]
    ds_read_b64_tr_b16 a[152:153], v224 offset:49152
    ds_read_b64_tr_b16 a[154:155], v224 offset:50176
    v_mfma_f32_16x16x32_bf16 v[40:43], a[132:135], a[100:103], v[40:43]
    ds_read_b64_tr_b16 a[156:157], v224 offset:51200
    ds_read_b64_tr_b16 a[158:159], v224 offset:52224
    v_mfma_f32_16x16x32_bf16 v[40:43], a[128:131], a[96:99], v[40:43]
    buffer_load_dwordx4 a[124:127], v247, s[28:31], s97 offen offset:3072 sc1
    v_mfma_f32_16x16x32_bf16 v[72:75], a[128:131], a[224:227], v[72:75]
    s_add_u32 s97, s66, 4096
    ds_read_b64_tr_b16 a[160:161], v233 offset:49152
    v_mfma_f32_16x16x32_bf16 v[72:75], a[132:135], a[228:231], v[72:75]
    ds_read_b64_tr_b16 a[162:163], v233 offset:50176
    v_mfma_f32_16x16x32_bf16 v[72:75], a[136:139], a[232:235], v[72:75]
    buffer_load_dwordx4 a[208:211], v247, s[28:31], s97 offen offset:0 sc1
    v_mfma_f32_16x16x32_bf16 v[72:75], a[140:143], a[236:239], v[72:75]
    s_waitcnt lgkmcnt(8)
    ds_read_b64_tr_b16 a[164:165], v233 offset:51200
    ds_read_b64_tr_b16 a[166:167], v233 offset:52224
    v_mfma_f32_16x16x32_bf16 v[12:15], a[144:147], a[80:83], v[12:15]
    s_waitcnt lgkmcnt(8)
    ds_read_b64_tr_b16 a[168:169], v225 offset:49152
    v_mfma_f32_16x16x32_bf16 v[12:15], a[148:151], a[84:87], v[12:15]
    s_waitcnt lgkmcnt(7)
    buffer_load_dwordx4 a[212:215], v247, s[28:31], s97 offen offset:1024 sc1
    v_mfma_f32_16x16x32_bf16 v[12:15], a[152:155], a[88:91], v[12:15]
    s_waitcnt lgkmcnt(5)
    ds_read_b64_tr_b16 a[170:171], v225 offset:50176
    ds_read_b64_tr_b16 a[172:173], v225 offset:51200
    v_mfma_f32_16x16x32_bf16 v[12:15], a[156:159], a[92:95], v[12:15]
    ds_read_b64_tr_b16 a[174:175], v225 offset:52224
    v_mfma_f32_16x16x32_bf16 v[44:47], a[156:159], a[108:111], v[44:47]
    buffer_load_dwordx4 a[216:219], v247, s[28:31], s97 offen offset:2048 sc1
    v_mfma_f32_16x16x32_bf16 v[44:47], a[152:155], a[104:107], v[44:47]
    ds_read_b64_tr_b16 a[128:129], v234 offset:49152
    v_mfma_f32_16x16x32_bf16 v[44:47], a[148:151], a[100:103], v[44:47]
    ds_read_b64_tr_b16 a[130:131], v234 offset:50176
    v_mfma_f32_16x16x32_bf16 v[44:47], a[144:147], a[96:99], v[44:47]
    s_waitcnt lgkmcnt(8)
    buffer_load_dwordx4 a[220:223], v247, s[28:31], s97 offen offset:3072 sc1
    v_mfma_f32_16x16x32_bf16 v[16:19], a[160:163], a[80:83], v[16:19]
    s_waitcnt lgkmcnt(6)
    ds_read_b64_tr_b16 a[132:133], v234 offset:51200
    ds_read_b64_tr_b16 a[134:135], v234 offset:52224
    v_mfma_f32_16x16x32_bf16 v[16:19], a[164:167], a[84:87], v[16:19]
    s_waitcnt lgkmcnt(6)
    buffer_load_dwordx4 v252, s[28:31], s43 offen offset:0 sc1 lds
    v_mfma_f32_16x16x32_bf16 v[16:19], a[168:171], a[88:91], v[16:19]
    s_waitcnt lgkmcnt(4)
    ds_read_b64_tr_b16 a[136:137], v226 offset:49152
    ds_read_b64_tr_b16 a[138:139], v226 offset:50176
    v_mfma_f32_16x16x32_bf16 v[16:19], a[172:175], a[92:95], v[16:19]
    s_add_u32 m0, s39, 16384
    ds_read_b64_tr_b16 a[140:141], v226 offset:51200
    ds_read_b64_tr_b16 a[142:143], v226 offset:52224
    v_mfma_f32_16x16x32_bf16 v[48:51], a[172:175], a[108:111], v[48:51]
    s_add_u32 s43, s63, 0
    ds_read_b64_tr_b16 a[144:145], v235 offset:49152
    v_mfma_f32_16x16x32_bf16 v[48:51], a[168:171], a[104:107], v[48:51]
    buffer_load_dwordx4 v246, s[24:27], s43 offen offset:0  lds
    v_mfma_f32_16x16x32_bf16 v[48:51], a[164:167], a[100:103], v[48:51]
    s_add_u32 s43, s63, 15360
    ds_read_b64_tr_b16 a[146:147], v235 offset:50176
    v_mfma_f32_16x16x32_bf16 v[48:51], a[160:163], a[96:99], v[48:51]
    s_waitcnt lgkmcnt(8)
    buffer_load_dwordx4 v246, s[24:27], s43 offen offset:1024  lds
    v_mfma_f32_16x16x32_bf16 v[20:23], a[128:131], a[80:83], v[20:23]
    s_waitcnt lgkmcnt(6)
    ds_read_b64_tr_b16 a[148:149], v235 offset:51200
    ds_read_b64_tr_b16 a[150:151], v235 offset:52224
    v_mfma_f32_16x16x32_bf16 v[20:23], a[132:135], a[84:87], v[20:23]
    s_waitcnt lgkmcnt(6)
    ds_read_b64_tr_b16 a[152:153], v227 offset:49152
    ds_read_b64_tr_b16 a[154:155], v227 offset:50176
    v_mfma_f32_16x16x32_bf16 v[20:23], a[136:139], a[88:91], v[20:23]
    s_waitcnt lgkmcnt(6)
    s_add_u32 s43, s63, 30720
    ds_read_b64_tr_b16 a[156:157], v227 offset:51200
    v_mfma_f32_16x16x32_bf16 v[20:23], a[140:143], a[92:95], v[20:23]
    buffer_load_dwordx4 v246, s[24:27], s43 offen offset:2048  lds
    v_mfma_f32_16x16x32_bf16 v[52:55], a[140:143], a[108:111], v[52:55]
    s_add_u32 s43, s63, 46080
    ds_read_b64_tr_b16 a[158:159], v227 offset:52224
    v_mfma_f32_16x16x32_bf16 v[52:55], a[136:139], a[104:107], v[52:55]
    buffer_load_dwordx4 v246, s[24:27], s43 offen offset:3072  lds
    v_mfma_f32_16x16x32_bf16 v[52:55], a[132:135], a[100:103], v[52:55]
    s_add_u32 m0, s39, 81920
    ds_read_b64_tr_b16 a[160:161], v236 offset:49152
    ds_read_b64_tr_b16 a[162:163], v236 offset:50176
    v_mfma_f32_16x16x32_bf16 v[52:55], a[128:131], a[96:99], v[52:55]
    s_waitcnt lgkmcnt(8)
    ds_read_b64_tr_b16 a[164:165], v236 offset:51200
    ds_read_b64_tr_b16 a[166:167], v236 offset:52224
    v_mfma_f32_16x16x32_bf16 v[24:27], a[144:147], a[80:83], v[24:27]
    s_waitcnt lgkmcnt(8)
    s_add_u32 s43, s63, 65536
    ds_read_b64_tr_b16 a[168:169], v228 offset:49152
    v_mfma_f32_16x16x32_bf16 v[24:27], a[148:151], a[84:87], v[24:27]
    s_waitcnt lgkmcnt(7)
    buffer_load_dwordx4 v246, s[24:27], s43 offen offset:0  lds
    v_mfma_f32_16x16x32_bf16 v[24:27], a[152:155], a[88:91], v[24:27]
    s_waitcnt lgkmcnt(5)
    ds_read_b64_tr_b16 a[170:171], v228 offset:50176
    ds_read_b64_tr_b16 a[172:173], v228 offset:51200
    v_mfma_f32_16x16x32_bf16 v[24:27], a[156:159], a[92:95], v[24:27]
    s_add_u32 s43, s63, 80896
    ds_read_b64_tr_b16 a[174:175], v228 offset:52224
    v_mfma_f32_16x16x32_bf16 v[56:59], a[156:159], a[108:111], v[56:59]
    buffer_load_dwordx4 v246, s[24:27], s43 offen offset:1024  lds
    v_mfma_f32_16x16x32_bf16 v[56:59], a[152:155], a[104:107], v[56:59]
    s_add_u32 s43, s63, 96256
    ds_read_b64_tr_b16 a[128:129], v237 offset:49152
    ds_read_b64_tr_b16 a[130:131], v237 offset:50176
    v_mfma_f32_16x16x32_bf16 v[56:59], a[148:151], a[100:103], v[56:59]
    buffer_load_dwordx4 v246, s[24:27], s43 offen offset:2048  lds
    v_mfma_f32_16x16x32_bf16 v[56:59], a[144:147], a[96:99], v[56:59]
    s_waitcnt lgkmcnt(8)
    ds_read_b64_tr_b16 a[132:133], v237 offset:51200
    ds_read_b64_tr_b16 a[134:135], v237 offset:52224
    v_mfma_f32_16x16x32_bf16 v[28:31], a[160:163], a[80:83], v[28:31]
    s_waitcnt lgkmcnt(8)
    ds_read_b64_tr_b16 a[136:137], v229 offset:49152
    ds_read_b64_tr_b16 a[138:139], v229 offset:50176
    v_mfma_f32_16x16x32_bf16 v[28:31], a[164:167], a[84:87], v[28:31]
    s_waitcnt lgkmcnt(8)
    s_add_u32 s43, s63, 111616
    ds_read_b64_tr_b16 a[140:141], v229 offset:51200
    v_mfma_f32_16x16x32_bf16 v[28:31], a[168:171], a[88:91], v[28:31]
    s_waitcnt lgkmcnt(7)
    buffer_load_dwordx4 v246, s[24:27], s43 offen offset:3072  lds
    v_mfma_f32_16x16x32_bf16 v[28:31], a[172:175], a[92:95], v[28:31]
    s_add_u32 m0, s39, 0
    ds_read_b64_tr_b16 a[142:143], v229 offset:52224
    v_mfma_f32_16x16x32_bf16 v[60:63], a[172:175], a[108:111], v[60:63]
    s_add_u32 s97, s67, 0
    v_mfma_f32_16x16x32_bf16 v[60:63], a[168:171], a[104:107], v[60:63]
    s_add_u32 s43, s61, 131072
    v_mfma_f32_16x16x32_bf16 v[60:63], a[164:167], a[100:103], v[60:63]
    v_mfma_f32_16x16x32_bf16 v[60:63], a[160:163], a[96:99], v[60:63]
    s_waitcnt vmcnt(17) lgkmcnt(0)
    s_barrier
    v_mfma_f32_16x16x32_bf16 v[32:35], a[128:131], a[80:83], v[32:35]
    ds_read_b64_tr_b16 a[144:145], v230 offset:32768
    ds_read_b64_tr_b16 a[146:147], v230 offset:33792
    v_mfma_f32_16x16x32_bf16 v[32:35], a[132:135], a[84:87], v[32:35]
    ds_read_b64_tr_b16 a[148:149], v230 offset:34816
    ds_read_b64_tr_b16 a[150:151], v230 offset:35840
    v_mfma_f32_16x16x32_bf16 v[32:35], a[136:139], a[88:91], v[32:35]
    buffer_load_dwordx4 a[176:179], v247, s[28:31], s97 offen offset:0 sc1
    v_mfma_f32_16x16x32_bf16 v[32:35], a[140:143], a[92:95], v[32:35]
    ds_read_b64_tr_b16 a[152:153], v222 offset:32768
    ds_read_b64_tr_b16 a[154:155], v222 offset:33792
    v_mfma_f32_16x16x32_bf16 v[64:67], a[140:143], a[108:111], v[64:67]
    ds_read_b64_tr_b16 a[156:157], v222 offset:34816
    ds_read_b64_tr_b16 a[158:159], v222 offset:35840
    v_mfma_f32_16x16x32_bf16 v[64:67], a[136:139], a[104:107], v[64:67]
    ds_read_b128 a[224:227], v242 offset:12288
    v_mfma_f32_16x16x32_bf16 v[64:67], a[132:135], a[100:103], v[64:67]
    buffer_load_dwordx4 a[180:183], v247, s[28:31], s97 offen offset:1024 sc1
    v_mfma_f32_16x16x32_bf16 v[64:67], a[128:131], a[96:99], v[64:67]
    s_waitcnt vmcnt(18) lgkmcnt(7)
    ds_read_b128 a[228:231], v242 offset:13312
    v_mfma_f32_16x16x32_bf16 v[4:7], a[144:147], a[112:115], v[4:7]
    s_waitcnt vmcnt(17) lgkmcnt(6)
    ds_read_b128 a[232:235], v242 offset:14336
    v_mfma_f32_16x16x32_bf16 v[4:7], a[148:151], a[116:119], v[4:7]
    s_waitcnt vmcnt(16) lgkmcnt(5)
    ds_read_b128 a[236:239], v242 offset:15360
    ds_read_b64_tr_b16 a[160:161], v231 offset:32768
    v_mfma_f32_16x16x32_bf16 v[4:7], a[152:155], a[120:123], v[4:7]
    s_waitcnt vmcnt(15) lgkmcnt(5)
    buffer_load_dwordx4 a[184:187], v247, s[28:31], s97 offen offset:2048 sc1
    v_mfma_f32_16x16x32_bf16 v[4:7], a[156:159], a[124:127], v[4:7]
    s_waitcnt vmcnt(12)
    ds_read_b64_tr_b16 a[162:163], v231 offset:33792
    ds_read_b64_tr_b16 a[164:165], v231 offset:34816
    v_mfma_f32_16x16x32_bf16 v[36:39], a[156:159], a[220:223], v[36:39]
    ds_read_b64_tr_b16 a[166:167], v231 offset:35840
    ds_read_b64_tr_b16 a[168:169], v223 offset:32768
    v_mfma_f32_16x16x32_bf16 v[36:39], a[152:155], a[216:219], v[36:39]
    buffer_load_dwordx4 a[188:191], v247, s[28:31], s97 offen offset:3072 sc1
    v_mfma_f32_16x16x32_bf16 v[36:39], a[148:151], a[212:215], v[36:39]
    ds_read_b64_tr_b16 a[170:171], v223 offset:33792
    ds_read_b64_tr_b16 a[172:173], v223 offset:34816
    v_mfma_f32_16x16x32_bf16 v[36:39], a[144:147], a[208:211], v[36:39]
    s_waitcnt lgkmcnt(10)
    ds_read_b64_tr_b16 a[174:175], v223 offset:35840
    v_mfma_f32_16x16x32_bf16 v[68:71], a[144:147], a[224:227], v[68:71]
    s_waitcnt lgkmcnt(10)
    s_add_u32 s97, s67, 4096
    v_mfma_f32_16x16x32_bf16 v[68:71], a[148:151], a[228:231], v[68:71]
    s_waitcnt lgkmcnt(9)
    v_mfma_f32_16x16x32_bf16 v[68:71], a[152:155], a[232:235], v[68:71]
    s_waitcnt lgkmcnt(8)
    buffer_load_dwordx4 a[192:195], v247, s[28:31], s97 offen offset:0 sc1
    v_mfma_f32_16x16x32_bf16 v[68:71], a[156:159], a[236:239], v[68:71]
    s_waitcnt lgkmcnt(6)
    ds_read_b64_tr_b16 a[128:129], v232 offset:32768
    v_mfma_f32_16x16x32_bf16 v[8:11], a[160:163], a[112:115], v[8:11]
    s_waitcnt lgkmcnt(5)
    ds_read_b64_tr_b16 a[130:131], v232 offset:33792
    v_mfma_f32_16x16x32_bf16 v[8:11], a[164:167], a[116:119], v[8:11]
    s_waitcnt lgkmcnt(4)
    ds_read_b64_tr_b16 a[132:133], v232 offset:34816
    v_mfma_f32_16x16x32_bf16 v[8:11], a[168:171], a[120:123], v[8:11]
    s_waitcnt lgkmcnt(3)
    ds_read_b64_tr_b16 a[134:135], v232 offset:35840
    v_mfma_f32_16x16x32_bf16 v[8:11], a[172:175], a[124:127], v[8:11]
    buffer_load_dwordx4 a[196:199], v247, s[28:31], s97 offen offset:1024 sc1
    v_mfma_f32_16x16x32_bf16 v[40:43], a[172:175], a[220:223], v[40:43]
    ds_read_b64_tr_b16 a[136:137], v224 offset:32768
    v_mfma_f32_16x16x32_bf16 v[40:43], a[168:171], a[216:219], v[40:43]
    buffer_load_dwordx4 a[204:207], v247, s[28:31], s97 offen offset:3072 sc1
    v_mfma_f32_16x16x32_bf16 v[40:43], a[164:167], a[212:215], v[40:43]
    ds_read_b64_tr_b16 a[138:139], v224 offset:33792
    ds_read_b64_tr_b16 a[140:141], v224 offset:34816
    v_mfma_f32_16x16x32_bf16 v[40:43], a[160:163], a[208:211], v[40:43]
    buffer_load_dwordx4 a[200:203], v247, s[28:31], s97 offen offset:2048 sc1
    v_mfma_f32_16x16x32_bf16 v[72:75], a[160:163], a[224:227], v[72:75]
    ds_read_b64_tr_b16 a[142:143], v224 offset:35840
    v_mfma_f32_16x16x32_bf16 v[72:75], a[164:167], a[228:231], v[72:75]
    buffer_load_dword v254, v255, s[28:31], 0 offen offset:4 sc1
    v_mfma_f32_16x16x32_bf16 v[72:75], a[168:171], a[232:235], v[72:75]
    ds_read_b64_tr_b16 a[144:145], v233 offset:32768
    ds_read_b64_tr_b16 a[146:147], v233 offset:33792
    v_mfma_f32_16x16x32_bf16 v[72:75], a[172:175], a[236:239], v[72:75]
    s_waitcnt lgkmcnt(8)
    ds_read_b64_tr_b16 a[148:149], v233 offset:34816
    ds_read_b64_tr_b16 a[150:151], v233 offset:35840
    v_mfma_f32_16x16x32_bf16 v[12:15], a[128:131], a[112:115], v[12:15]
    s_waitcnt lgkmcnt(8)
    ds_read_b64_tr_b16 a[152:153], v225 offset:32768
    v_mfma_f32_16x16x32_bf16 v[12:15], a[132:135], a[116:119], v[12:15]
    s_waitcnt lgkmcnt(7)
    ds_read_b64_tr_b16 a[154:155], v225 offset:33792
    v_mfma_f32_16x16x32_bf16 v[12:15], a[136:139], a[120:123], v[12:15]
    s_waitcnt lgkmcnt(6)
    ds_read_b64_tr_b16 a[156:157], v225 offset:34816
    ds_read_b64_tr_b16 a[158:159], v225 offset:35840
    v_mfma_f32_16x16x32_bf16 v[12:15], a[140:143], a[124:127], v[12:15]
    buffer_load_dwordx4 v246, s[24:27], s43 offen offset:0  lds
    v_mfma_f32_16x16x32_bf16 v[44:47], a[140:143], a[220:223], v[44:47]
    s_add_u32 s43, s61, 146432
    ds_read_b64_tr_b16 a[160:161], v234 offset:32768
    v_mfma_f32_16x16x32_bf16 v[44:47], a[136:139], a[216:219], v[44:47]
    ds_read_b64_tr_b16 a[162:163], v234 offset:33792
    v_mfma_f32_16x16x32_bf16 v[44:47], a[132:135], a[212:215], v[44:47]
    ds_read_b64_tr_b16 a[164:165], v234 offset:34816
    v_mfma_f32_16x16x32_bf16 v[44:47], a[128:131], a[208:211], v[44:47]
    s_waitcnt lgkmcnt(9)
    ds_read_b64_tr_b16 a[166:167], v234 offset:35840
    v_mfma_f32_16x16x32_bf16 v[16:19], a[144:147], a[112:115], v[16:19]
    s_waitcnt lgkmcnt(8)
    buffer_load_dwordx4 v246, s[24:27], s43 offen offset:1024  lds
    v_mfma_f32_16x16x32_bf16 v[16:19], a[148:151], a[116:119], v[16:19]
    s_waitcnt lgkmcnt(6)
    ds_read_b64_tr_b16 a[168:169], v226 offset:32768
    ds_read_b64_tr_b16 a[170:171], v226 offset:33792
    v_mfma_f32_16x16x32_bf16 v[16:19], a[152:155], a[120:123], v[16:19]
    s_waitcnt lgkmcnt(6)
    ds_read_b64_tr_b16 a[172:173], v226 offset:34816
    ds_read_b64_tr_b16 a[174:175], v226 offset:35840
    v_mfma_f32_16x16x32_bf16 v[16:19], a[156:159], a[124:127], v[16:19]
    s_add_u32 s43, s61, 161792
    ds_read_b64_tr_b16 a[128:129], v235 offset:32768
    v_mfma_f32_16x16x32_bf16 v[48:51], a[156:159], a[220:223], v[48:51]
    ds_read_b64_tr_b16 a[130:131], v235 offset:33792
    v_mfma_f32_16x16x32_bf16 v[48:51], a[152:155], a[216:219], v[48:51]
    buffer_load_dwordx4 v246, s[24:27], s43 offen offset:2048  lds
    v_mfma_f32_16x16x32_bf16 v[48:51], a[148:151], a[212:215], v[48:51]
    s_add_u32 s43, s61, 177152
    ds_read_b64_tr_b16 a[132:133], v235 offset:34816
    v_mfma_f32_16x16x32_bf16 v[48:51], a[144:147], a[208:211], v[48:51]
    s_waitcnt lgkmcnt(9)
    ds_read_b64_tr_b16 a[134:135], v235 offset:35840
    v_mfma_f32_16x16x32_bf16 v[20:23], a[160:163], a[112:115], v[20:23]
    s_waitcnt lgkmcnt(8)
    buffer_load_dwordx4 v246, s[24:27], s43 offen offset:3072  lds
    v_mfma_f32_16x16x32_bf16 v[20:23], a[164:167], a[116:119], v[20:23]
    s_waitcnt lgkmcnt(6)
    ds_read_b64_tr_b16 a[136:137], v227 offset:32768
    ds_read_b64_tr_b16 a[138:139], v227 offset:33792
    v_mfma_f32_16x16x32_bf16 v[20:23], a[168:171], a[120:123], v[20:23]
    s_waitcnt lgkmcnt(6)
    ds_read_b64_tr_b16 a[140:141], v227 offset:34816
    ds_read_b64_tr_b16 a[142:143], v227 offset:35840
    v_mfma_f32_16x16x32_bf16 v[20:23], a[172:175], a[124:127], v[20:23]
    s_add_u32 m0, s39, 65536
    s_add_u32 s43, s61, 196608
    ds_read_b64_tr_b16 a[144:145], v236 offset:32768
    v_mfma_f32_16x16x32_bf16 v[52:55], a[172:175], a[220:223], v[52:55]
    buffer_load_dwordx4 v246, s[24:27], s43 offen offset:0  lds
    v_mfma_f32_16x16x32_bf16 v[52:55], a[168:171], a[216:219], v[52:55]
    s_add_u32 s43, s61, 211968
    ds_read_b64_tr_b16 a[146:147], v236 offset:33792
    v_mfma_f32_16x16x32_bf16 v[52:55], a[164:167], a[212:215], v[52:55]
    ds_read_b64_tr_b16 a[148:149], v236 offset:34816
    v_mfma_f32_16x16x32_bf16 v[52:55], a[160:163], a[208:211], v[52:55]
    s_waitcnt lgkmcnt(9)
    buffer_load_dwordx4 v246, s[24:27], s43 offen offset:1024  lds
    v_mfma_f32_16x16x32_bf16 v[24:27], a[128:131], a[112:115], v[24:27]
    s_waitcnt lgkmcnt(7)
    ds_read_b64_tr_b16 a[150:151], v236 offset:35840
    ds_read_b64_tr_b16 a[152:153], v228 offset:32768
    v_mfma_f32_16x16x32_bf16 v[24:27], a[132:135], a[116:119], v[24:27]
    s_waitcnt lgkmcnt(7)
    ds_read_b64_tr_b16 a[154:155], v228 offset:33792
    v_mfma_f32_16x16x32_bf16 v[24:27], a[136:139], a[120:123], v[24:27]
    s_waitcnt lgkmcnt(6)
    s_add_u32 s43, s61, 227328
    ds_read_b64_tr_b16 a[156:157], v228 offset:34816
    v_mfma_f32_16x16x32_bf16 v[24:27], a[140:143], a[124:127], v[24:27]
    buffer_load_dwordx4 v246, s[24:27], s43 offen offset:2048  lds
    v_mfma_f32_16x16x32_bf16 v[56:59], a[140:143], a[220:223], v[56:59]
    s_add_u32 s43, s61, 242688
    ds_read_b64_tr_b16 a[158:159], v228 offset:35840
    ds_read_b64_tr_b16 a[160:161], v237 offset:32768
    v_mfma_f32_16x16x32_bf16 v[56:59], a[136:139], a[216:219], v[56:59]
    ds_read_b64_tr_b16 a[162:163], v237 offset:33792
    ds_read_b64_tr_b16 a[164:165], v237 offset:34816
    v_mfma_f32_16x16x32_bf16 v[56:59], a[132:135], a[212:215], v[56:59]
    buffer_load_dwordx4 v246, s[24:27], s43 offen offset:3072  lds
    v_mfma_f32_16x16x32_bf16 v[56:59], a[128:131], a[208:211], v[56:59]
    s_waitcnt lgkmcnt(9)
    ds_read_b64_tr_b16 a[166:167], v237 offset:35840
    ds_read_b64_tr_b16 a[168:169], v229 offset:32768
    v_mfma_f32_16x16x32_bf16 v[28:31], a[144:147], a[112:115], v[28:31]
    s_waitcnt lgkmcnt(9)
    ds_read_b64_tr_b16 a[170:171], v229 offset:33792
    v_mfma_f32_16x16x32_bf16 v[28:31], a[148:151], a[116:119], v[28:31]
    s_waitcnt lgkmcnt(8)
    s_add_u32 m0, s39, 49152
    s_add_u32 s43, s62, 131072
    v_mfma_f32_16x16x32_bf16 v[28:31], a[152:155], a[120:123], v[28:31]
    s_waitcnt lgkmcnt(6)
    buffer_load_dwordx4 v246, s[24:27], s43 offen offset:0  lds
    v_mfma_f32_16x16x32_bf16 v[28:31], a[156:159], a[124:127], v[28:31]
    s_add_u32 s43, s62, 146432
    ds_read_b64_tr_b16 a[172:173], v229 offset:34816
    ds_read_b64_tr_b16 a[174:175], v229 offset:35840
    v_mfma_f32_16x16x32_bf16 v[60:63], a[156:159], a[220:223], v[60:63]
    v_mfma_f32_16x16x32_bf16 v[60:63], a[152:155], a[216:219], v[60:63]
    buffer_load_dwordx4 v246, s[24:27], s43 offen offset:1024  lds
    v_mfma_f32_16x16x32_bf16 v[60:63], a[148:151], a[212:215], v[60:63]
    s_add_u32 s43, s62, 161792
    v_mfma_f32_16x16x32_bf16 v[60:63], a[144:147], a[208:211], v[60:63]
    s_waitcnt vmcnt(19) lgkmcnt(0)
    s_barrier
    v_mfma_f32_16x16x32_bf16 v[32:35], a[160:163], a[112:115], v[32:35]
    ds_read_b64_tr_b16 a[128:129], v230 offset:16384
    ds_read_b64_tr_b16 a[130:131], v230 offset:17408
    v_mfma_f32_16x16x32_bf16 v[32:35], a[164:167], a[116:119], v[32:35]
    buffer_load_dwordx4 v246, s[24:27], s43 offen offset:2048  lds
    ds_read_b64_tr_b16 a[132:133], v230 offset:18432
    v_mfma_f32_16x16x32_bf16 v[32:35], a[168:171], a[120:123], v[32:35]
    ds_read_b64_tr_b16 a[134:135], v230 offset:19456
    ds_read_b64_tr_b16 a[136:137], v222 offset:16384
    v_mfma_f32_16x16x32_bf16 v[32:35], a[172:175], a[124:127], v[32:35]
    s_add_u32 s43, s62, 177152
    ds_read_b64_tr_b16 a[138:139], v222 offset:17408
    ds_read_b64_tr_b16 a[140:141], v222 offset:18432
    v_mfma_f32_16x16x32_bf16 v[64:67], a[172:175], a[220:223], v[64:67]
    buffer_load_dwordx4 v246, s[24:27], s43 offen offset:3072  lds
    v_mfma_f32_16x16x32_bf16 v[64:67], a[168:171], a[216:219], v[64:67]
    s_add_u32 m0, s39, 114688
    ds_read_b64_tr_b16 a[142:143], v222 offset:19456
    v_mfma_f32_16x16x32_bf16 v[64:67], a[164:167], a[212:215], v[64:67]
    s_add_u32 s43, s62, 196608
    ds_read_b128 a[224:227], v242 offset:0
    v_mfma_f32_16x16x32_bf16 v[64:67], a[160:163], a[208:211], v[64:67]
    s_waitcnt vmcnt(20) lgkmcnt(7)
    ds_read_b128 a[228:231], v242 offset:1024
    v_mfma_f32_16x16x32_bf16 v[4:7], a[128:131], a[176:179], v[4:7]
    s_waitcnt vmcnt(19) lgkmcnt(6)
    buffer_load_dwordx4 v246, s[24:27], s43 offen offset:0  lds
    v_mfma_f32_16x16x32_bf16 v[4:7], a[132:135], a[180:183], v[4:7]
    s_waitcnt vmcnt(19) lgkmcnt(4)
    ds_read_b128 a[232:235], v242 offset:2048
    ds_read_b64_tr_b16 a[144:145], v231 offset:16384
    v_mfma_f32_16x16x32_bf16 v[4:7], a[136:139], a[184:187], v[4:7]
    s_waitcnt vmcnt(18) lgkmcnt(4)
    ds_read_b128 a[236:239], v242 offset:3072
    ds_read_b64_tr_b16 a[146:147], v231 offset:17408
    v_mfma_f32_16x16x32_bf16 v[4:7], a[140:143], a[188:191], v[4:7]
    s_waitcnt vmcnt(13)
    v_cmp_ne_u32 vcc, 1, v254
    s_cbranch_vccnz L_spin_o1
L_ret_o1:
    v_mfma_f32_16x16x32_bf16 v[36:39], a[140:143], a[204:207], v[36:39]
    ds_read_b64_tr_b16 a[148:149], v231 offset:18432
    ds_read_b64_tr_b16 a[150:151], v231 offset:19456
    v_mfma_f32_16x16x32_bf16 v[36:39], a[136:139], a[200:203], v[36:39]
    s_add_u32 s97, s65, 36864
    s_add_u32 m0, s83, 135168
    v_mfma_f32_16x16x32_bf16 v[36:39], a[132:135], a[196:199], v[36:39]
    s_add_u32 s43, s65, 36864
    ds_read_b64_tr_b16 a[152:153], v223 offset:16384
    v_mfma_f32_16x16x32_bf16 v[36:39], a[128:131], a[192:195], v[36:39]
    s_waitcnt lgkmcnt(8)
    buffer_load_dwordx4 v252, s[28:31], s43 offen offset:0 sc1 lds
    v_mfma_f32_16x16x32_bf16 v[68:71], a[128:131], a[224:227], v[68:71]
    s_waitcnt lgkmcnt(7)
    ds_read_b64_tr_b16 a[154:155], v223 offset:17408
    ds_read_b64_tr_b16 a[156:157], v223 offset:18432
    v_mfma_f32_16x16x32_bf16 v[68:71], a[132:135], a[228:231], v[68:71]
    s_waitcnt lgkmcnt(8)
    buffer_load_dwordx4 a[32:35], v247, s[28:31], s97 offen offset:0 sc1
    ds_read_b64_tr_b16 a[158:159], v223 offset:19456
    v_mfma_f32_16x16x32_bf16 v[68:71], a[136:139], a[232:235], v[68:71]
    s_waitcnt lgkmcnt(7)
    ds_read_b64_tr_b16 a[160:161], v232 offset:16384
    v_mfma_f32_16x16x32_bf16 v[68:71], a[140:143], a[236:239], v[68:71]
    s_waitcnt lgkmcnt(7)
    ds_read_b64_tr_b16 a[162:163], v232 offset:17408
    v_mfma_f32_16x16x32_bf16 v[8:11], a[144:147], a[176:179], v[8:11]
    s_waitcnt lgkmcnt(6)
    buffer_load_dwordx4 a[36:39], v247, s[28:31], s97 offen offset:1024 sc1
    v_mfma_f32_16x16x32_bf16 v[8:11], a[148:151], a[180:183], v[8:11]
    s_waitcnt lgkmcnt(4)
    ds_read_b64_tr_b16 a[164:165], v232 offset:18432
    v_mfma_f32_16x16x32_bf16 v[8:11], a[152:155], a[184:187], v[8:11]
    s_waitcnt lgkmcnt(3)
    ds_read_b64_tr_b16 a[166:167], v232 offset:19456
    v_mfma_f32_16x16x32_bf16 v[8:11], a[156:159], a[188:191], v[8:11]
    s_add_u32 m0, s83, 139264
    buffer_load_dwordx4 a[40:43], v247, s[28:31], s97 offen offset:2048 sc1
    v_mfma_f32_16x16x32_bf16 v[40:43], a[156:159], a[204:207], v[40:43]
    s_add_u32 s43, s66, 36864
    ds_read_b64_tr_b16 a[168:169], v224 offset:16384
    v_mfma_f32_16x16x32_bf16 v[40:43], a[152:155], a[200:203], v[40:43]
    buffer_load_dwordx4 a[44:47], v247, s[28:31], s97 offen offset:3072 sc1
    v_mfma_f32_16x16x32_bf16 v[40:43], a[148:151], a[196:199], v[40:43]
    s_add_u32 s97, s65, 40960
    ds_read_b64_tr_b16 a[170:171], v224 offset:17408
    ds_read_b64_tr_b16 a[172:173], v224 offset:18432
    v_mfma_f32_16x16x32_bf16 v[40:43], a[144:147], a[192:195], v[40:43]
    buffer_load_dwordx4 a[56:59], v247, s[28:31], s97 offen offset:2048 sc1
    v_mfma_f32_16x16x32_bf16 v[72:75], a[144:147], a[224:227], v[72:75]
    ds_read_b64_tr_b16 a[174:175], v224 offset:19456
    v_mfma_f32_16x16x32_bf16 v[72:75], a[148:151], a[228:231], v[72:75]
    buffer_load_dwordx4 a[60:63], v247, s[28:31], s97 offen offset:3072 sc1
    v_mfma_f32_16x16x32_bf16 v[72:75], a[152:155], a[232:235], v[72:75]
    buffer_load_dwordx4 a[52:55], v247, s[28:31], s97 offen offset:1024 sc1
    v_mfma_f32_16x16x32_bf16 v[72:75], a[156:159], a[236:239], v[72:75]
    s_waitcnt lgkmcnt(6)
    buffer_load_dwordx4 a[48:51], v247, s[28:31], s97 offen offset:0 sc1
    v_mfma_f32_16x16x32_bf16 v[12:15], a[160:163], a[176:179], v[12:15]
    s_waitcnt lgkmcnt(4)
    ds_read_b64_tr_b16 a[128:129], v233 offset:16384
    ds_read_b64_tr_b16 a[130:131], v233 offset:17408
    v_mfma_f32_16x16x32_bf16 v[12:15], a[164:167], a[180:183], v[12:15]
    s_waitcnt lgkmcnt(4)
    ds_read_b64_tr_b16 a[132:133], v233 offset:18432
    ds_read_b64_tr_b16 a[134:135], v233 offset:19456
    v_mfma_f32_16x16x32_bf16 v[12:15], a[168:171], a[184:187], v[12:15]
    s_waitcnt lgkmcnt(4)
    buffer_load_dwordx4 v252, s[28:31], s43 offen offset:0 sc1 lds
    v_mfma_f32_16x16x32_bf16 v[12:15], a[172:175], a[188:191], v[12:15]
    s_add_u32 m0, s39, 115712
    ds_read_b64_tr_b16 a[136:137], v225 offset:16384
    ds_read_b64_tr_b16 a[138:139], v225 offset:17408
    v_mfma_f32_16x16x32_bf16 v[44:47], a[172:175], a[204:207], v[44:47]
    s_add_u32 s43, s62, 212992
    ds_read_b64_tr_b16 a[140:141], v225 offset:18432
    ds_read_b64_tr_b16 a[142:143], v225 offset:19456
    v_mfma_f32_16x16x32_bf16 v[44:47], a[168:171], a[200:203], v[44:47]
    ds_read_b64_tr_b16 a[144:145], v234 offset:16384
    v_mfma_f32_16x16x32_bf16 v[44:47], a[164:167], a[196:199], v[44:47]
    ds_read_b64_tr_b16 a[146:147], v234 offset:17408
    ds_read_b64_tr_b16 a[148:149], v234 offset:18432
    v_mfma_f32_16x16x32_bf16 v[44:47], a[160:163], a[192:195], v[44:47]
    s_waitcnt lgkmcnt(9)
    ds_read_b64_tr_b16 a[150:151], v234 offset:19456
    v_mfma_f32_16x16x32_bf16 v[16:19], a[128:131], a[176:179], v[16:19]
    s_waitcnt lgkmcnt(8)
    buffer_load_dwordx4 v246, s[24:27], s43 offen offset:0  lds
    v_mfma_f32_16x16x32_bf16 v[16:19], a[132:135], a[180:183], v[16:19]
    s_waitcnt lgkmcnt(6)
    ds_read_b64_tr_b16 a[152:153], v226 offset:16384
    ds_read_b64_tr_b16 a[154:155], v226 offset:17408
    v_mfma_f32_16x16x32_bf16 v[16:19], a[136:139], a[184:187], v[16:19]
    s_waitcnt lgkmcnt(6)
    ds_read_b64_tr_b16 a[156:157], v226 offset:18432
    ds_read_b64_tr_b16 a[158:159], v226 offset:19456
    v_mfma_f32_16x16x32_bf16 v[16:19], a[140:143], a[188:191], v[16:19]
    s_add_u32 s43, s62, 228352
    ds_read_b64_tr_b16 a[160:161], v235 offset:16384
    v_mfma_f32_16x16x32_bf16 v[48:51], a[140:143], a[204:207], v[48:51]
    ds_read_b64_tr_b16 a[162:163], v235 offset:17408
    v_mfma_f32_16x16x32_bf16 v[48:51], a[136:139], a[200:203], v[48:51]
    ds_read_b64_tr_b16 a[164:165], v235 offset:18432
    v_mfma_f32_16x16x32_bf16 v[48:51], a[132:135], a[196:199], v[48:51]
    buffer_load_dwordx4 v246, s[24:27], s43 offen offset:1024  lds
    v_mfma_f32_16x16x32_bf16 v[48:51], a[128:131], a[192:195], v[48:51]
    s_waitcnt lgkmcnt(9)
    ds_read_b64_tr_b16 a[166:167], v235 offset:19456
    v_mfma_f32_16x16x32_bf16 v[20:23], a[144:147], a[176:179], v[20:23]
    s_waitcnt lgkmcnt(8)
    ds_read_b64_tr_b16 a[168:169], v227 offset:16384
    v_mfma_f32_16x16x32_bf16 v[20:23], a[148:151], a[180:183], v[20:23]
    s_waitcnt lgkmcnt(7)
    ds_read_b64_tr_b16 a[170:171], v227 offset:17408
    v_mfma_f32_16x16x32_bf16 v[20:23], a[152:155], a[184:187], v[20:23]
    s_waitcnt lgkmcnt(6)
    ds_read_b64_tr_b16 a[172:173], v227 offset:18432
    ds_read_b64_tr_b16 a[174:175], v227 offset:19456
    v_mfma_f32_16x16x32_bf16 v[20:23], a[156:159], a[188:191], v[20:23]
    s_add_u32 s43, s62, 243712
    ds_read_b64_tr_b16 a[128:129], v236 offset:16384
    v_mfma_f32_16x16x32_bf16 v[52:55], a[156:159], a[204:207], v[52:55]
    s_add_u32 s97, s66, 36864
    buffer_load_dwordx4 v246, s[24:27], s43 offen offset:2048  lds
    v_mfma_f32_16x16x32_bf16 v[52:55], a[152:155], a[200:203], v[52:55]
    s_add_u32 m0, s83, 143360
    ds_read_b64_tr_b16 a[130:131], v236 offset:17408
    v_mfma_f32_16x16x32_bf16 v[52:55], a[148:151], a[196:199], v[52:55]
    s_add_u32 s43, s67, 36864
    ds_read_b64_tr_b16 a[132:133], v236 offset:18432
    v_mfma_f32_16x16x32_bf16 v[52:55], a[144:147], a[192:195], v[52:55]
    s_waitcnt lgkmcnt(9)
    ds_read_b64_tr_b16 a[134:135], v236 offset:19456
    v_mfma_f32_16x16x32_bf16 v[24:27], a[160:163], a[176:179], v[24:27]
    s_waitcnt lgkmcnt(8)
    ds_read_b64_tr_b16 a[136:137], v228 offset:16384
    v_mfma_f32_16x16x32_bf16 v[24:27], a[164:167], a[180:183], v[24:27]
    s_waitcnt lgkmcnt(7)
    buffer_load_dwordx4 a[80:83], v247, s[28:31], s97 offen offset:0 sc1
    v_mfma_f32_16x16x32_bf16 v[24:27], a[168:171], a[184:187], v[24:27]
    s_waitcnt lgkmcnt(5)
    ds_read_b64_tr_b16 a[138:139], v228 offset:17408
    ds_read_b64_tr_b16 a[140:141], v228 offset:18432
    v_mfma_f32_16x16x32_bf16 v[24:27], a[172:175], a[188:191], v[24:27]
    ds_read_b64_tr_b16 a[142:143], v228 offset:19456
    v_mfma_f32_16x16x32_bf16 v[56:59], a[172:175], a[204:207], v[56:59]
    ds_read_b64_tr_b16 a[144:145], v237 offset:16384
    v_mfma_f32_16x16x32_bf16 v[56:59], a[168:171], a[200:203], v[56:59]
L_pad12:
    s_cbranch_execz L_back3
    buffer_load_dwordx4 a[84:87], v247, s[28:31], s97 offen offset:1024 sc1
    v_mfma_f32_16x16x32_bf16 v[56:59], a[164:167], a[196:199], v[56:59]
    ds_read_b64_tr_b16 a[146:147], v237 offset:17408
    ds_read_b64_tr_b16 a[148:149], v237 offset:18432
    v_mfma_f32_16x16x32_bf16 v[56:59], a[160:163], a[192:195], v[56:59]
    s_waitcnt lgkmcnt(9)
    ds_read_b64_tr_b16 a[150:151], v237 offset:19456
    ds_read_b64_tr_b16 a[152:153], v229 offset:16384
    v_mfma_f32_16x16x32_bf16 v[28:31], a[128:131], a[176:179], v[28:31]
    s_waitcnt lgkmcnt(9)
    buffer_load_dwordx4 a[88:91], v247, s[28:31], s97 offen offset:2048 sc1
    v_mfma_f32_16x16x32_bf16 v[28:31], a[132:135], a[180:183], v[28:31]
    s_waitcnt lgkmcnt(7)
    ds_read_b64_tr_b16 a[154:155], v229 offset:17408
    ds_read_b64_tr_b16 a[156:157], v229 offset:18432
    v_mfma_f32_16x16x32_bf16 v[28:31], a[136:139], a[184:187], v[28:31]
    s_waitcnt lgkmcnt(7)
    ds_read_b64_tr_b16 a[158:159], v229 offset:19456
    v_mfma_f32_16x16x32_bf16 v[28:31], a[140:143], a[188:191], v[28:31]
    v_mfma_f32_16x16x32_bf16 v[60:63], a[140:143], a[204:207], v[60:63]
    buffer_load_dwordx4 a[92:95], v247, s[28:31], s97 offen offset:3072 sc1
    v_mfma_f32_16x16x32_bf16 v[60:63], a[136:139], a[200:203], v[60:63]
    s_add_u32 s97, s66, 40960
    v_mfma_f32_16x16x32_bf16 v[60:63], a[132:135], a[196:199], v[60:63]
    v_mfma_f32_16x16x32_bf16 v[60:63], a[128:131], a[192:195], v[60:63]
    s_waitcnt vmcnt(16) lgkmcnt(0)
    s_barrier
    ds_read_b64_tr_b16 a[160:161], v230 offset:0
    v_mfma_f32_16x16x32_bf16 v[32:35], a[144:147], a[176:179], v[32:35]
    ds_read_b64_tr_b16 a[162:163], v230 offset:1024
    ds_read_b64_tr_b16 a[164:165], v230 offset:2048
    v_mfma_f32_16x16x32_bf16 v[32:35], a[148:151], a[180:183], v[32:35]
    buffer_load_dwordx4 a[96:99], v247, s[28:31], s97 offen offset:0 sc1
    ds_read_b64_tr_b16 a[166:167], v230 offset:3072
    v_mfma_f32_16x16x32_bf16 v[32:35], a[152:155], a[184:187], v[32:35]
    ds_read_b64_tr_b16 a[168:169], v222 offset:0
    ds_read_b64_tr_b16 a[170:171], v222 offset:1024
    v_mfma_f32_16x16x32_bf16 v[32:35], a[156:159], a[188:191], v[32:35]
    ds_read_b64_tr_b16 a[172:173], v222 offset:2048
    ds_read_b64_tr_b16 a[174:175], v222 offset:3072
    v_mfma_f32_16x16x32_bf16 v[64:67], a[156:159], a[204:207], v[64:67]
    ds_read_b128 a[224:227], v242 offset:4096
    v_mfma_f32_16x16x32_bf16 v[64:67], a[152:155], a[200:203], v[64:67]
    buffer_load_dwordx4 a[100:103], v247, s[28:31], s97 offen offset:1024 sc1
    v_mfma_f32_16x16x32_bf16 v[64:67], a[148:151], a[196:199], v[64:67]
    ds_read_b128 a[228:231], v242 offset:5120
    ds_read_b64_tr_b16 a[128:129], v231 offset:0
    v_mfma_f32_16x16x32_bf16 v[64:67], a[144:147], a[192:195], v[64:67]
    s_waitcnt vmcnt(17) lgkmcnt(9)
    ds_read_b128 a[232:235], v242 offset:6144
    ds_read_b64_tr_b16 a[130:131], v231 offset:1024
    v_mfma_f32_16x16x32_bf16 v[4:7], a[160:163], a[32:35], v[4:7]
    s_waitcnt vmcnt(16) lgkmcnt(9)
    ds_read_b128 a[236:239], v242 offset:7168
    v_bfe_u32 v188, v247, 4, 2
    v_mfma_f32_16x16x32_bf16 v[4:7], a[164:167], a[36:39], v[4:7]
    s_waitcnt vmcnt(15) lgkmcnt(8)
    buffer_load_dwordx4 a[104:107], v247, s[28:31], s97 offen offset:2048 sc1
    v_mfma_f32_16x16x32_bf16 v[4:7], a[168:171], a[40:43], v[4:7]
    s_waitcnt vmcnt(15) lgkmcnt(6)
    ds_read_b64_tr_b16 a[132:133], v231 offset:2048
    ds_read_b64_tr_b16 a[134:135], v231 offset:3072
    v_mfma_f32_16x16x32_bf16 v[4:7], a[172:175], a[44:47], v[4:7]
    s_waitcnt vmcnt(13)
    buffer_load_dwordx4 a[108:111], v247, s[28:31], s97 offen offset:3072 sc1
    v_mfma_f32_16x16x32_bf16 v[36:39], a[172:175], a[60:63], v[36:39]
    ds_read_b64_tr_b16 a[136:137], v223 offset:0
    ds_read_b64_tr_b16 a[138:139], v223 offset:1024
    v_mfma_f32_16x16x32_bf16 v[36:39], a[168:171], a[56:59], v[36:39]
    s_waitcnt vmcnt(13)
    ds_read_b64_tr_b16 a[140:141], v223 offset:2048
    ds_read_b64_tr_b16 a[142:143], v223 offset:3072
    v_mfma_f32_16x16x32_bf16 v[36:39], a[164:167], a[52:55], v[36:39]
    s_waitcnt vmcnt(12)
    ds_read_b64_tr_b16 a[144:145], v232 offset:0
    v_max_u32 v190, 1, v188
    v_mfma_f32_16x16x32_bf16 v[36:39], a[160:163], a[48:51], v[36:39]
    s_waitcnt lgkmcnt(12)
    buffer_load_dwordx4 v252, s[28:31], s43 offen offset:0 sc1 lds
    v_mfma_f32_16x16x32_bf16 v[68:71], a[160:163], a[224:227], v[68:71]
    s_waitcnt lgkmcnt(11)
    ds_read_b64_tr_b16 a[146:147], v232 offset:1024
    ds_read_b64_tr_b16 a[148:149], v232 offset:2048
    v_mfma_f32_16x16x32_bf16 v[68:71], a[164:167], a[228:231], v[68:71]
    s_waitcnt lgkmcnt(11)
    ds_read_b64_tr_b16 a[150:151], v232 offset:3072
    ds_read_b64_tr_b16 a[152:153], v224 offset:0
    v_mfma_f32_16x16x32_bf16 v[68:71], a[168:171], a[232:235], v[68:71]
    s_waitcnt lgkmcnt(11)
    ds_read_b64_tr_b16 a[154:155], v224 offset:1024
    v_lshlrev_b32 v189, 9, v190
    v_mfma_f32_16x16x32_bf16 v[68:71], a[172:175], a[236:239], v[68:71]
    s_add_u32 m0, s39, 32768
    s_add_u32 s43, s63, 131072
    v_mfma_f32_16x16x32_bf16 v[8:11], a[128:131], a[32:35], v[8:11]
    s_waitcnt lgkmcnt(10)
    buffer_load_dwordx4 v246, s[24:27], s43 offen offset:0  lds
    ds_read_b64_tr_b16 a[156:157], v224 offset:2048
    v_mfma_f32_16x16x32_bf16 v[8:11], a[132:135], a[36:39], v[8:11]
    s_waitcnt lgkmcnt(9)
    ds_read_b64_tr_b16 a[158:159], v224 offset:3072
    ds_read_b64_tr_b16 a[160:161], v233 offset:0
    v_mfma_f32_16x16x32_bf16 v[8:11], a[136:139], a[40:43], v[8:11]
    s_waitcnt lgkmcnt(9)
    ds_read_b64_tr_b16 a[162:163], v233 offset:1024
    ds_read_b64_tr_b16 a[164:165], v233 offset:2048
    v_mfma_f32_16x16x32_bf16 v[8:11], a[140:143], a[44:47], v[8:11]
    s_add_u32 s43, s63, 146432
    ds_read_b64_tr_b16 a[166:167], v233 offset:3072
    ds_read_b64_tr_b16 a[168:169], v225 offset:0
    v_mfma_f32_16x16x32_bf16 v[40:43], a[140:143], a[60:63], v[40:43]
    s_cmp_eq_u32 s36, 0
    s_cselect_b32 s4, 64, 0
    buffer_load_dwordx4 v246, s[24:27], s43 offen offset:1024  lds
    v_mfma_f32_16x16x32_bf16 v[40:43], a[136:139], a[56:59], v[40:43]
    s_add_u32 s43, s63, 161792
    ds_read_b64_tr_b16 a[170:171], v225 offset:1024
    ds_read_b64_tr_b16 a[172:173], v225 offset:2048
    v_mfma_f32_16x16x32_bf16 v[40:43], a[132:135], a[52:55], v[40:43]
    ds_read_b64_tr_b16 a[174:175], v225 offset:3072
    v_xor_b32 v189, s47, v189
    v_mfma_f32_16x16x32_bf16 v[40:43], a[128:131], a[48:51], v[40:43]
    v_mul_u32_u24 v190, 640, v190
    v_xor_b32 v190, s47, v190
    v_mfma_f32_16x16x32_bf16 v[72:75], a[128:131], a[224:227], v[72:75]
    ds_read_b64_tr_b16 a[128:129], v234 offset:0
    ds_read_b64_tr_b16 a[130:131], v234 offset:1024
    v_mfma_f32_16x16x32_bf16 v[72:75], a[132:135], a[228:231], v[72:75]
    buffer_load_dwordx4 v246, s[24:27], s43 offen offset:2048  lds
    ds_read_b64_tr_b16 a[132:133], v234 offset:2048
    v_mfma_f32_16x16x32_bf16 v[72:75], a[136:139], a[232:235], v[72:75]
    s_add_u32 s43, s63, 177152
    ds_read_b64_tr_b16 a[134:135], v234 offset:3072
    ds_read_b64_tr_b16 a[136:137], v226 offset:0
    v_mfma_f32_16x16x32_bf16 v[72:75], a[140:143], a[236:239], v[72:75]
    s_waitcnt lgkmcnt(15)
    ds_read_b64_tr_b16 a[138:139], v226 offset:1024
    ds_read_b64_tr_b16 a[140:141], v226 offset:2048
    v_mfma_f32_16x16x32_bf16 v[12:15], a[144:147], a[32:35], v[12:15]
    ds_read_b64_tr_b16 a[142:143], v226 offset:3072
    v_and_b32 v191, s4, v247
    v_mfma_f32_16x16x32_bf16 v[12:15], a[148:151], a[36:39], v[12:15]
    v_bfe_u32 v192, v247, 4, 4
    v_lshlrev_b32 v185, 10, v192
    v_mfma_f32_16x16x32_bf16 v[12:15], a[152:155], a[40:43], v[12:15]
    s_waitcnt lgkmcnt(15)
    buffer_load_dwordx4 v246, s[24:27], s43 offen offset:3072  lds
    v_mfma_f32_16x16x32_bf16 v[12:15], a[156:159], a[44:47], v[12:15]
    s_add_u32 m0, s39, 98304
    ds_read_b64_tr_b16 v[76:77], v236 offset:0
    v_bfe_u32 v193, v247, 8, 1
    v_mfma_f32_16x16x32_bf16 v[44:47], a[156:159], a[60:63], v[44:47]
    s_add_u32 s43, s63, 196608
    ds_read_b64_tr_b16 a[156:157], v227 offset:2048
    v_lshl_add_u32 v185, v193, 5, v185
    v_mfma_f32_16x16x32_bf16 v[44:47], a[152:155], a[56:59], v[44:47]
    ds_read_b64_tr_b16 a[152:153], v227 offset:0
    ds_read_b64_tr_b16 a[154:155], v227 offset:1024
    v_mfma_f32_16x16x32_bf16 v[44:47], a[148:151], a[52:55], v[44:47]
    buffer_load_dwordx4 v246, s[24:27], s43 offen offset:0  lds
    ds_read_b64_tr_b16 a[148:149], v235 offset:2048
    ds_read_b64_tr_b16 a[150:151], v235 offset:3072
    v_mfma_f32_16x16x32_bf16 v[44:47], a[144:147], a[48:51], v[44:47]
    s_waitcnt lgkmcnt(15)
    ds_read_b64_tr_b16 a[144:145], v235 offset:0
    ds_read_b64_tr_b16 a[146:147], v235 offset:1024
    v_mfma_f32_16x16x32_bf16 v[16:19], a[160:163], a[32:35], v[16:19]
    ds_read_b64_tr_b16 a[158:159], v227 offset:3072
    ds_read_b64_tr_b16 v[78:79], v236 offset:1024
    v_mfma_f32_16x16x32_bf16 v[16:19], a[164:167], a[36:39], v[16:19]
    s_add_u32 s43, s63, 211968
    ds_read_b64_tr_b16 v[80:81], v236 offset:2048
    v_mfma_f32_16x16x32_bf16 v[16:19], a[168:171], a[40:43], v[16:19]
    s_waitcnt lgkmcnt(15)
    buffer_load_dwordx4 v246, s[24:27], s43 offen offset:1024  lds
    v_mfma_f32_16x16x32_bf16 v[16:19], a[172:175], a[44:47], v[16:19]
    s_add_u32 s43, s63, 227328
    ds_read_b64_tr_b16 v[82:83], v236 offset:3072
    ds_read_b64_tr_b16 v[84:85], v228 offset:0
    v_mfma_f32_16x16x32_bf16 v[48:51], a[172:175], a[60:63], v[48:51]
    ds_read_b64_tr_b16 v[86:87], v228 offset:1024
    ds_read_b64_tr_b16 v[88:89], v228 offset:2048
    v_mfma_f32_16x16x32_bf16 v[48:51], a[168:171], a[56:59], v[48:51]
    buffer_load_dwordx4 v246, s[24:27], s43 offen offset:2048  lds
    v_mfma_f32_16x16x32_bf16 v[48:51], a[164:167], a[52:55], v[48:51]
    s_add_u32 s43, s63, 242688
    ds_read_b64_tr_b16 v[90:91], v228 offset:3072
    ds_read_b64_tr_b16 v[92:93], v237 offset:0
    v_mfma_f32_16x16x32_bf16 v[48:51], a[160:163], a[48:51], v[48:51]
    ds_read_b64_tr_b16 v[94:95], v237 offset:1024
    ds_read_b64_tr_b16 v[96:97], v237 offset:2048
    v_mfma_f32_16x16x32_bf16 v[20:23], a[128:131], a[32:35], v[20:23]
    buffer_load_dwordx4 v246, s[24:27], s43 offen offset:3072  lds
    v_mfma_f32_16x16x32_bf16 v[20:23], a[132:135], a[36:39], v[20:23]
    s_waitcnt lgkmcnt(15)
    ds_read_b64_tr_b16 v[98:99], v237 offset:3072
    ds_read_b64_tr_b16 v[100:101], v229 offset:0
    v_mfma_f32_16x16x32_bf16 v[20:23], a[136:139], a[40:43], v[20:23]
    s_add_u32 s97, s67, 36864
    ds_read_b64_tr_b16 v[102:103], v229 offset:1024
    v_mfma_f32_16x16x32_bf16 v[20:23], a[140:143], a[44:47], v[20:23]
    ds_read_b64_tr_b16 v[104:105], v229 offset:2048
    ds_read_b64_tr_b16 v[106:107], v229 offset:3072
    v_mfma_f32_16x16x32_bf16 v[52:55], a[140:143], a[60:63], v[52:55]
    buffer_load_dwordx4 a[112:115], v247, s[28:31], s97 offen offset:0 sc1
    v_mfma_f32_16x16x32_bf16 v[52:55], a[136:139], a[56:59], v[52:55]
    v_bfe_u32 v193, v247, 9, 1
    v_lshl_add_u32 v185, v193, 4, v185
    v_mfma_f32_16x16x32_bf16 v[52:55], a[132:135], a[52:55], v[52:55]
    v_mov_b32 v194, 0
    v_lshrrev_b32 v192, 2, v192
    v_mfma_f32_16x16x32_bf16 v[52:55], a[128:131], a[48:51], v[52:55]
    s_waitcnt vmcnt(18) lgkmcnt(0)
    s_barrier
    ds_read_b64_tr_b16 a[160:161], v230 offset:49152
    v_mfma_f32_16x16x32_bf16 v[24:27], a[144:147], a[32:35], v[24:27]
    buffer_load_dwordx4 a[116:119], v247, s[28:31], s97 offen offset:1024 sc1
    ds_read_b64_tr_b16 a[162:163], v230 offset:50176
    v_mfma_f32_16x16x32_bf16 v[24:27], a[148:151], a[36:39], v[24:27]
    ds_read_b64_tr_b16 a[164:165], v230 offset:51200
    ds_read_b64_tr_b16 a[166:167], v230 offset:52224
    v_mfma_f32_16x16x32_bf16 v[24:27], a[152:155], a[40:43], v[24:27]
    ds_read_b64_tr_b16 a[168:169], v222 offset:49152
    ds_read_b64_tr_b16 a[170:171], v222 offset:50176
    v_mfma_f32_16x16x32_bf16 v[24:27], a[156:159], a[44:47], v[24:27]
    buffer_load_dwordx4 a[120:123], v247, s[28:31], s97 offen offset:2048 sc1
    v_mfma_f32_16x16x32_bf16 v[56:59], a[156:159], a[60:63], v[56:59]
    ds_read_b64_tr_b16 a[172:173], v222 offset:51200
    ds_read_b64_tr_b16 a[174:175], v222 offset:52224
    v_mfma_f32_16x16x32_bf16 v[56:59], a[152:155], a[56:59], v[56:59]
    ds_read_b128 a[224:227], v242 offset:8192
    v_lshrrev_b32 v193, 8, v247
    v_mfma_f32_16x16x32_bf16 v[56:59], a[148:151], a[52:55], v[56:59]
    buffer_load_dwordx4 a[124:127], v247, s[28:31], s97 offen offset:3072 sc1
    ds_read_b128 a[228:231], v242 offset:9216
    v_mfma_f32_16x16x32_bf16 v[56:59], a[144:147], a[48:51], v[56:59]
    s_waitcnt vmcnt(20) lgkmcnt(8)
    ds_read_b128 a[232:235], v242 offset:10240
    ds_read_b64_tr_b16 a[128:129], v231 offset:49152
    v_mfma_f32_16x16x32_bf16 v[4:7], a[160:163], a[80:83], v[4:7]
    s_waitcnt vmcnt(19) lgkmcnt(8)
    ds_read_b128 a[236:239], v242 offset:11264
    ds_read_b64_tr_b16 a[130:131], v231 offset:50176
    v_mfma_f32_16x16x32_bf16 v[4:7], a[164:167], a[84:87], v[4:7]
    s_waitcnt vmcnt(18) lgkmcnt(8)
    s_add_u32 s97, s67, 40960
    ds_read_b64_tr_b16 a[132:133], v231 offset:51200
    v_mfma_f32_16x16x32_bf16 v[4:7], a[168:171], a[88:91], v[4:7]
    s_waitcnt vmcnt(17) lgkmcnt(7)
    buffer_load_dwordx4 a[216:219], v247, s[28:31], s97 offen offset:2048 sc1
    v_mfma_f32_16x16x32_bf16 v[4:7], a[172:175], a[92:95], v[4:7]
    s_waitcnt vmcnt(14)
    ds_read_b64_tr_b16 a[134:135], v231 offset:52224
    ds_read_b64_tr_b16 a[136:137], v223 offset:49152
    v_mfma_f32_16x16x32_bf16 v[36:39], a[172:175], a[108:111], v[36:39]
    buffer_load_dwordx4 a[220:223], v247, s[28:31], s97 offen offset:3072 sc1
    ds_read_b64_tr_b16 a[138:139], v223 offset:50176
    v_mfma_f32_16x16x32_bf16 v[36:39], a[168:171], a[104:107], v[36:39]
    buffer_load_dwordx4 a[212:215], v247, s[28:31], s97 offen offset:1024 sc1
    ds_read_b64_tr_b16 a[140:141], v223 offset:51200
    v_mfma_f32_16x16x32_bf16 v[36:39], a[164:167], a[100:103], v[36:39]
    buffer_load_dwordx4 a[208:211], v247, s[28:31], s97 offen offset:0 sc1
    ds_read_b64_tr_b16 a[142:143], v223 offset:52224
    v_mfma_f32_16x16x32_bf16 v[36:39], a[160:163], a[96:99], v[36:39]
    s_waitcnt lgkmcnt(11)
    ds_read_b64_tr_b16 a[144:145], v232 offset:49152
    ds_read_b64_tr_b16 a[146:147], v232 offset:50176
    v_mfma_f32_16x16x32_bf16 v[68:71], a[160:163], a[224:227], v[68:71]
    s_waitcnt lgkmcnt(12)
    ds_read_b64_tr_b16 a[148:149], v232 offset:51200
    ds_read_b64_tr_b16 a[150:151], v232 offset:52224
    v_mfma_f32_16x16x32_bf16 v[68:71], a[164:167], a[228:231], v[68:71]
    s_waitcnt lgkmcnt(13)
    ds_read_b64_tr_b16 a[152:153], v224 offset:49152
    v_and_b32 v195, 16, v247
    v_mfma_f32_16x16x32_bf16 v[68:71], a[168:171], a[232:235], v[68:71]
    s_waitcnt lgkmcnt(12)
    ds_read_b64_tr_b16 a[154:155], v224 offset:50176
    v_mov_b32 v196, 0x3f80
    v_mfma_f32_16x16x32_bf16 v[68:71], a[172:175], a[236:239], v[68:71]
    s_waitcnt lgkmcnt(12)
    ds_read_b64_tr_b16 a[156:157], v224 offset:51200
    ds_read_b64_tr_b16 a[158:159], v224 offset:52224
    v_mfma_f32_16x16x32_bf16 v[8:11], a[128:131], a[80:83], v[8:11]
    s_waitcnt lgkmcnt(12)
    ds_read_b64_tr_b16 a[160:161], v233 offset:49152
    v_lshlrev_b32 v195, v195, v196
    v_mfma_f32_16x16x32_bf16 v[8:11], a[132:135], a[84:87], v[8:11]
    s_waitcnt lgkmcnt(11)
    ds_read_b64_tr_b16 a[162:163], v233 offset:50176
    v_accvgpr_write_b32 a66, 0
    v_mfma_f32_16x16x32_bf16 v[8:11], a[136:139], a[88:91], v[8:11]
    s_waitcnt lgkmcnt(10)
    ds_read_b64_tr_b16 a[164:165], v233 offset:51200
    v_accvgpr_write_b32 a67, 0
    v_mfma_f32_16x16x32_bf16 v[8:11], a[140:143], a[92:95], v[8:11]
    ds_read_b64_tr_b16 a[166:167], v233 offset:52224
    ds_read_b64_tr_b16 a[168:169], v225 offset:49152
    v_mfma_f32_16x16x32_bf16 v[40:43], a[140:143], a[108:111], v[40:43]
    ds_read_b64_tr_b16 a[170:171], v225 offset:50176
    v_accvgpr_write_b32 a68, 0
    v_mfma_f32_16x16x32_bf16 v[40:43], a[136:139], a[104:107], v[40:43]
    ds_read_b64_tr_b16 a[172:173], v225 offset:51200
    v_accvgpr_write_b32 a69, 0
    v_mfma_f32_16x16x32_bf16 v[40:43], a[132:135], a[100:103], v[40:43]
    ds_read_b64_tr_b16 a[174:175], v225 offset:52224
    v_mfma_f32_16x16x32_bf16 v[40:43], a[128:131], a[96:99], v[40:43]
    v_cmp_ne_u32 vcc, 0, v191
    s_nop 1
    v_cndmask_b32 v184, v189, v190, vcc
    v_mfma_f32_16x16x32_bf16 v[72:75], a[128:131], a[224:227], v[72:75]
    ds_read_b64_tr_b16 a[128:129], v234 offset:49152
    ds_read_b64_tr_b16 a[130:131], v234 offset:50176
    v_mfma_f32_16x16x32_bf16 v[72:75], a[132:135], a[228:231], v[72:75]
    ds_read_b64_tr_b16 a[132:133], v234 offset:51200
    ds_read_b64_tr_b16 a[134:135], v234 offset:52224
    v_mfma_f32_16x16x32_bf16 v[72:75], a[136:139], a[232:235], v[72:75]
    ds_read_b64_tr_b16 a[136:137], v226 offset:49152
    ds_read_b64_tr_b16 a[138:139], v226 offset:50176
    v_mfma_f32_16x16x32_bf16 v[72:75], a[140:143], a[236:239], v[72:75]
    s_waitcnt lgkmcnt(15)
    ds_read_b64_tr_b16 a[140:141], v226 offset:51200
    ds_read_b64_tr_b16 a[142:143], v226 offset:52224
    v_mfma_f32_16x16x32_bf16 v[12:15], a[144:147], a[80:83], v[12:15]
    v_cmp_eq_u32 vcc, v192, v193
    s_nop 1
    v_cndmask_b32 v195, v194, v195, vcc
    v_mfma_f32_16x16x32_bf16 v[12:15], a[148:151], a[84:87], v[12:15]
    v_cmp_gt_u32 vcc, 2, v188
    s_nop 1
    v_cndmask_b32 v196, v194, v195, vcc
    v_cndmask_b32 v195, v195, v194, vcc
    v_mfma_f32_16x16x32_bf16 v[12:15], a[152:155], a[88:91], v[12:15]
    s_waitcnt lgkmcnt(15)
    ds_read_b64_tr_b16 a[0:1], v236 offset:49152
    v_accvgpr_write_b32 a64, v196
    v_mfma_f32_16x16x32_bf16 v[12:15], a[156:159], a[92:95], v[12:15]
    ds_read_b64_tr_b16 a[2:3], v236 offset:50176
    v_accvgpr_write_b32 a65, v195
    v_mfma_f32_16x16x32_bf16 v[44:47], a[156:159], a[108:111], v[44:47]
    ds_read_b64_tr_b16 a[156:157], v227 offset:51200
    v_accvgpr_write_b32 a70, v196
    v_mfma_f32_16x16x32_bf16 v[44:47], a[152:155], a[104:107], v[44:47]
    ds_read_b64_tr_b16 a[152:153], v227 offset:49152
    ds_read_b64_tr_b16 a[154:155], v227 offset:50176
    v_mfma_f32_16x16x32_bf16 v[44:47], a[148:151], a[100:103], v[44:47]
    ds_read_b64_tr_b16 a[148:149], v235 offset:51200
    ds_read_b64_tr_b16 a[150:151], v235 offset:52224
    v_mfma_f32_16x16x32_bf16 v[44:47], a[144:147], a[96:99], v[44:47]
    s_waitcnt lgkmcnt(15)
    ds_read_b64_tr_b16 a[144:145], v235 offset:49152
    ds_read_b64_tr_b16 a[146:147], v235 offset:50176
    v_mfma_f32_16x16x32_bf16 v[16:19], a[160:163], a[80:83], v[16:19]
    ds_read_b64_tr_b16 a[158:159], v227 offset:52224
    v_accvgpr_write_b32 a71, v195
    v_mfma_f32_16x16x32_bf16 v[16:19], a[164:167], a[84:87], v[16:19]
    ds_read_b64_tr_b16 a[4:5], v236 offset:51200
    ds_read_b64_tr_b16 a[6:7], v236 offset:52224
    v_mfma_f32_16x16x32_bf16 v[16:19], a[168:171], a[88:91], v[16:19]
    ds_read_b64_tr_b16 a[8:9], v228 offset:49152
    ds_read_b64_tr_b16 a[10:11], v228 offset:50176
    v_mfma_f32_16x16x32_bf16 v[16:19], a[172:175], a[92:95], v[16:19]
    ds_read_b64_tr_b16 a[12:13], v228 offset:51200
    ds_read_b64_tr_b16 a[14:15], v228 offset:52224
    v_mfma_f32_16x16x32_bf16 v[48:51], a[172:175], a[108:111], v[48:51]
    ds_read_b64_tr_b16 a[16:17], v237 offset:49152
    v_mfma_f32_16x16x32_bf16 v[48:51], a[168:171], a[104:107], v[48:51]
    ds_read_b64_tr_b16 a[18:19], v237 offset:50176
    ds_read_b64_tr_b16 a[20:21], v237 offset:51200
    v_mfma_f32_16x16x32_bf16 v[48:51], a[164:167], a[100:103], v[48:51]
    ds_read_b64_tr_b16 a[22:23], v237 offset:52224
    v_mfma_f32_16x16x32_bf16 v[48:51], a[160:163], a[96:99], v[48:51]
    s_waitcnt lgkmcnt(15)
    ds_read_b64_tr_b16 a[24:25], v229 offset:49152
    v_mfma_f32_16x16x32_bf16 v[20:23], a[128:131], a[80:83], v[20:23]
    ds_read_b64_tr_b16 a[26:27], v229 offset:50176
    v_mfma_f32_16x16x32_bf16 v[20:23], a[132:135], a[84:87], v[20:23]
    ds_read_b64_tr_b16 a[28:29], v229 offset:51200
    ds_read_b64_tr_b16 a[30:31], v229 offset:52224
    v_mfma_f32_16x16x32_bf16 v[20:23], a[136:139], a[88:91], v[20:23]
    v_mfma_f32_16x16x32_bf16 v[20:23], a[140:143], a[92:95], v[20:23]
    v_mfma_f32_16x16x32_bf16 v[52:55], a[140:143], a[108:111], v[52:55]
    v_mfma_f32_16x16x32_bf16 v[52:55], a[136:139], a[104:107], v[52:55]
    v_mfma_f32_16x16x32_bf16 v[52:55], a[132:135], a[100:103], v[52:55]
    v_mfma_f32_16x16x32_bf16 v[52:55], a[128:131], a[96:99], v[52:55]
    s_waitcnt vmcnt(8) lgkmcnt(0)
    s_barrier
    v_mfma_f32_16x16x32_bf16 v[24:27], a[144:147], a[80:83], v[24:27]
    ds_read_b64_tr_b16 a[160:161], v230 offset:32768
    ds_read_b64_tr_b16 a[162:163], v230 offset:33792
    v_mfma_f32_16x16x32_bf16 v[24:27], a[148:151], a[84:87], v[24:27]
    ds_read_b64_tr_b16 a[164:165], v230 offset:34816
    ds_read_b64_tr_b16 a[166:167], v230 offset:35840
    v_mfma_f32_16x16x32_bf16 v[24:27], a[152:155], a[88:91], v[24:27]
    ds_read_b64_tr_b16 a[168:169], v222 offset:32768
    ds_read_b64_tr_b16 a[170:171], v222 offset:33792
    v_mfma_f32_16x16x32_bf16 v[24:27], a[156:159], a[92:95], v[24:27]
    ds_read_b64_tr_b16 a[172:173], v222 offset:34816
    ds_read_b64_tr_b16 a[174:175], v222 offset:35840
    v_mfma_f32_16x16x32_bf16 v[56:59], a[156:159], a[108:111], v[56:59]
    ds_read_b128 a[224:227], v242 offset:12288
    v_mfma_f32_16x16x32_bf16 v[56:59], a[152:155], a[104:107], v[56:59]
    ds_read_b128 a[228:231], v242 offset:13312
    v_mfma_f32_16x16x32_bf16 v[56:59], a[148:151], a[100:103], v[56:59]
    ds_read_b128 a[232:235], v242 offset:14336
    v_mfma_f32_16x16x32_bf16 v[56:59], a[144:147], a[96:99], v[56:59]
    s_waitcnt vmcnt(7) lgkmcnt(9)
    ds_read_b128 a[236:239], v242 offset:15360
    v_mfma_f32_16x16x32_bf16 v[4:7], a[160:163], a[112:115], v[4:7]
    s_waitcnt vmcnt(6) lgkmcnt(8)
    ds_read_b64_tr_b16 a[128:129], v231 offset:32768
    v_mfma_f32_16x16x32_bf16 v[4:7], a[164:167], a[116:119], v[4:7]
    s_waitcnt vmcnt(5) lgkmcnt(7)
    ds_read_b64_tr_b16 a[130:131], v231 offset:33792
    v_mfma_f32_16x16x32_bf16 v[4:7], a[168:171], a[120:123], v[4:7]
    s_waitcnt vmcnt(4) lgkmcnt(6)
    ds_read_b64_tr_b16 a[132:133], v231 offset:34816
    v_mfma_f32_16x16x32_bf16 v[4:7], a[172:175], a[124:127], v[4:7]
    s_waitcnt vmcnt(2)
    ds_read_b64_tr_b16 a[134:135], v231 offset:35840
    v_mfma_f32_16x16x32_bf16 v[36:39], a[172:175], a[220:223], v[36:39]
    ds_read_b64_tr_b16 a[136:137], v223 offset:32768
    v_mfma_f32_16x16x32_bf16 v[36:39], a[168:171], a[216:219], v[36:39]
    s_waitcnt vmcnt(1)
    ds_read_b64_tr_b16 a[138:139], v223 offset:33792
    v_mfma_f32_16x16x32_bf16 v[36:39], a[164:167], a[212:215], v[36:39]
    s_waitcnt vmcnt(0)
    ds_read_b64_tr_b16 a[140:141], v223 offset:34816
    ds_read_b64_tr_b16 a[142:143], v223 offset:35840
    v_mfma_f32_16x16x32_bf16 v[36:39], a[160:163], a[208:211], v[36:39]
    s_waitcnt lgkmcnt(11)
    v_cvt_pk_bf16_f32 v4, v4, v5
    v_cvt_pk_bf16_f32 v5, v6, v7
    v_mfma_f32_16x16x32_bf16 v[68:71], a[160:163], a[224:227], v[68:71]
    s_waitcnt lgkmcnt(10)
    v_mfma_f32_16x16x32_bf16 v[68:71], a[164:167], a[228:231], v[68:71]
    s_waitcnt lgkmcnt(9)
    v_mfma_f32_16x16x32_bf16 v[68:71], a[168:171], a[232:235], v[68:71]
    s_waitcnt lgkmcnt(8)
    ds_read_b64_tr_b16 a[144:145], v232 offset:32768
    v_mfma_f32_16x16x32_bf16 v[68:71], a[172:175], a[236:239], v[68:71]
    s_waitcnt lgkmcnt(7)
    ds_read_b64_tr_b16 a[146:147], v232 offset:33792
    v_cvt_pk_bf16_f32 v36, v36, v37
    v_mfma_f32_16x16x32_bf16 v[8:11], a[128:131], a[112:115], v[8:11]
    s_waitcnt lgkmcnt(6)
    ds_read_b64_tr_b16 a[148:149], v232 offset:34816
    v_cvt_pk_bf16_f32 v37, v38, v39
    v_mfma_f32_16x16x32_bf16 v[8:11], a[132:135], a[116:119], v[8:11]
    s_waitcnt lgkmcnt(5)
    ds_read_b64_tr_b16 a[150:151], v232 offset:35840
    v_mfma_f32_16x16x32_bf16 v[8:11], a[136:139], a[120:123], v[8:11]
    s_waitcnt lgkmcnt(4)
    ds_read_b64_tr_b16 a[152:153], v224 offset:32768
    v_mfma_f32_16x16x32_bf16 v[8:11], a[140:143], a[124:127], v[8:11]
    ds_read_b64_tr_b16 a[154:155], v224 offset:33792
    v_cvt_pk_bf16_f32 v248, v68, v69
    v_mfma_f32_16x16x32_bf16 v[40:43], a[140:143], a[220:223], v[40:43]
    ds_read_b64_tr_b16 a[156:157], v224 offset:34816
    v_cvt_pk_bf16_f32 v249, v70, v71
    v_mfma_f32_16x16x32_bf16 v[40:43], a[136:139], a[216:219], v[40:43]
    ds_read_b64_tr_b16 a[158:159], v224 offset:35840
    v_mfma_f32_16x16x32_bf16 v[40:43], a[132:135], a[212:215], v[40:43]
    ds_read_b64_tr_b16 a[160:161], v233 offset:32768
    v_mfma_f32_16x16x32_bf16 v[40:43], a[128:131], a[208:211], v[40:43]
    ds_read_b64_tr_b16 a[162:163], v233 offset:33792
    v_cvt_pk_bf16_f32 v6, v8, v9
    v_mfma_f32_16x16x32_bf16 v[72:75], a[128:131], a[224:227], v[72:75]
    ds_read_b64_tr_b16 a[164:165], v233 offset:34816
    v_cvt_pk_bf16_f32 v7, v10, v11
    v_mfma_f32_16x16x32_bf16 v[72:75], a[132:135], a[228:231], v[72:75]
    buffer_store_dwordx4 v[4:7], v247, s[28:31], s68 offen offset:0 sc1
    v_mfma_f32_16x16x32_bf16 v[72:75], a[136:139], a[232:235], v[72:75]
    ds_read_b64_tr_b16 a[166:167], v233 offset:35840
    v_mfma_f32_16x16x32_bf16 v[72:75], a[140:143], a[236:239], v[72:75]
    s_waitcnt lgkmcnt(10)
    ds_read_b64_tr_b16 a[168:169], v225 offset:32768
    v_cvt_pk_bf16_f32 v38, v40, v41
    v_mfma_f32_16x16x32_bf16 v[12:15], a[144:147], a[112:115], v[12:15]
    s_waitcnt lgkmcnt(9)
    ds_read_b64_tr_b16 a[170:171], v225 offset:33792
    v_cvt_pk_bf16_f32 v39, v42, v43
    v_mfma_f32_16x16x32_bf16 v[12:15], a[148:151], a[116:119], v[12:15]
    s_waitcnt lgkmcnt(8)
    buffer_store_dwordx4 v[36:39], v247, s[28:31], s68 offen offset:1024 sc1
    v_mfma_f32_16x16x32_bf16 v[12:15], a[152:155], a[120:123], v[12:15]
    s_waitcnt lgkmcnt(6)
    ds_read_b64_tr_b16 a[172:173], v225 offset:34816
    ds_read_b64_tr_b16 a[174:175], v225 offset:35840
    v_mfma_f32_16x16x32_bf16 v[12:15], a[156:159], a[124:127], v[12:15]
    ds_read_b64_tr_b16 a[128:129], v234 offset:32768
    v_cvt_pk_bf16_f32 v250, v72, v73
    v_mfma_f32_16x16x32_bf16 v[44:47], a[156:159], a[220:223], v[44:47]
    ds_read_b64_tr_b16 a[130:131], v234 offset:33792
    v_cvt_pk_bf16_f32 v251, v74, v75
    v_mfma_f32_16x16x32_bf16 v[44:47], a[152:155], a[216:219], v[44:47]
    buffer_store_dwordx4 v[248:251], v247, s[28:31], s72 offen offset:0 sc1
    v_mfma_f32_16x16x32_bf16 v[44:47], a[148:151], a[212:215], v[44:47]
    ds_read_b64_tr_b16 a[132:133], v234 offset:34816
    v_mfma_f32_16x16x32_bf16 v[44:47], a[144:147], a[208:211], v[44:47]
    s_waitcnt lgkmcnt(9)
    ds_read_b64_tr_b16 a[134:135], v234 offset:35840
    v_cvt_pk_bf16_f32 v12, v12, v13
    v_mfma_f32_16x16x32_bf16 v[16:19], a[160:163], a[112:115], v[16:19]
    s_waitcnt lgkmcnt(8)
    ds_read_b64_tr_b16 a[136:137], v226 offset:32768
    v_cvt_pk_bf16_f32 v13, v14, v15
    v_mfma_f32_16x16x32_bf16 v[16:19], a[164:167], a[116:119], v[16:19]
    s_waitcnt lgkmcnt(7)
    ds_read_b64_tr_b16 a[138:139], v226 offset:33792
    v_mfma_f32_16x16x32_bf16 v[16:19], a[168:171], a[120:123], v[16:19]
    s_waitcnt lgkmcnt(6)
    ds_read_b64_tr_b16 a[140:141], v226 offset:34816
    ds_read_b64_tr_b16 a[142:143], v226 offset:35840
    v_mfma_f32_16x16x32_bf16 v[16:19], a[172:175], a[124:127], v[16:19]
    ds_read_b64_tr_b16 a[144:145], v235 offset:32768
    v_cvt_pk_bf16_f32 v44, v44, v45
    v_mfma_f32_16x16x32_bf16 v[48:51], a[172:175], a[220:223], v[48:51]
    ds_read_b64_tr_b16 a[146:147], v235 offset:33792
    v_cvt_pk_bf16_f32 v45, v46, v47
    v_mfma_f32_16x16x32_bf16 v[48:51], a[168:171], a[216:219], v[48:51]
    ds_read_b64_tr_b16 a[148:149], v235 offset:34816
    v_mfma_f32_16x16x32_bf16 v[48:51], a[164:167], a[212:215], v[48:51]
    ds_read_b64_tr_b16 a[150:151], v235 offset:35840
    v_mfma_f32_16x16x32_bf16 v[48:51], a[160:163], a[208:211], v[48:51]
    s_waitcnt lgkmcnt(10)
    ds_read_b64_tr_b16 a[152:153], v227 offset:32768
    v_cvt_pk_bf16_f32 v14, v16, v17
    v_mfma_f32_16x16x32_bf16 v[20:23], a[128:131], a[112:115], v[20:23]
    s_waitcnt lgkmcnt(9)
    ds_read_b64_tr_b16 a[154:155], v227 offset:33792
    v_cvt_pk_bf16_f32 v15, v18, v19
    v_mfma_f32_16x16x32_bf16 v[20:23], a[132:135], a[116:119], v[20:23]
    s_waitcnt lgkmcnt(8)
    buffer_store_dwordx4 v[12:15], v247, s[28:31], s69 offen offset:0 sc1
    v_mfma_f32_16x16x32_bf16 v[20:23], a[136:139], a[120:123], v[20:23]
    s_waitcnt lgkmcnt(6)
    ds_read_b64_tr_b16 a[156:157], v227 offset:34816
    ds_read_b64_tr_b16 a[158:159], v227 offset:35840
    v_mfma_f32_16x16x32_bf16 v[20:23], a[140:143], a[124:127], v[20:23]
    v_cvt_pk_bf16_f32 v46, v48, v49
    v_cvt_pk_bf16_f32 v47, v50, v51
    v_mfma_f32_16x16x32_bf16 v[52:55], a[140:143], a[220:223], v[52:55]
    buffer_store_dwordx4 v[44:47], v247, s[28:31], s69 offen offset:1024 sc1
    v_mfma_f32_16x16x32_bf16 v[52:55], a[136:139], a[216:219], v[52:55]
    v_mfma_f32_16x16x32_bf16 v[52:55], a[132:135], a[212:215], v[52:55]
    v_mfma_f32_16x16x32_bf16 v[52:55], a[128:131], a[208:211], v[52:55]
    s_waitcnt lgkmcnt(6)
    v_cvt_pk_bf16_f32 v20, v20, v21
    v_cvt_pk_bf16_f32 v21, v22, v23
    v_mfma_f32_16x16x32_bf16 v[24:27], a[144:147], a[112:115], v[24:27]
    s_waitcnt lgkmcnt(4)
    v_mfma_f32_16x16x32_bf16 v[24:27], a[148:151], a[116:119], v[24:27]
    s_waitcnt lgkmcnt(2)
    v_mfma_f32_16x16x32_bf16 v[24:27], a[152:155], a[120:123], v[24:27]
    s_waitcnt lgkmcnt(0)
    v_mfma_f32_16x16x32_bf16 v[24:27], a[156:159], a[124:127], v[24:27]
    v_cvt_pk_bf16_f32 v52, v52, v53
    v_cvt_pk_bf16_f32 v53, v54, v55
    v_mfma_f32_16x16x32_bf16 v[56:59], a[156:159], a[220:223], v[56:59]
    v_mfma_f32_16x16x32_bf16 v[56:59], a[152:155], a[216:219], v[56:59]
L_pad13:
    s_cbranch_execz L_back3
    v_mfma_f32_16x16x32_bf16 v[56:59], a[148:151], a[212:215], v[56:59]
    v_mfma_f32_16x16x32_bf16 v[56:59], a[144:147], a[208:211], v[56:59]
    s_nop 1
    v_cvt_pk_bf16_f32 v22, v24, v25
    v_cvt_pk_bf16_f32 v23, v26, v27
    v_mfma_f32_16x16x32_bf16 v[28:31], v[76:79], a[32:35], v[28:31]
    buffer_store_dwordx4 v[20:23], v247, s[28:31], s70 offen offset:0 sc1
    v_mfma_f32_16x16x32_bf16 v[28:31], v[80:83], a[36:39], v[28:31]
    v_mfma_f32_16x16x32_bf16 v[28:31], v[84:87], a[40:43], v[28:31]
    v_mfma_f32_16x16x32_bf16 v[28:31], v[88:91], a[44:47], v[28:31]
    v_cvt_pk_bf16_f32 v54, v56, v57
    v_cvt_pk_bf16_f32 v55, v58, v59
    v_mfma_f32_16x16x32_bf16 v[28:31], a[0:3], a[80:83], v[28:31]
    buffer_store_dwordx4 v[52:55], v247, s[28:31], s70 offen offset:1024 sc1
    v_mfma_f32_16x16x32_bf16 v[28:31], a[4:7], a[84:87], v[28:31]
    v_mfma_f32_16x16x32_bf16 v[28:31], a[8:11], a[88:91], v[28:31]
    v_mfma_f32_16x16x32_bf16 v[28:31], a[12:15], a[92:95], v[28:31]
    v_mfma_f32_16x16x32_bf16 v[60:63], a[12:15], a[108:111], v[60:63]
    v_mfma_f32_16x16x32_bf16 v[60:63], a[8:11], a[104:107], v[60:63]
    v_mfma_f32_16x16x32_bf16 v[60:63], a[4:7], a[100:103], v[60:63]
    v_mfma_f32_16x16x32_bf16 v[60:63], a[0:3], a[96:99], v[60:63]
    v_mfma_f32_16x16x32_bf16 v[60:63], v[88:91], a[60:63], v[60:63]
    v_mfma_f32_16x16x32_bf16 v[60:63], v[84:87], a[56:59], v[60:63]
    v_mfma_f32_16x16x32_bf16 v[60:63], v[80:83], a[52:55], v[60:63]
    v_mfma_f32_16x16x32_bf16 v[60:63], v[76:79], a[48:51], v[60:63]
    v_mfma_f32_16x16x32_bf16 v[32:35], v[92:95], a[32:35], v[32:35]
    v_mfma_f32_16x16x32_bf16 v[32:35], v[96:99], a[36:39], v[32:35]
    v_mfma_f32_16x16x32_bf16 v[32:35], v[100:103], a[40:43], v[32:35]
    ds_read_b64_tr_b16 a[160:161], v236 offset:32768
    v_mfma_f32_16x16x32_bf16 v[32:35], v[104:107], a[44:47], v[32:35]
    ds_read_b64_tr_b16 a[162:163], v236 offset:33792
    v_mfma_f32_16x16x32_bf16 v[32:35], a[16:19], a[80:83], v[32:35]
    ds_read_b64_tr_b16 a[164:165], v236 offset:34816
    v_mfma_f32_16x16x32_bf16 v[32:35], a[20:23], a[84:87], v[32:35]
    ds_read_b64_tr_b16 a[166:167], v236 offset:35840
    v_mfma_f32_16x16x32_bf16 v[32:35], a[24:27], a[88:91], v[32:35]
    ds_read_b64_tr_b16 a[168:169], v228 offset:32768
    v_mfma_f32_16x16x32_bf16 v[32:35], a[28:31], a[92:95], v[32:35]
    s_waitcnt vmcnt(0)
    buffer_store_dword v0, v253, s[28:31], s47 offen offset:8 sc1
    v_mfma_f32_16x16x32_bf16 v[64:67], a[28:31], a[108:111], v[64:67]
    ds_read_b64_tr_b16 a[170:171], v228 offset:33792
    v_mfma_f32_16x16x32_bf16 v[64:67], a[24:27], a[104:107], v[64:67]
    ds_read_b64_tr_b16 a[172:173], v228 offset:34816
    v_mfma_f32_16x16x32_bf16 v[64:67], a[20:23], a[100:103], v[64:67]
    ds_read_b64_tr_b16 a[174:175], v228 offset:35840
    v_mfma_f32_16x16x32_bf16 v[64:67], a[16:19], a[96:99], v[64:67]
    ds_read_b64_tr_b16 a[128:129], v237 offset:32768
    v_mfma_f32_16x16x32_bf16 v[64:67], v[104:107], a[60:63], v[64:67]
    ds_read_b64_tr_b16 a[130:131], v237 offset:33792
    v_mfma_f32_16x16x32_bf16 v[64:67], v[100:103], a[56:59], v[64:67]
    ds_read_b64_tr_b16 a[132:133], v237 offset:34816
    v_mfma_f32_16x16x32_bf16 v[64:67], v[96:99], a[52:55], v[64:67]
    ds_read_b64_tr_b16 a[134:135], v237 offset:35840
    v_mfma_f32_16x16x32_bf16 v[64:67], v[92:95], a[48:51], v[64:67]
    s_waitcnt lgkmcnt(10)
    ds_read_b64_tr_b16 a[136:137], v229 offset:32768
    v_mfma_f32_16x16x32_bf16 v[28:31], a[160:163], a[112:115], v[28:31]
    s_waitcnt lgkmcnt(9)
    ds_read_b64_tr_b16 a[138:139], v229 offset:33792
    v_mfma_f32_16x16x32_bf16 v[28:31], a[164:167], a[116:119], v[28:31]
    s_waitcnt lgkmcnt(8)
    ds_read_b64_tr_b16 a[140:141], v229 offset:34816
    v_mfma_f32_16x16x32_bf16 v[28:31], a[168:171], a[120:123], v[28:31]
    s_waitcnt lgkmcnt(7)
    ds_read_b64_tr_b16 a[142:143], v229 offset:35840
    v_mfma_f32_16x16x32_bf16 v[28:31], a[172:175], a[124:127], v[28:31]
    v_mfma_f32_16x16x32_bf16 v[60:63], a[172:175], a[220:223], v[60:63]
    v_mfma_f32_16x16x32_bf16 v[60:63], a[168:171], a[216:219], v[60:63]
    v_mfma_f32_16x16x32_bf16 v[60:63], a[164:167], a[212:215], v[60:63]
    v_mfma_f32_16x16x32_bf16 v[60:63], a[160:163], a[208:211], v[60:63]
    s_waitcnt lgkmcnt(6)
    buffer_load_dword v254, v184, s[28:31], 0 offen offset:8 sc1
    v_mfma_f32_16x16x32_bf16 v[32:35], a[128:131], a[112:115], v[32:35]
    s_waitcnt lgkmcnt(4)
    v_mfma_f32_16x16x32_bf16 v[32:35], a[132:135], a[116:119], v[32:35]
    s_waitcnt lgkmcnt(2)
    v_mfma_f32_16x16x32_bf16 v[32:35], a[136:139], a[120:123], v[32:35]
    s_waitcnt lgkmcnt(0)
    v_mfma_f32_16x16x32_bf16 v[32:35], a[140:143], a[124:127], v[32:35]
    v_mfma_f32_16x16x32_bf16 v[64:67], a[140:143], a[220:223], v[64:67]
    v_mfma_f32_16x16x32_bf16 v[64:67], a[136:139], a[216:219], v[64:67]
    v_mfma_f32_16x16x32_bf16 v[64:67], a[132:135], a[212:215], v[64:67]
    v_mfma_f32_16x16x32_bf16 v[64:67], a[128:131], a[208:211], v[64:67]
    s_waitcnt vmcnt(0)
    v_cmp_ne_u32 vcc, 1, v254
    s_cbranch_vccnz L_spin_pp
L_ret_pp:
    buffer_load_dwordx4 a[128:131], v247, s[28:31], s71 offen offset:0 sc1
    buffer_load_dwordx4 a[132:135], v247, s[28:31], s71 offen offset:1024 sc1
    buffer_load_dwordx4 a[136:139], v247, s[28:31], s71 offen offset:2048 sc1
    buffer_load_dwordx4 a[140:143], v247, s[28:31], s71 offen offset:3072 sc1
    s_add_u32 s71, s71, 4096
    buffer_load_dwordx4 a[144:147], v247, s[28:31], s71 offen offset:0 sc1
    buffer_load_dwordx4 a[148:151], v247, s[28:31], s71 offen offset:1024 sc1
    buffer_load_dwordx4 a[152:155], v247, s[28:31], s73 offen offset:1024 sc1
    buffer_load_dwordx4 a[156:159], v247, s[28:31], s73 offen offset:2048 sc1
    buffer_load_dwordx4 a[160:163], v247, s[28:31], s73 offen offset:3072 sc1
    s_waitcnt vmcnt(8)
    v_mfma_f32_16x16x32_bf16 v[28:31], a[64:67], a[128:131], v[28:31]
    v_mfma_f32_16x16x32_bf16 v[32:35], a[68:71], a[128:131], v[32:35]
    s_waitcnt vmcnt(7)
    v_mfma_f32_16x16x32_bf16 v[60:63], a[64:67], a[132:135], v[60:63]
    v_mfma_f32_16x16x32_bf16 v[64:67], a[68:71], a[132:135], v[64:67]
    s_waitcnt vmcnt(6)
    v_mfma_f32_16x16x32_bf16 v[28:31], a[64:67], a[136:139], v[28:31]
    v_mfma_f32_16x16x32_bf16 v[32:35], a[68:71], a[136:139], v[32:35]
    s_waitcnt vmcnt(5)
    v_mfma_f32_16x16x32_bf16 v[60:63], a[64:67], a[140:143], v[60:63]
    v_mfma_f32_16x16x32_bf16 v[64:67], a[68:71], a[140:143], v[64:67]
    s_waitcnt vmcnt(4)
    v_mfma_f32_16x16x32_bf16 v[28:31], a[64:67], a[144:147], v[28:31]
    v_mfma_f32_16x16x32_bf16 v[32:35], a[68:71], a[144:147], v[32:35]
    s_waitcnt vmcnt(3)
    v_mfma_f32_16x16x32_bf16 v[60:63], a[64:67], a[148:151], v[60:63]
    v_mfma_f32_16x16x32_bf16 v[64:67], a[68:71], a[148:151], v[64:67]
    s_waitcnt vmcnt(2)
    v_mfma_f32_16x16x32_bf16 v[68:71], a[64:67], a[152:155], v[68:71]
    s_nop 1
    v_cvt_pk_bf16_f32 v28, v28, v29
    v_cvt_pk_bf16_f32 v29, v30, v31
    v_mfma_f32_16x16x32_bf16 v[72:75], a[68:71], a[152:155], v[72:75]
    s_waitcnt vmcnt(1)
    v_cvt_pk_bf16_f32 v30, v32, v33
    v_cvt_pk_bf16_f32 v31, v34, v35
    v_mfma_f32_16x16x32_bf16 v[68:71], a[64:67], a[156:159], v[68:71]
    v_permlane16_swap_b32 v28, v30
    v_permlane16_swap_b32 v29, v31
    v_mfma_f32_16x16x32_bf16 v[72:75], a[68:71], a[156:159], v[72:75]
    s_waitcnt vmcnt(0)
    buffer_store_dwordx4 v[28:31], v185, s[32:35], s74 offen offset:0 sc1
    v_mfma_f32_16x16x32_bf16 v[68:71], a[64:67], a[160:163], v[68:71]
    s_nop 0
    s_add_u32 s74, s74, 16384
    v_cvt_pk_bf16_f32 v60, v60, v61
    v_cvt_pk_bf16_f32 v61, v62, v63
    v_mfma_f32_16x16x32_bf16 v[72:75], a[68:71], a[160:163], v[72:75]
    v_cvt_pk_bf16_f32 v62, v64, v65
    v_cvt_pk_bf16_f32 v63, v66, v67
    s_nop 0
    v_permlane16_swap_b32 v60, v62
    v_permlane16_swap_b32 v61, v63
    buffer_store_dwordx4 v[60:63], v185, s[32:35], s74 offen offset:0 sc1
    v_cvt_pk_bf16_f32 v68, v68, v69
    v_cvt_pk_bf16_f32 v69, v70, v71
    v_cvt_pk_bf16_f32 v70, v72, v73
    v_cvt_pk_bf16_f32 v71, v74, v75
    s_nop 0
    v_permlane16_swap_b32 v68, v70
    v_permlane16_swap_b32 v69, v71
    buffer_store_dwordx4 v[68:71], v185, s[32:35], s75 offen offset:0 sc1
    s_endpgm
L_max0:
    s_nop 15
    v_lshrrev_b32 v28, 4, v247
    v_and_b32 v29, 15, v28
    v_lshlrev_b32 v29, 8, v29
    v_and_b32 v30, 16, v28
    v_lshl_add_u32 v29, v30, 1, v29
    v_lshrrev_b32 v30, 5, v28
    v_lshl_add_u32 v29, v30, 4, v29
    s_lshr_b32 s79, s80, 4
    v_add_u32 v24, s79, v29
    s_lshr_b32 s79, s81, 4
    v_add_u32 v25, s79, v29
    s_lshr_b32 s79, s82, 4
    v_add_u32 v26, s79, v29
    s_lshr_b32 s79, s83, 4
    v_add_u32 v27, s79, v29
    v_mov_b32 v20, 0xff800000
    v_mov_b32 v21, 0xff800000
    v_mov_b32 v22, 0xff800000
    s_and_b32 s98, s40, 0xfffc0000
    s_add_u32 s98, s98, 0
    s_mov_b32 s79, 0
L_maxl0:
    buffer_load_dwordx4 v[4:7], v24, s[12:15], s98 offen
    s_waitcnt vmcnt(0)
    v_mfma_f32_16x16x32_bf16 v[8:11], v[4:7], a[176:179], 0
    v_mfma_f32_16x16x32_bf16 v[12:15], v[4:7], a[192:195], 0
    v_mfma_f32_16x16x32_bf16 v[16:19], v[4:7], a[208:211], 0
    s_nop 15
    buffer_load_dwordx4 v[4:7], v25, s[12:15], s98 offen
    s_waitcnt vmcnt(0)
    v_mfma_f32_16x16x32_bf16 v[8:11], v[4:7], a[180:183], v[8:11]
    v_mfma_f32_16x16x32_bf16 v[12:15], v[4:7], a[196:199], v[12:15]
    v_mfma_f32_16x16x32_bf16 v[16:19], v[4:7], a[212:215], v[16:19]
    s_nop 15
    buffer_load_dwordx4 v[4:7], v26, s[12:15], s98 offen
    s_waitcnt vmcnt(0)
    v_mfma_f32_16x16x32_bf16 v[8:11], v[4:7], a[184:187], v[8:11]
    v_mfma_f32_16x16x32_bf16 v[12:15], v[4:7], a[200:203], v[12:15]
    v_mfma_f32_16x16x32_bf16 v[16:19], v[4:7], a[216:219], v[16:19]
    s_nop 15
    buffer_load_dwordx4 v[4:7], v27, s[12:15], s98 offen
    s_waitcnt vmcnt(0)
    v_mfma_f32_16x16x32_bf16 v[8:11], v[4:7], a[188:191], v[8:11]
    v_mfma_f32_16x16x32_bf16 v[12:15], v[4:7], a[204:207], v[12:15]
    v_mfma_f32_16x16x32_bf16 v[16:19], v[4:7], a[220:223], v[16:19]
    s_nop 15
    v_max3_f32 v20, v20, v8, v9
    v_max3_f32 v20, v20, v10, v11
    v_max3_f32 v21, v21, v12, v13
    v_max3_f32 v21, v21, v14, v15
    v_max3_f32 v22, v22, v16, v17
    v_max3_f32 v22, v22, v18, v19
    s_add_u32 s98, s98, 4096
    s_add_u32 s79, s79, 1
    s_cmp_lt_u32 s79, 32
    s_cbranch_scc1 L_maxl0
    v_mov_b32 v4, v20
    s_nop 1
    v_permlane16_swap_b32 v4, v20
    s_nop 1
    v_max_f32 v20, v4, v20
    v_mov_b32 v4, v20
    s_nop 1
    v_permlane32_swap_b32 v4, v20
    s_nop 1
    v_max_f32 v20, v4, v20
    v_xor_b32 v202, 0x80000000, v20
    v_xor_b32 v203, 0x80000000, v20
    v_xor_b32 v204, 0x80000000, v20
    v_xor_b32 v205, 0x80000000, v20
    v_mov_b32 v4, v21
    s_nop 1
    v_permlane16_swap_b32 v4, v21
    s_nop 1
    v_max_f32 v21, v4, v21
    v_mov_b32 v4, v21
    s_nop 1
    v_permlane32_swap_b32 v4, v21
    s_nop 1
    v_max_f32 v21, v4, v21
    v_xor_b32 v206, 0x80000000, v21
    v_xor_b32 v207, 0x80000000, v21
    v_xor_b32 v208, 0x80000000, v21
    v_xor_b32 v209, 0x80000000, v21
    v_mov_b32 v4, v22
    s_nop 1
    v_permlane16_swap_b32 v4, v22
    s_nop 1
    v_max_f32 v22, v4, v22
    v_mov_b32 v4, v22
    s_nop 1
    v_permlane32_swap_b32 v4, v22
    s_nop 1
    v_max_f32 v22, v4, v22
    v_xor_b32 v210, 0x80000000, v22
    v_xor_b32 v211, 0x80000000, v22
    v_xor_b32 v212, 0x80000000, v22
    v_xor_b32 v213, 0x80000000, v22
    s_nop 7
    s_branch L_maxret0
L_spin_ini:
    s_mov_b32 s79, 0
L_spin2_ini:
    buffer_load_dword v250, v1, s[84:87], 0 offen offset:0 sc1
    s_waitcnt vmcnt(0)
    v_cmp_gt_u32 vcc, s101, v250
    s_cbranch_vccz L_ret_ini
    s_add_u32 s79, s79, 1
    s_cmp_lt_u32 s79, 0x40000
    s_cbranch_scc0 L_ret_ini
    s_branch L_spin2_ini
L_max1:
    s_nop 15
    v_lshrrev_b32 v100, 4, v247
    v_and_b32 v101, 15, v100
    v_lshlrev_b32 v101, 8, v101
    v_and_b32 v102, 16, v100
    v_lshl_add_u32 v101, v102, 1, v101
    v_lshrrev_b32 v102, 5, v100
    v_lshl_add_u32 v101, v102, 4, v101
    s_lshr_b32 s79, s80, 4
    v_add_u32 v96, s79, v101
    s_lshr_b32 s79, s81, 4
    v_add_u32 v97, s79, v101
    s_lshr_b32 s79, s82, 4
    v_add_u32 v98, s79, v101
    s_lshr_b32 s79, s83, 4
    v_add_u32 v99, s79, v101
    v_mov_b32 v92, 0xff800000
    v_mov_b32 v93, 0xff800000
    v_mov_b32 v94, 0xff800000
    s_and_b32 s98, s40, 0xfffc0000
    s_add_u32 s98, s98, 131072
    s_mov_b32 s79, 0
L_maxl1:
    buffer_load_dwordx4 v[76:79], v96, s[12:15], s98 offen
    s_waitcnt vmcnt(0)
    v_mfma_f32_16x16x32_bf16 v[80:83], v[76:79], a[0:3], 0
    v_mfma_f32_16x16x32_bf16 v[84:87], v[76:79], a[64:67], 0
    v_mfma_f32_16x16x32_bf16 v[88:91], v[76:79], a[16:19], 0
    s_nop 15
    buffer_load_dwordx4 v[76:79], v97, s[12:15], s98 offen
    s_waitcnt vmcnt(0)
    v_mfma_f32_16x16x32_bf16 v[80:83], v[76:79], a[4:7], v[80:83]
    v_mfma_f32_16x16x32_bf16 v[84:87], v[76:79], a[68:71], v[84:87]
    v_mfma_f32_16x16x32_bf16 v[88:91], v[76:79], a[20:23], v[88:91]
    s_nop 15
    buffer_load_dwordx4 v[76:79], v98, s[12:15], s98 offen
    s_waitcnt vmcnt(0)
    v_mfma_f32_16x16x32_bf16 v[80:83], v[76:79], a[8:11], v[80:83]
    v_mfma_f32_16x16x32_bf16 v[84:87], v[76:79], a[72:75], v[84:87]
    v_mfma_f32_16x16x32_bf16 v[88:91], v[76:79], a[24:27], v[88:91]
    s_nop 15
    buffer_load_dwordx4 v[76:79], v99, s[12:15], s98 offen
    s_waitcnt vmcnt(0)
    v_mfma_f32_16x16x32_bf16 v[80:83], v[76:79], a[12:15], v[80:83]
    v_mfma_f32_16x16x32_bf16 v[84:87], v[76:79], a[76:79], v[84:87]
    v_mfma_f32_16x16x32_bf16 v[88:91], v[76:79], a[28:31], v[88:91]
    s_nop 15
    v_max3_f32 v92, v92, v80, v81
    v_max3_f32 v92, v92, v82, v83
    v_max3_f32 v93, v93, v84, v85
    v_max3_f32 v93, v93, v86, v87
    v_max3_f32 v94, v94, v88, v89
    v_max3_f32 v94, v94, v90, v91
    s_add_u32 s98, s98, 4096
    s_add_u32 s79, s79, 1
    s_cmp_lt_u32 s79, 32
    s_cbranch_scc1 L_maxl1
    v_mov_b32 v76, v92
    s_nop 1
    v_permlane16_swap_b32 v76, v92
    s_nop 1
    v_max_f32 v92, v76, v92
    v_mov_b32 v76, v92
    s_nop 1
    v_permlane32_swap_b32 v76, v92
    s_nop 1
    v_max_f32 v92, v76, v92
    v_xor_b32 v202, 0x80000000, v92
    v_xor_b32 v203, 0x80000000, v92
    v_xor_b32 v204, 0x80000000, v92
    v_xor_b32 v205, 0x80000000, v92
    v_mov_b32 v76, v93
    s_nop 1
    v_permlane16_swap_b32 v76, v93
    s_nop 1
    v_max_f32 v93, v76, v93
    v_mov_b32 v76, v93
    s_nop 1
    v_permlane32_swap_b32 v76, v93
    s_nop 1
    v_max_f32 v93, v76, v93
    v_xor_b32 v206, 0x80000000, v93
    v_xor_b32 v207, 0x80000000, v93
    v_xor_b32 v208, 0x80000000, v93
    v_xor_b32 v209, 0x80000000, v93
    v_mov_b32 v76, v94
    s_nop 1
    v_permlane16_swap_b32 v76, v94
    s_nop 1
    v_max_f32 v94, v76, v94
    v_mov_b32 v76, v94
    s_nop 1
    v_permlane32_swap_b32 v76, v94
    s_nop 1
    v_max_f32 v94, v76, v94
    v_xor_b32 v210, 0x80000000, v94
    v_xor_b32 v211, 0x80000000, v94
    v_xor_b32 v212, 0x80000000, v94
    v_xor_b32 v213, 0x80000000, v94
    s_nop 7
    s_branch L_maxret1
L_fail0:
    s_mov_b32 s76, -1
    s_mov_b32 s77, -1
    s_mov_b32 s41, 2130706432
    s_waitcnt vmcnt(0) lgkmcnt(0)
    s_nop 15
    s_barrier
    s_branch L_restart
L_fail1:
    s_mov_b32 s77, -1
    s_mov_b32 s41, 2130706432
    s_waitcnt vmcnt(0) lgkmcnt(0)
    s_nop 15
    s_barrier
    s_branch L_restart
L_spin_o0:
    s_mov_b32 s79, 0
L_spin2_o0:
    buffer_load_dword v254, v255, s[28:31], 0 offen offset:0 sc1
    s_waitcnt vmcnt(0)
    v_cmp_ne_u32 vcc, 1, v254
    s_cbranch_vccz L_ret_o0
    s_add_u32 s79, s79, 1
    s_cmp_lt_u32 s79, 0x40000
    s_cbranch_scc0 L_ret_o0
    s_branch L_spin2_o0
L_spin_o1:
    s_mov_b32 s79, 0
L_spin2_o1:
    buffer_load_dword v254, v255, s[28:31], 0 offen offset:4 sc1
    s_waitcnt vmcnt(0)
    v_cmp_ne_u32 vcc, 1, v254
    s_cbranch_vccz L_ret_o1
    s_add_u32 s79, s79, 1
    s_cmp_lt_u32 s79, 0x40000
    s_cbranch_scc0 L_ret_o1
    s_branch L_spin2_o1
L_spin_pp:
    s_mov_b32 s79, 0
L_spin2_pp:
    buffer_load_dword v254, v184, s[28:31], 0 offen offset:8 sc1
    s_waitcnt vmcnt(0)
    v_cmp_ne_u32 vcc, 1, v254
    s_cbranch_vccz L_ret_pp
    s_add_u32 s79, s79, 1
    s_cmp_lt_u32 s79, 0x40000
    s_cbranch_scc0 L_ret_pp
    s_branch L_spin2_pp
L_restart:
    v_mbcnt_lo_u32_b32 v161, -1, 0
    v_mbcnt_hi_u32_b32 v161, -1, v161
    s_lshl_b32 s3, s36, 15
    v_and_b32 v162, 15, v161
    v_lshrrev_b32 v163, 4, v161
    v_lshlrev_b32 v247, 4, v161
    v_xor_b32 v248, v162, v163
    v_lshlrev_b32 v248, 4, v248
    v_lshl_add_u32 v248, v163, 10, v248
    v_add_u32 v148, s3, v248
    v_xor_b32 v149, 64, v148
    v_add_u32 v149, 3072, v149
    v_xor_b32 v150, 128, v148
    v_add_u32 v150, 6144, v150
    v_xor_b32 v151, 192, v148
    v_add_u32 v151, 9216, v151
    s_mul_i32 s3, s36, 4160
    v_xor_b32 v160, s3, v248
    s_lshl_b32 s3, s36, 2
    v_add_u32 v250, s3, v163
    v_and_b32 v248, 7, v250
    v_lshlrev_b32 v248, 1, v248
    v_xor_b32 v248, v162, v248
    v_lshlrev_b32 v248, 4, v248
    s_lshl_b32 s3, s36, 4
    v_add_u32 v251, s3, v163
    v_lshl_add_u32 v246, v251, 13, v248
    v_lshl_add_u32 v249, v163, 8, s39
    v_add_u32 v245, v248, v249
    v_and_b32 v248, 0xf0, v160
    v_add_u32 v244, v248, v249
    s_branch L_go
L_exit:
    s_endpgm
.section .rodata,"a"
.p2align 6
.amdhsa_kernel standalone__mha_block_cached__near_ridge_kernel
  .amdhsa_next_free_vgpr 512
  .amdhsa_next_free_sgpr 102
  .amdhsa_accum_offset 256
  .amdhsa_group_segment_fixed_size 0
  .amdhsa_kernarg_size 64
  .amdhsa_user_sgpr_count 2
  .amdhsa_user_sgpr_kernarg_segment_ptr 1
  .amdhsa_system_sgpr_workgroup_id_x 1
.end_amdhsa_kernel
```
